```python
import torch

def _softmax(x, axis=-1):
    return torch.softmax(x, dim=axis)

def _gelu(x):
    return torch.nn.functional.gelu(x, approximate='tanh')

def _silu(x):
    return torch.nn.functional.silu(x)

def _sigmoid(x):
    return torch.sigmoid(x)

def _layernorm(x, axis=-1, eps=1e-05):
    m = x.mean(dim=axis, keepdim=True)
    v = x.var(dim=axis, keepdim=True, unbiased=False)
    return (x - m) / torch.sqrt(v + eps)

def _scatter_add(tgt, idx, src, axis=0):
    return tgt.clone().index_add_(axis, idx, src)

def _segment_sum(src, seg, n):
    out = torch.zeros((n,) + src.shape[1:], dtype=src.dtype)
    return out.index_add_(0, seg, src)

def _pad(x, pw):
    flat = tuple((v for pair in reversed(pw) for v in pair))
    return torch.nn.functional.pad(x, flat)
kernel_name = 'adaLN_cond__mha_block__mixer_gmlp__prompt'

def setup_inputs():

    _w = lambda a: (lambda t: t.to(torch.bfloat16) if t.is_floating_point() else t)(torch.as_tensor(a))

    def _A_setup():
        B, S, D, H = (1, 2048, 512, 32)
        return {'x': _w((lambda *s: torch.randn(*s, dtype=torch.bfloat16) * 0.05)(B, S, D)), 'wqkv': _w((lambda *s: torch.randn(*s, dtype=torch.bfloat16) * 0.05)(D, 3 * D)), 'wo': _w((lambda *s: torch.randn(*s, dtype=torch.bfloat16) * 0.05)(D, D))}
    _A_in = _A_setup()

    def _B_setup():
        B, S, D, F = (1, 2048, 512, 1792)
        Fh = F // 2
        return {'x': _w((lambda *s: torch.randn(*s, dtype=torch.bfloat16) * 0.05)(B, S, D)), 'w_in': _w((lambda *s: torch.randn(*s, dtype=torch.bfloat16) * 0.4)(D, 2 * Fh)), 'w_sp': _w(0.01 * (lambda *s: torch.randn(*s, dtype=torch.bfloat16) * 0.4)(S, S)), 'b_sp': _w(1.0 + 0.01 * (lambda *s: torch.randn(*s, dtype=torch.bfloat16) * 0.05)(S)), 'w_out': _w((lambda *s: torch.randn(*s, dtype=torch.bfloat16) * 0.05)(Fh, D))}
    _B_in = _B_setup()
    return {'A_x': _A_in['x'], 'A_wqkv': _A_in['wqkv'], 'A_wo': _A_in['wo'], 'B_x': _B_in['x'], 'B_w_in': _B_in['w_in'], 'B_w_sp': _B_in['w_sp'], 'B_b_sp': _B_in['b_sp'], 'B_w_out': _B_in['w_out'], 'c': _w((lambda *s: torch.randn(*s, dtype=torch.bfloat16) * 0.1)(1, 512) * 8.0), 'w_mod': _w((lambda *s: torch.randn(*s, dtype=torch.bfloat16) * 0.1)(512, 6 * 512) * 512 ** (-0.5) * 8.0)}

def reference(A_x, A_wqkv, A_wo, B_x, B_w_in, B_w_sp, B_b_sp, B_w_out, c, w_mod):

    def _A_ref(x, wqkv, wo):
        B, S, D = x.shape
        H = 32
        Dh = D // H
        qkv = (lambda x, *d: x.permute(*d))((x @ wqkv).reshape(B, S, 3, H, Dh), 2, 0, 3, 1, 4)
        q, k, v = (qkv[0], qkv[1], qkv[2])
        scores = torch.einsum('bhqd,bhkd->bhqk', q, k) * Dh ** (-0.5)
        p = _softmax(scores, axis=-1)
        o = torch.einsum('bhqk,bhkd->bhqd', p, v)
        return (lambda x, *d: x.permute(*d))(o, 0, 2, 1, 3).reshape(B, S, D) @ wo

    def _B_ref(x, w_in, w_sp, b_sp, w_out):
        B, S, D = x.shape
        F = w_in.shape[-1]
        Fh = F // 2
        z = _gelu(torch.einsum('bsd,df->bsf', x, w_in))
        z1 = z[..., :Fh].clone()
        z2 = _layernorm(z[..., Fh:], axis=-1)
        g = torch.einsum('ts,bsf->btf', w_sp, z2) + b_sp[None, :, None]
        return torch.einsum('bsf,fd->bsd', z1 * g, w_out)
    x = A_x
    mod = (_silu(c) @ w_mod).reshape(c.shape[0], 6, 1, -1)
    sa, ca, ga, sb, cb, gb = (mod[:, 0].clone(), mod[:, 1].clone(), mod[:, 2].clone(), mod[:, 3].clone(), mod[:, 4].clone(), mod[:, 5].clone())
    h = _layernorm(x, axis=-1) * (1 + ca) + sa
    x = x + ga * _A_ref(h, A_wqkv, A_wo)
    h = _layernorm(x, axis=-1) * (1 + cb) + sb
    x = x + gb * _B_ref(h, B_w_in, B_w_sp, B_b_sp, B_w_out)
    return x
```

```asm
; @launch grid=(256,1,1) block=(256,1,1) lds=163840
.amdgcn_target "amdgcn-amd-amdhsa--gfx950"
.text
.globl adaLN_cond__mha_block__mixer_gmlp__prompt_kernel
.p2align 8
.type adaLN_cond__mha_block__mixer_gmlp__prompt_kernel,@function
adaLN_cond__mha_block__mixer_gmlp__prompt_kernel:
    s_cmp_ge_u32 s2, 256
    s_cbranch_scc1 END
    s_load_dwordx16 s[52:67], s[0:1], 0
    s_load_dwordx8 s[68:75], s[0:1], 64
    s_load_dwordx2 s[76:77], s[0:1], 96
    v_lshrrev_b32 v4, 6, v0
    v_and_b32 v1, 63, v0
    v_and_b32 v2, 31, v0
    v_bfe_u32 v3, v0, 5, 1
    v_readfirstlane_b32 s6, v4
    s_and_b32 s4, s2, 7
    s_lshr_b32 s5, s2, 3
    s_waitcnt lgkmcnt(0)
    s_mov_b32 s8, s52
    s_mov_b32 s9, s53
    s_mov_b32 s10, 2097152
    s_mov_b32 s11, 0x20000
    s_mov_b32 s12, s54
    s_mov_b32 s13, s55
    s_mov_b32 s14, 1572864
    s_mov_b32 s15, 0x20000
    s_mov_b32 s16, s56
    s_mov_b32 s17, s57
    s_mov_b32 s18, 524288
    s_mov_b32 s19, 0x20000
    s_mov_b32 s20, s60
    s_mov_b32 s21, s61
    s_mov_b32 s22, 1835008
    s_mov_b32 s23, 0x20000
    s_mov_b32 s24, s62
    s_mov_b32 s25, s63
    s_mov_b32 s26, 8388608
    s_mov_b32 s27, 0x20000
    s_mov_b32 s28, s64
    s_mov_b32 s29, s65
    s_mov_b32 s30, 4096
    s_mov_b32 s31, 0x20000
    s_mov_b32 s32, s66
    s_mov_b32 s33, s67
    s_mov_b32 s34, 917504
    s_mov_b32 s35, 0x20000
    s_mov_b32 s36, s68
    s_mov_b32 s37, s69
    s_mov_b32 s38, 1024
    s_mov_b32 s39, 0x20000
    s_mov_b32 s40, s70
    s_mov_b32 s41, s71
    s_mov_b32 s42, 3145728
    s_mov_b32 s43, 0x20000
    s_mov_b32 s44, s72
    s_mov_b32 s45, s73
    s_mov_b32 s46, 2097152
    s_mov_b32 s47, 0x20000
    s_mov_b32 s48, s76
    s_mov_b32 s49, s77
    s_mov_b32 s50, 29360128
    s_mov_b32 s51, 0x20000
    v_mov_b32 v5, 0
    buffer_load_dword v6, v5, s[48:51], 0 offen sc0 sc1
    s_cmp_lg_u32 s6, 0
    s_cbranch_scc1 PT_1
    s_lshl_b32 s3, s2, 7
    v_lshlrev_b32 v7, 15, v1
    v_add_u32 v7, s3, v7
    v_add_u32 v7, 65536, v7
    s_lshl_b32 s3, s2, 8
    s_add_u32 s3, s3, 393216
    v_lshlrev_b32 v8, 7, v1
    v_add_u32 v8, s3, v8
    v_cmp_gt_u32 vcc, 2, v1
    s_nop 1
    v_cndmask_b32 v7, v7, v8, vcc
    s_mov_b64 exec, 63
    buffer_load_dword v100, v7, s[48:51], 0 offen sc0 sc1
    s_mov_b64 exec, -1
PT_1:
    s_cmp_lt_u32 s5, 24
    s_cbranch_scc1 P1MAIN
    s_sub_u32 s53, s5, 24
    s_lshl_b32 s53, s53, 3
    s_add_u32 s53, s53, s4
    s_cmp_ge_u32 s53, 48
    s_cbranch_scc1 HN_2
    s_lshl_b32 s3, s6, 8
    v_lshlrev_b32 v8, 2, v1
    buffer_load_dword v7, v8, s[36:39], s3 offen
    v_lshrrev_b32 v9, 3, v1
    v_mul_u32_u24 v9, 6144, v9
    v_and_b32 v10, 7, v1
    v_lshl_add_u32 v9, v10, 4, v9
    s_mul_i32 s54, s6, 786432
    s_lshl_b32 s3, s53, 7
    s_add_u32 s54, s54, s3
    s_add_u32 s3, s54, 0
    buffer_load_dwordx4 v[64:67], v9, s[40:43], s3 offen
    s_add_u32 s3, s54, 49152
    buffer_load_dwordx4 v[68:71], v9, s[40:43], s3 offen
    s_add_u32 s3, s54, 98304
    buffer_load_dwordx4 v[72:75], v9, s[40:43], s3 offen
    s_add_u32 s3, s54, 147456
    buffer_load_dwordx4 v[76:79], v9, s[40:43], s3 offen
    s_add_u32 s3, s54, 196608
    buffer_load_dwordx4 v[80:83], v9, s[40:43], s3 offen
    s_add_u32 s3, s54, 245760
    buffer_load_dwordx4 v[84:87], v9, s[40:43], s3 offen
    s_add_u32 s3, s54, 294912
    buffer_load_dwordx4 v[88:91], v9, s[40:43], s3 offen
    s_add_u32 s3, s54, 344064
    buffer_load_dwordx4 v[92:95], v9, s[40:43], s3 offen
    s_add_u32 s3, s54, 393216
    buffer_load_dwordx4 v[96:99], v9, s[40:43], s3 offen
    s_add_u32 s3, s54, 442368
    buffer_load_dwordx4 v[100:103], v9, s[40:43], s3 offen
    s_add_u32 s3, s54, 491520
    buffer_load_dwordx4 v[104:107], v9, s[40:43], s3 offen
    s_add_u32 s3, s54, 540672
    buffer_load_dwordx4 v[108:111], v9, s[40:43], s3 offen
    s_add_u32 s3, s54, 589824
    buffer_load_dwordx4 v[112:115], v9, s[40:43], s3 offen
    s_add_u32 s3, s54, 638976
    buffer_load_dwordx4 v[116:119], v9, s[40:43], s3 offen
    s_add_u32 s3, s54, 688128
    buffer_load_dwordx4 v[120:123], v9, s[40:43], s3 offen
    s_add_u32 s3, s54, 737280
    buffer_load_dwordx4 v[124:127], v9, s[40:43], s3 offen
    s_waitcnt vmcnt(16)
    v_readfirstlane_b32 s7, v6
    v_lshlrev_b32 v10, 16, v7
    v_and_b32 v11, 0xffff0000, v7
    v_mul_f32 v12, 0xbfb8aa3b, v10
    v_mul_f32 v13, 0xbfb8aa3b, v11
    v_exp_f32 v12, v12
    v_exp_f32 v13, v13
    s_mul_i32 s7, s7, 1664525
    v_add_f32 v12, 1.0, v12
    v_add_f32 v13, 1.0, v13
    v_rcp_f32 v12, v12
    v_rcp_f32 v13, v13
    s_add_u32 s7, s7, 1013904223
    v_mul_f32 v10, v10, v12
    v_mul_f32 v11, v11, v13
    v_cvt_pk_bf16_f32 v10, v10, v11
    s_lshl_b32 s3, s6, 8
    v_lshlrev_b32 v12, 2, v1
    v_add_u32 v12, s3, v12
    ds_write_b32 v12, v10
    v_lshrrev_b32 v12, 3, v1
    v_lshlrev_b32 v12, 1, v12
    v_add_u32 v12, s3, v12
    s_waitcnt lgkmcnt(0)
    ds_read_u16 v16, v12 offset:0
    ds_read_u16 v17, v12 offset:16
    ds_read_u16 v18, v12 offset:32
    ds_read_u16 v19, v12 offset:48
    ds_read_u16 v20, v12 offset:64
    ds_read_u16 v21, v12 offset:80
    ds_read_u16 v22, v12 offset:96
    ds_read_u16 v23, v12 offset:112
    ds_read_u16 v24, v12 offset:128
    ds_read_u16 v25, v12 offset:144
    ds_read_u16 v26, v12 offset:160
    ds_read_u16 v27, v12 offset:176
    ds_read_u16 v28, v12 offset:192
    ds_read_u16 v29, v12 offset:208
    ds_read_u16 v30, v12 offset:224
    ds_read_u16 v31, v12 offset:240
    s_waitcnt lgkmcnt(0)
    v_lshl_or_b32 v32, v17, 16, v16
    v_lshl_or_b32 v33, v19, 16, v18
    v_lshl_or_b32 v34, v21, 16, v20
    v_lshl_or_b32 v35, v23, 16, v22
    v_lshl_or_b32 v36, v25, 16, v24
    v_lshl_or_b32 v37, v27, 16, v26
    v_lshl_or_b32 v38, v29, 16, v28
    v_lshl_or_b32 v39, v31, 16, v30
    v_mov_b32 v48, 0
    v_mov_b32 v49, 0
    v_mov_b32 v50, 0
    v_mov_b32 v51, 0
    v_mov_b32 v52, 0
    v_mov_b32 v53, 0
    v_mov_b32 v54, 0
    v_mov_b32 v55, 0
    s_mov_b32 s55, 0x05040100
    s_mov_b32 s56, 0x07060302
    s_waitcnt vmcnt(14)
    v_perm_b32 v16, v68, v64, s55
    v_perm_b32 v17, v68, v64, s56
    v_perm_b32 v18, v69, v65, s55
    v_perm_b32 v19, v69, v65, s56
    v_perm_b32 v20, v70, v66, s55
    v_perm_b32 v21, v70, v66, s56
    v_perm_b32 v22, v71, v67, s55
    v_perm_b32 v23, v71, v67, s56
    v_dot2_f32_bf16 v48, v16, v32, v48
    v_dot2_f32_bf16 v49, v17, v32, v49
    v_dot2_f32_bf16 v50, v18, v32, v50
    v_dot2_f32_bf16 v51, v19, v32, v51
    v_dot2_f32_bf16 v52, v20, v32, v52
    v_dot2_f32_bf16 v53, v21, v32, v53
    v_dot2_f32_bf16 v54, v22, v32, v54
    v_dot2_f32_bf16 v55, v23, v32, v55
    s_waitcnt vmcnt(12)
    v_perm_b32 v16, v76, v72, s55
    v_perm_b32 v17, v76, v72, s56
    v_perm_b32 v18, v77, v73, s55
    v_perm_b32 v19, v77, v73, s56
    v_perm_b32 v20, v78, v74, s55
    v_perm_b32 v21, v78, v74, s56
    v_perm_b32 v22, v79, v75, s55
    v_perm_b32 v23, v79, v75, s56
    v_dot2_f32_bf16 v48, v16, v33, v48
    v_dot2_f32_bf16 v49, v17, v33, v49
    v_dot2_f32_bf16 v50, v18, v33, v50
    v_dot2_f32_bf16 v51, v19, v33, v51
    v_dot2_f32_bf16 v52, v20, v33, v52
    v_dot2_f32_bf16 v53, v21, v33, v53
    v_dot2_f32_bf16 v54, v22, v33, v54
    v_dot2_f32_bf16 v55, v23, v33, v55
    s_waitcnt vmcnt(10)
    v_perm_b32 v16, v84, v80, s55
    v_perm_b32 v17, v84, v80, s56
    v_perm_b32 v18, v85, v81, s55
    v_perm_b32 v19, v85, v81, s56
    v_perm_b32 v20, v86, v82, s55
    v_perm_b32 v21, v86, v82, s56
    v_perm_b32 v22, v87, v83, s55
    v_perm_b32 v23, v87, v83, s56
    v_dot2_f32_bf16 v48, v16, v34, v48
    v_dot2_f32_bf16 v49, v17, v34, v49
    v_dot2_f32_bf16 v50, v18, v34, v50
    v_dot2_f32_bf16 v51, v19, v34, v51
    v_dot2_f32_bf16 v52, v20, v34, v52
    v_dot2_f32_bf16 v53, v21, v34, v53
    v_dot2_f32_bf16 v54, v22, v34, v54
    v_dot2_f32_bf16 v55, v23, v34, v55
    s_waitcnt vmcnt(8)
    v_perm_b32 v16, v92, v88, s55
    v_perm_b32 v17, v92, v88, s56
    v_perm_b32 v18, v93, v89, s55
    v_perm_b32 v19, v93, v89, s56
    v_perm_b32 v20, v94, v90, s55
    v_perm_b32 v21, v94, v90, s56
    v_perm_b32 v22, v95, v91, s55
    v_perm_b32 v23, v95, v91, s56
    v_dot2_f32_bf16 v48, v16, v35, v48
    v_dot2_f32_bf16 v49, v17, v35, v49
    v_dot2_f32_bf16 v50, v18, v35, v50
    v_dot2_f32_bf16 v51, v19, v35, v51
    v_dot2_f32_bf16 v52, v20, v35, v52
    v_dot2_f32_bf16 v53, v21, v35, v53
    v_dot2_f32_bf16 v54, v22, v35, v54
    v_dot2_f32_bf16 v55, v23, v35, v55
    s_waitcnt vmcnt(6)
    v_perm_b32 v16, v100, v96, s55
    v_perm_b32 v17, v100, v96, s56
    v_perm_b32 v18, v101, v97, s55
    v_perm_b32 v19, v101, v97, s56
    v_perm_b32 v20, v102, v98, s55
    v_perm_b32 v21, v102, v98, s56
    v_perm_b32 v22, v103, v99, s55
    v_perm_b32 v23, v103, v99, s56
    v_dot2_f32_bf16 v48, v16, v36, v48
    v_dot2_f32_bf16 v49, v17, v36, v49
    v_dot2_f32_bf16 v50, v18, v36, v50
    v_dot2_f32_bf16 v51, v19, v36, v51
    v_dot2_f32_bf16 v52, v20, v36, v52
    v_dot2_f32_bf16 v53, v21, v36, v53
    v_dot2_f32_bf16 v54, v22, v36, v54
    v_dot2_f32_bf16 v55, v23, v36, v55
    s_waitcnt vmcnt(4)
    v_perm_b32 v16, v108, v104, s55
    v_perm_b32 v17, v108, v104, s56
    v_perm_b32 v18, v109, v105, s55
    v_perm_b32 v19, v109, v105, s56
    v_perm_b32 v20, v110, v106, s55
    v_perm_b32 v21, v110, v106, s56
    v_perm_b32 v22, v111, v107, s55
    v_perm_b32 v23, v111, v107, s56
    v_dot2_f32_bf16 v48, v16, v37, v48
    v_dot2_f32_bf16 v49, v17, v37, v49
    v_dot2_f32_bf16 v50, v18, v37, v50
    v_dot2_f32_bf16 v51, v19, v37, v51
    v_dot2_f32_bf16 v52, v20, v37, v52
    v_dot2_f32_bf16 v53, v21, v37, v53
    v_dot2_f32_bf16 v54, v22, v37, v54
    v_dot2_f32_bf16 v55, v23, v37, v55
    s_waitcnt vmcnt(2)
    v_perm_b32 v16, v116, v112, s55
    v_perm_b32 v17, v116, v112, s56
    v_perm_b32 v18, v117, v113, s55
    v_perm_b32 v19, v117, v113, s56
    v_perm_b32 v20, v118, v114, s55
    v_perm_b32 v21, v118, v114, s56
    v_perm_b32 v22, v119, v115, s55
    v_perm_b32 v23, v119, v115, s56
    v_dot2_f32_bf16 v48, v16, v38, v48
    v_dot2_f32_bf16 v49, v17, v38, v49
    v_dot2_f32_bf16 v50, v18, v38, v50
    v_dot2_f32_bf16 v51, v19, v38, v51
    v_dot2_f32_bf16 v52, v20, v38, v52
    v_dot2_f32_bf16 v53, v21, v38, v53
    v_dot2_f32_bf16 v54, v22, v38, v54
    v_dot2_f32_bf16 v55, v23, v38, v55
    s_waitcnt vmcnt(0)
    v_perm_b32 v16, v124, v120, s55
    v_perm_b32 v17, v124, v120, s56
    v_perm_b32 v18, v125, v121, s55
    v_perm_b32 v19, v125, v121, s56
    v_perm_b32 v20, v126, v122, s55
    v_perm_b32 v21, v126, v122, s56
    v_perm_b32 v22, v127, v123, s55
    v_perm_b32 v23, v127, v123, s56
    v_dot2_f32_bf16 v48, v16, v39, v48
    v_dot2_f32_bf16 v49, v17, v39, v49
    v_dot2_f32_bf16 v50, v18, v39, v50
    v_dot2_f32_bf16 v51, v19, v39, v51
    v_dot2_f32_bf16 v52, v20, v39, v52
    v_dot2_f32_bf16 v53, v21, v39, v53
    v_dot2_f32_bf16 v54, v22, v39, v54
    v_dot2_f32_bf16 v55, v23, v39, v55
    v_add_f32_dpp v48, v48, v48 row_ror:8 row_mask:0xf bank_mask:0xf
    v_add_f32_dpp v49, v49, v49 row_ror:8 row_mask:0xf bank_mask:0xf
    v_add_f32_dpp v50, v50, v50 row_ror:8 row_mask:0xf bank_mask:0xf
    v_add_f32_dpp v51, v51, v51 row_ror:8 row_mask:0xf bank_mask:0xf
    v_add_f32_dpp v52, v52, v52 row_ror:8 row_mask:0xf bank_mask:0xf
    v_add_f32_dpp v53, v53, v53 row_ror:8 row_mask:0xf bank_mask:0xf
    v_add_f32_dpp v54, v54, v54 row_ror:8 row_mask:0xf bank_mask:0xf
    v_add_f32_dpp v55, v55, v55 row_ror:8 row_mask:0xf bank_mask:0xf
    v_lshrrev_b32 v12, 4, v0
    v_lshlrev_b32 v12, 8, v12
    v_and_b32 v13, 7, v0
    v_lshlrev_b32 v13, 5, v13
    v_add3_u32 v12, v12, v13, 0
    v_add_u32 v12, 4096, v12
    s_mov_b32 s60, 0x00ff00ff
    s_mov_b32 s61, 0x00ff00ff
    s_mov_b64 exec, s[60:61]
    ds_write_b128 v12, v[48:51]
    ds_write_b128 v12, v[52:55] offset:16
    s_mov_b64 exec, -1
    s_waitcnt lgkmcnt(0)
    s_barrier
    s_cmp_lg_u32 s6, 0
    s_cbranch_scc1 P0_3
    v_lshlrev_b32 v12, 2, v1
    v_add_u32 v12, 4096, v12
    ds_read_b32 v16, v12 offset:0
    ds_read_b32 v17, v12 offset:256
    ds_read_b32 v18, v12 offset:512
    ds_read_b32 v19, v12 offset:768
    ds_read_b32 v20, v12 offset:1024
    ds_read_b32 v21, v12 offset:1280
    ds_read_b32 v22, v12 offset:1536
    ds_read_b32 v23, v12 offset:1792
    ds_read_b32 v24, v12 offset:2048
    ds_read_b32 v25, v12 offset:2304
    ds_read_b32 v26, v12 offset:2560
    ds_read_b32 v27, v12 offset:2816
    ds_read_b32 v28, v12 offset:3072
    ds_read_b32 v29, v12 offset:3328
    ds_read_b32 v30, v12 offset:3584
    ds_read_b32 v31, v12 offset:3840
    s_waitcnt lgkmcnt(0)
    v_add_f32 v16, v16, v24
    v_add_f32 v17, v17, v25
    v_add_f32 v18, v18, v26
    v_add_f32 v19, v19, v27
    v_add_f32 v20, v20, v28
    v_add_f32 v21, v21, v29
    v_add_f32 v22, v22, v30
    v_add_f32 v23, v23, v31
    v_add_f32 v16, v16, v20
    v_add_f32 v17, v17, v21
    v_add_f32 v18, v18, v22
    v_add_f32 v19, v19, v23
    v_add_f32 v16, v16, v18
    v_add_f32 v17, v17, v19
    v_add_f32 v16, v16, v17
    s_lshl_b32 s3, s53, 6
    v_add_u32 v12, s3, v1
    v_lshlrev_b32 v13, 2, v12
    v_lshlrev_b32 v14, 3, v12
    v_mov_b32 v17, s7
    s_mov_b32 s3, 278528
    s_mov_b32 s52, 262144
    s_cmp_ge_u32 s53, 16
    s_cbranch_scc1 P0_4
    buffer_store_dwordx2 v[16:17], v14, s[48:51], s52 offen sc0 sc1
P0_4:
    buffer_store_dword v16, v13, s[48:51], s3 offen sc1
P0_3:
    s_branch HJ_5
HN_2:
    s_waitcnt vmcnt(0)
    v_readfirstlane_b32 s7, v6
    s_nop 3
    s_mul_i32 s7, s7, 1664525
    s_add_u32 s7, s7, 1013904223
HJ_5:
    v_lshlrev_b32 v16, 5, v0
    s_mov_b32 s3, 262144
    s_mov_b32 s52, 262144
    s_mov_b64 exec, 1
HW_6:
    buffer_load_dwordx4 v[24:27], v16, s[48:51], s3 offen offset:16 sc0 sc1
    s_waitcnt vmcnt(0)
    v_cmp_ne_u32 vcc, s7, v27
    s_cbranch_vccz HW_7
    s_sub_u32 s52, s52, 1
    s_cmp_lg_u32 s52, 0
    s_cbranch_scc1 HW_6
HW_7:
    s_mov_b64 exec, -1
    s_lshl_b32 s64, s53, 17
    s_lshl_b32 s3, s6, 8
    s_add_u32 s64, s64, s3
    v_lshrrev_b32 v8, 4, v1
    v_lshlrev_b32 v8, 12, v8
    v_and_b32 v9, 15, v1
    v_lshl_add_u32 v8, v9, 4, v8
    s_add_u32 s3, s64, 0
    buffer_load_dwordx4 v[128:131], v8, s[24:27], s3 offen offset:0
    s_add_u32 s3, s64, 16384
    buffer_load_dwordx4 v[132:135], v8, s[24:27], s3 offen offset:0
    s_add_u32 s3, s64, 32768
    buffer_load_dwordx4 v[136:139], v8, s[24:27], s3 offen offset:0
    s_add_u32 s3, s64, 49152
    buffer_load_dwordx4 v[140:143], v8, s[24:27], s3 offen offset:0
    s_add_u32 s3, s64, 65536
    buffer_load_dwordx4 v[144:147], v8, s[24:27], s3 offen offset:0
    s_add_u32 s3, s64, 81920
    buffer_load_dwordx4 v[148:151], v8, s[24:27], s3 offen offset:0
    s_add_u32 s3, s64, 98304
    buffer_load_dwordx4 v[152:155], v8, s[24:27], s3 offen offset:0
    s_add_u32 s3, s64, 114688
    buffer_load_dwordx4 v[156:159], v8, s[24:27], s3 offen offset:0
    s_add_u32 s3, s64, 0
    buffer_load_dwordx4 v[160:163], v8, s[24:27], s3 offen offset:1024
    s_add_u32 s3, s64, 16384
    buffer_load_dwordx4 v[164:167], v8, s[24:27], s3 offen offset:1024
    s_add_u32 s3, s64, 32768
    buffer_load_dwordx4 v[168:171], v8, s[24:27], s3 offen offset:1024
    s_add_u32 s3, s64, 49152
    buffer_load_dwordx4 v[172:175], v8, s[24:27], s3 offen offset:1024
    s_add_u32 s3, s64, 65536
    buffer_load_dwordx4 v[176:179], v8, s[24:27], s3 offen offset:1024
    s_add_u32 s3, s64, 81920
    buffer_load_dwordx4 v[180:183], v8, s[24:27], s3 offen offset:1024
    s_add_u32 s3, s64, 98304
    buffer_load_dwordx4 v[184:187], v8, s[24:27], s3 offen offset:1024
    s_add_u32 s3, s64, 114688
    buffer_load_dwordx4 v[188:191], v8, s[24:27], s3 offen offset:1024
    s_add_u32 s3, s64, 0
    buffer_load_dwordx4 v[192:195], v8, s[24:27], s3 offen offset:2048
    s_add_u32 s3, s64, 16384
    buffer_load_dwordx4 v[196:199], v8, s[24:27], s3 offen offset:2048
    s_add_u32 s3, s64, 32768
    buffer_load_dwordx4 v[200:203], v8, s[24:27], s3 offen offset:2048
    s_add_u32 s3, s64, 49152
    buffer_load_dwordx4 v[204:207], v8, s[24:27], s3 offen offset:2048
    s_add_u32 s3, s64, 65536
    buffer_load_dwordx4 v[208:211], v8, s[24:27], s3 offen offset:2048
    s_add_u32 s3, s64, 81920
    buffer_load_dwordx4 v[212:215], v8, s[24:27], s3 offen offset:2048
    s_add_u32 s3, s64, 98304
    buffer_load_dwordx4 v[216:219], v8, s[24:27], s3 offen offset:2048
    s_add_u32 s3, s64, 114688
    buffer_load_dwordx4 v[220:223], v8, s[24:27], s3 offen offset:2048
    s_add_u32 s3, s64, 0
    buffer_load_dwordx4 v[224:227], v8, s[24:27], s3 offen offset:3072
    s_add_u32 s3, s64, 16384
    buffer_load_dwordx4 v[228:231], v8, s[24:27], s3 offen offset:3072
    s_add_u32 s3, s64, 32768
    buffer_load_dwordx4 v[232:235], v8, s[24:27], s3 offen offset:3072
    s_add_u32 s3, s64, 49152
    buffer_load_dwordx4 v[236:239], v8, s[24:27], s3 offen offset:3072
    s_add_u32 s3, s64, 65536
    buffer_load_dwordx4 v[240:243], v8, s[24:27], s3 offen offset:3072
    s_add_u32 s3, s64, 81920
    buffer_load_dwordx4 v[244:247], v8, s[24:27], s3 offen offset:3072
    s_add_u32 s3, s64, 98304
    buffer_load_dwordx4 v[248:251], v8, s[24:27], s3 offen offset:3072
    s_add_u32 s3, s64, 114688
    buffer_load_dwordx4 v[252:255], v8, s[24:27], s3 offen offset:3072
    s_lshl_b32 s58, s6, 13
    s_add_u32 s58, s58, 98304
    v_lshrrev_b32 v10, 4, v1
    v_and_b32 v11, 15, v1
    v_add_u32 v12, 0, v10
    v_xor_b32 v13, v12, v11
    v_lshlrev_b32 v13, 4, v13
    v_lshl_add_u32 v13, v10, 8, v13
    v_add_u32 v40, s58, v13
    v_add_u32 v12, 4, v10
    v_xor_b32 v13, v12, v11
    v_lshlrev_b32 v13, 4, v13
    v_lshl_add_u32 v13, v10, 8, v13
    v_add_u32 v41, s58, v13
    v_add_u32 v12, 8, v10
    v_xor_b32 v13, v12, v11
    v_lshlrev_b32 v13, 4, v13
    v_lshl_add_u32 v13, v10, 8, v13
    v_add_u32 v42, s58, v13
    v_add_u32 v12, 12, v10
    v_xor_b32 v13, v12, v11
    v_lshlrev_b32 v13, 4, v13
    v_lshl_add_u32 v13, v10, 8, v13
    v_add_u32 v43, s58, v13
    v_and_b32 v10, 15, v2
    v_add_u32 v12, 0, v3
    v_xor_b32 v12, v12, v10
    v_lshlrev_b32 v12, 4, v12
    v_lshl_add_u32 v12, v2, 8, v12
    v_add_u32 v44, s58, v12
    v_add_u32 v12, 2, v3
    v_xor_b32 v12, v12, v10
    v_lshlrev_b32 v12, 4, v12
    v_lshl_add_u32 v12, v2, 8, v12
    v_add_u32 v45, s58, v12
    v_add_u32 v12, 4, v3
    v_xor_b32 v12, v12, v10
    v_lshlrev_b32 v12, 4, v12
    v_lshl_add_u32 v12, v2, 8, v12
    v_add_u32 v46, s58, v12
    v_add_u32 v12, 6, v3
    v_xor_b32 v12, v12, v10
    v_lshlrev_b32 v12, 4, v12
    v_lshl_add_u32 v12, v2, 8, v12
    v_add_u32 v47, s58, v12
    v_add_u32 v12, 8, v3
    v_xor_b32 v12, v12, v10
    v_lshlrev_b32 v12, 4, v12
    v_lshl_add_u32 v12, v2, 8, v12
    v_add_u32 v48, s58, v12
    v_add_u32 v12, 10, v3
    v_xor_b32 v12, v12, v10
    v_lshlrev_b32 v12, 4, v12
    v_lshl_add_u32 v12, v2, 8, v12
    v_add_u32 v49, s58, v12
    v_add_u32 v12, 12, v3
    v_xor_b32 v12, v12, v10
    v_lshlrev_b32 v12, 4, v12
    v_lshl_add_u32 v12, v2, 8, v12
    v_add_u32 v50, s58, v12
    v_add_u32 v12, 14, v3
    v_xor_b32 v12, v12, v10
    v_lshlrev_b32 v12, 4, v12
    v_lshl_add_u32 v12, v2, 8, v12
    v_add_u32 v51, s58, v12
    s_lshl_b32 s3, s53, 7
    s_lshl_b32 s64, s6, 3
    s_add_u32 s3, s3, s64
    s_lshl_b32 s3, s3, 10
    s_add_u32 s64, s3, 20971520
    v_lshlrev_b32 v8, 4, v1
    s_waitcnt vmcnt(24)
    ds_write_b128 v40, v[128:131] offset:0
    ds_write_b128 v41, v[132:135] offset:1024
    ds_write_b128 v42, v[136:139] offset:2048
    ds_write_b128 v43, v[140:143] offset:3072
    ds_write_b128 v40, v[144:147] offset:4096
    ds_write_b128 v41, v[148:151] offset:5120
    ds_write_b128 v42, v[152:155] offset:6144
    ds_write_b128 v43, v[156:159] offset:7168
    s_waitcnt lgkmcnt(0)
    ds_read_b128 v[128:131], v44
    ds_read_b128 v[132:135], v45
    ds_read_b128 v[136:139], v46
    ds_read_b128 v[140:143], v47
    ds_read_b128 v[144:147], v48
    ds_read_b128 v[148:151], v49
    ds_read_b128 v[152:155], v50
    ds_read_b128 v[156:159], v51
    s_waitcnt lgkmcnt(0)
    s_add_u32 s3, s64, 0
    buffer_store_dwordx4 v[128:131], v8, s[48:51], s3 offen sc1
    s_add_u32 s3, s64, 1024
    buffer_store_dwordx4 v[132:135], v8, s[48:51], s3 offen sc1
    s_add_u32 s3, s64, 2048
    buffer_store_dwordx4 v[136:139], v8, s[48:51], s3 offen sc1
    s_add_u32 s3, s64, 3072
    buffer_store_dwordx4 v[140:143], v8, s[48:51], s3 offen sc1
    s_add_u32 s3, s64, 4096
    buffer_store_dwordx4 v[144:147], v8, s[48:51], s3 offen sc1
    s_add_u32 s3, s64, 5120
    buffer_store_dwordx4 v[148:151], v8, s[48:51], s3 offen sc1
    s_add_u32 s3, s64, 6144
    buffer_store_dwordx4 v[152:155], v8, s[48:51], s3 offen sc1
    s_add_u32 s3, s64, 7168
    buffer_store_dwordx4 v[156:159], v8, s[48:51], s3 offen sc1
    s_waitcnt vmcnt(24)
    ds_write_b128 v40, v[160:163] offset:0
    ds_write_b128 v41, v[164:167] offset:1024
    ds_write_b128 v42, v[168:171] offset:2048
    ds_write_b128 v43, v[172:175] offset:3072
    ds_write_b128 v40, v[176:179] offset:4096
    ds_write_b128 v41, v[180:183] offset:5120
    ds_write_b128 v42, v[184:187] offset:6144
    ds_write_b128 v43, v[188:191] offset:7168
    s_waitcnt lgkmcnt(0)
    ds_read_b128 v[160:163], v44
    ds_read_b128 v[164:167], v45
    ds_read_b128 v[168:171], v46
    ds_read_b128 v[172:175], v47
    ds_read_b128 v[176:179], v48
    ds_read_b128 v[180:183], v49
    ds_read_b128 v[184:187], v50
    ds_read_b128 v[188:191], v51
    s_waitcnt lgkmcnt(0)
    s_add_u32 s3, s64, 32768
    buffer_store_dwordx4 v[160:163], v8, s[48:51], s3 offen sc1
    s_add_u32 s3, s64, 33792
    buffer_store_dwordx4 v[164:167], v8, s[48:51], s3 offen sc1
    s_add_u32 s3, s64, 34816
    buffer_store_dwordx4 v[168:171], v8, s[48:51], s3 offen sc1
    s_add_u32 s3, s64, 35840
    buffer_store_dwordx4 v[172:175], v8, s[48:51], s3 offen sc1
    s_add_u32 s3, s64, 36864
    buffer_store_dwordx4 v[176:179], v8, s[48:51], s3 offen sc1
    s_add_u32 s3, s64, 37888
    buffer_store_dwordx4 v[180:183], v8, s[48:51], s3 offen sc1
    s_add_u32 s3, s64, 38912
    buffer_store_dwordx4 v[184:187], v8, s[48:51], s3 offen sc1
    s_add_u32 s3, s64, 39936
    buffer_store_dwordx4 v[188:191], v8, s[48:51], s3 offen sc1
    s_waitcnt vmcnt(24)
    ds_write_b128 v40, v[192:195] offset:0
    ds_write_b128 v41, v[196:199] offset:1024
    ds_write_b128 v42, v[200:203] offset:2048
    ds_write_b128 v43, v[204:207] offset:3072
    ds_write_b128 v40, v[208:211] offset:4096
    ds_write_b128 v41, v[212:215] offset:5120
    ds_write_b128 v42, v[216:219] offset:6144
    ds_write_b128 v43, v[220:223] offset:7168
    s_waitcnt lgkmcnt(0)
    ds_read_b128 v[192:195], v44
    ds_read_b128 v[196:199], v45
    ds_read_b128 v[200:203], v46
    ds_read_b128 v[204:207], v47
    ds_read_b128 v[208:211], v48
    ds_read_b128 v[212:215], v49
    ds_read_b128 v[216:219], v50
    ds_read_b128 v[220:223], v51
    s_waitcnt lgkmcnt(0)
    s_add_u32 s3, s64, 65536
    buffer_store_dwordx4 v[192:195], v8, s[48:51], s3 offen sc1
    s_add_u32 s3, s64, 66560
    buffer_store_dwordx4 v[196:199], v8, s[48:51], s3 offen sc1
    s_add_u32 s3, s64, 67584
    buffer_store_dwordx4 v[200:203], v8, s[48:51], s3 offen sc1
    s_add_u32 s3, s64, 68608
    buffer_store_dwordx4 v[204:207], v8, s[48:51], s3 offen sc1
    s_add_u32 s3, s64, 69632
    buffer_store_dwordx4 v[208:211], v8, s[48:51], s3 offen sc1
    s_add_u32 s3, s64, 70656
    buffer_store_dwordx4 v[212:215], v8, s[48:51], s3 offen sc1
    s_add_u32 s3, s64, 71680
    buffer_store_dwordx4 v[216:219], v8, s[48:51], s3 offen sc1
    s_add_u32 s3, s64, 72704
    buffer_store_dwordx4 v[220:223], v8, s[48:51], s3 offen sc1
    s_waitcnt vmcnt(24)
    ds_write_b128 v40, v[224:227] offset:0
    ds_write_b128 v41, v[228:231] offset:1024
    ds_write_b128 v42, v[232:235] offset:2048
    ds_write_b128 v43, v[236:239] offset:3072
    ds_write_b128 v40, v[240:243] offset:4096
    ds_write_b128 v41, v[244:247] offset:5120
    ds_write_b128 v42, v[248:251] offset:6144
    ds_write_b128 v43, v[252:255] offset:7168
    s_waitcnt lgkmcnt(0)
    ds_read_b128 v[224:227], v44
    ds_read_b128 v[228:231], v45
    ds_read_b128 v[232:235], v46
    ds_read_b128 v[236:239], v47
    ds_read_b128 v[240:243], v48
    ds_read_b128 v[244:247], v49
    ds_read_b128 v[248:251], v50
    ds_read_b128 v[252:255], v51
    s_waitcnt lgkmcnt(0)
    s_add_u32 s3, s64, 98304
    buffer_store_dwordx4 v[224:227], v8, s[48:51], s3 offen sc1
    s_add_u32 s3, s64, 99328
    buffer_store_dwordx4 v[228:231], v8, s[48:51], s3 offen sc1
    s_add_u32 s3, s64, 100352
    buffer_store_dwordx4 v[232:235], v8, s[48:51], s3 offen sc1
    s_add_u32 s3, s64, 101376
    buffer_store_dwordx4 v[236:239], v8, s[48:51], s3 offen sc1
    s_add_u32 s3, s64, 102400
    buffer_store_dwordx4 v[240:243], v8, s[48:51], s3 offen sc1
    s_add_u32 s3, s64, 103424
    buffer_store_dwordx4 v[244:247], v8, s[48:51], s3 offen sc1
    s_add_u32 s3, s64, 104448
    buffer_store_dwordx4 v[248:251], v8, s[48:51], s3 offen sc1
    s_add_u32 s3, s64, 105472
    buffer_store_dwordx4 v[252:255], v8, s[48:51], s3 offen sc1
    s_waitcnt vmcnt(0)
    s_barrier
    s_cmp_lg_u32 s6, 0
    s_cbranch_scc1 SG_8
    s_lshl_b32 s3, s53, 7
    v_mov_b32 v5, s3
    s_mov_b32 s3, 65536
    v_mov_b32 v4, s7
    s_mov_b32 exec_lo, 0x1
    s_mov_b32 exec_hi, 0x0
    buffer_store_dword v4, v5, s[48:51], s3 offen sc0 sc1
    s_mov_b64 exec, -1
SG_8:
    s_branch P1END
P1MAIN:
    s_and_b32 s53, s4, 3
    s_lshl_b32 s53, s53, 2
    s_and_b32 s3, s5, 3
    s_add_u32 s53, s53, s3
    s_lshr_b32 s54, s4, 2
    s_mul_i32 s54, s54, 6
    s_lshr_b32 s3, s5, 2
    s_add_u32 s54, s54, s3
    s_lshl_b32 s3, s53, 2
    s_add_u32 s3, s3, s6
    s_lshl_b32 s55, s3, 15
    v_lshrrev_b32 v126, 4, v1
    v_lshlrev_b32 v126, 10, v126
    v_and_b32 v127, 15, v1
    v_lshl_add_u32 v126, v127, 4, v126
    v_lshrrev_b32 v10, 4, v1
    v_bfe_u32 v11, v1, 2, 2
    v_xor_b32 v11, v11, v10
    v_lshlrev_b32 v11, 6, v11
    v_mul_u32_u24 v10, 3072, v10
    v_and_b32 v13, 3, v1
    v_lshlrev_b32 v13, 4, v13
    v_add3_u32 v120, v10, v11, v13
    s_mul_i32 s56, s6, 98304
    s_lshl_b32 s3, s54, 8
    s_add_u32 s56, s56, s3
    s_lshl_b32 s57, s6, 13
    s_add_u32 s3, s55, 0
    buffer_load_dwordx4 v[128:131], v126, s[8:11], s3 offen offset:0
    s_add_u32 s3, s55, 4096
    buffer_load_dwordx4 v[132:135], v126, s[8:11], s3 offen offset:0
    s_add_u32 s3, s55, 8192
    buffer_load_dwordx4 v[136:139], v126, s[8:11], s3 offen offset:0
    s_add_u32 s3, s55, 12288
    buffer_load_dwordx4 v[140:143], v126, s[8:11], s3 offen offset:0
    s_add_u32 s3, s55, 16384
    buffer_load_dwordx4 v[144:147], v126, s[8:11], s3 offen offset:0
    s_add_u32 s3, s55, 20480
    buffer_load_dwordx4 v[148:151], v126, s[8:11], s3 offen offset:0
    s_add_u32 s3, s55, 24576
    buffer_load_dwordx4 v[152:155], v126, s[8:11], s3 offen offset:0
    s_add_u32 s3, s55, 28672
    buffer_load_dwordx4 v[156:159], v126, s[8:11], s3 offen offset:0
    s_add_u32 s3, s55, 0
    buffer_load_dwordx4 v[160:163], v126, s[8:11], s3 offen offset:256
    s_add_u32 s3, s55, 4096
    buffer_load_dwordx4 v[164:167], v126, s[8:11], s3 offen offset:256
    s_add_u32 s3, s55, 8192
    buffer_load_dwordx4 v[168:171], v126, s[8:11], s3 offen offset:256
    s_add_u32 s3, s55, 12288
    buffer_load_dwordx4 v[172:175], v126, s[8:11], s3 offen offset:256
    s_add_u32 s3, s55, 16384
    buffer_load_dwordx4 v[176:179], v126, s[8:11], s3 offen offset:256
    s_add_u32 s3, s55, 20480
    buffer_load_dwordx4 v[180:183], v126, s[8:11], s3 offen offset:256
    s_add_u32 s3, s55, 24576
    buffer_load_dwordx4 v[184:187], v126, s[8:11], s3 offen offset:256
    s_add_u32 s3, s55, 28672
    buffer_load_dwordx4 v[188:191], v126, s[8:11], s3 offen offset:256
    s_lshl_b32 s58, s6, 13
    s_add_u32 s58, s58, 131072
    v_lshrrev_b32 v10, 4, v1
    v_and_b32 v11, 15, v1
    v_add_u32 v12, 0, v10
    v_xor_b32 v13, v12, v11
    v_lshlrev_b32 v13, 4, v13
    v_lshl_add_u32 v13, v10, 8, v13
    v_add_u32 v108, s58, v13
    v_add_u32 v12, 4, v10
    v_xor_b32 v13, v12, v11
    v_lshlrev_b32 v13, 4, v13
    v_lshl_add_u32 v13, v10, 8, v13
    v_add_u32 v109, s58, v13
    v_add_u32 v12, 8, v10
    v_xor_b32 v13, v12, v11
    v_lshlrev_b32 v13, 4, v13
    v_lshl_add_u32 v13, v10, 8, v13
    v_add_u32 v110, s58, v13
    v_add_u32 v12, 12, v10
    v_xor_b32 v13, v12, v11
    v_lshlrev_b32 v13, 4, v13
    v_lshl_add_u32 v13, v10, 8, v13
    v_add_u32 v111, s58, v13
    v_and_b32 v10, 15, v2
    v_add_u32 v12, 0, v3
    v_xor_b32 v12, v12, v10
    v_lshlrev_b32 v12, 4, v12
    v_lshl_add_u32 v12, v2, 8, v12
    v_add_u32 v112, s58, v12
    v_add_u32 v12, 2, v3
    v_xor_b32 v12, v12, v10
    v_lshlrev_b32 v12, 4, v12
    v_lshl_add_u32 v12, v2, 8, v12
    v_add_u32 v113, s58, v12
    v_add_u32 v12, 4, v3
    v_xor_b32 v12, v12, v10
    v_lshlrev_b32 v12, 4, v12
    v_lshl_add_u32 v12, v2, 8, v12
    v_add_u32 v114, s58, v12
    v_add_u32 v12, 6, v3
    v_xor_b32 v12, v12, v10
    v_lshlrev_b32 v12, 4, v12
    v_lshl_add_u32 v12, v2, 8, v12
    v_add_u32 v115, s58, v12
    v_add_u32 v12, 8, v3
    v_xor_b32 v12, v12, v10
    v_lshlrev_b32 v12, 4, v12
    v_lshl_add_u32 v12, v2, 8, v12
    v_add_u32 v116, s58, v12
    v_add_u32 v12, 10, v3
    v_xor_b32 v12, v12, v10
    v_lshlrev_b32 v12, 4, v12
    v_lshl_add_u32 v12, v2, 8, v12
    v_add_u32 v117, s58, v12
    v_add_u32 v12, 12, v3
    v_xor_b32 v12, v12, v10
    v_lshlrev_b32 v12, 4, v12
    v_lshl_add_u32 v12, v2, 8, v12
    v_add_u32 v118, s58, v12
    v_add_u32 v12, 14, v3
    v_xor_b32 v12, v12, v10
    v_lshlrev_b32 v12, 4, v12
    v_lshl_add_u32 v12, v2, 8, v12
    v_add_u32 v119, s58, v12
    s_add_u32 m0, s57, 0
    s_add_u32 s3, s56, 0
    buffer_load_dwordx4 v120, s[12:15], s3 offen lds
    s_add_u32 m0, s57, 1024
    s_add_u32 s3, s56, 12288
    buffer_load_dwordx4 v120, s[12:15], s3 offen lds
    s_add_u32 m0, s57, 2048
    s_add_u32 s3, s56, 24576
    buffer_load_dwordx4 v120, s[12:15], s3 offen lds
    s_add_u32 m0, s57, 3072
    s_add_u32 s3, s56, 36864
    buffer_load_dwordx4 v120, s[12:15], s3 offen lds
    s_add_u32 m0, s57, 4096
    s_add_u32 s3, s56, 49152
    buffer_load_dwordx4 v120, s[12:15], s3 offen lds
    s_add_u32 m0, s57, 5120
    s_add_u32 s3, s56, 61440
    buffer_load_dwordx4 v120, s[12:15], s3 offen lds
    s_add_u32 m0, s57, 6144
    s_add_u32 s3, s56, 73728
    buffer_load_dwordx4 v120, s[12:15], s3 offen lds
    s_add_u32 m0, s57, 7168
    s_add_u32 s3, s56, 86016
    buffer_load_dwordx4 v120, s[12:15], s3 offen lds
    v_lshlrev_b32 v16, 5, v0
    s_mov_b32 s60, 262144
    v_mov_b32 v125, 0x3f803f80
    v_mov_b32 v121, 0
    v_mov_b32 v122, 0
    v_mov_b32 v123, 0
    v_mov_b32 v124, 0
    s_waitcnt vmcnt(16)
    v_readfirstlane_b32 s7, v6
    ds_write_b128 v108, v[128:131] offset:0
    ds_write_b128 v109, v[132:135] offset:1024
    ds_write_b128 v110, v[136:139] offset:2048
    ds_write_b128 v111, v[140:143] offset:3072
    ds_write_b128 v108, v[144:147] offset:4096
    ds_write_b128 v109, v[148:151] offset:5120
    ds_write_b128 v110, v[152:155] offset:6144
    ds_write_b128 v111, v[156:159] offset:7168
    s_waitcnt lgkmcnt(0)
    ds_read_b128 v[128:131], v112
    ds_read_b128 v[132:135], v113
    ds_read_b128 v[136:139], v114
    ds_read_b128 v[140:143], v115
    ds_read_b128 v[144:147], v116
    ds_read_b128 v[148:151], v117
    ds_read_b128 v[152:155], v118
    ds_read_b128 v[156:159], v119
    s_mul_i32 s7, s7, 1664525
    s_add_u32 s7, s7, 1013904223
    s_waitcnt lgkmcnt(0)
    v_dot2_f32_bf16 v121, v128, v125, v121
    v_dot2_f32_bf16 v123, v128, v128, v123
    v_dot2_f32_bf16 v122, v129, v125, v122
    v_dot2_f32_bf16 v124, v129, v129, v124
    s_add_u32 s3, s55, 0
    buffer_load_dwordx4 v[192:195], v126, s[8:11], s3 offen offset:512
    v_dot2_f32_bf16 v121, v130, v125, v121
    v_dot2_f32_bf16 v123, v130, v130, v123
    v_dot2_f32_bf16 v122, v131, v125, v122
    v_dot2_f32_bf16 v124, v131, v131, v124
    v_dot2_f32_bf16 v121, v132, v125, v121
    v_dot2_f32_bf16 v123, v132, v132, v123
    v_dot2_f32_bf16 v122, v133, v125, v122
    v_dot2_f32_bf16 v124, v133, v133, v124
    s_add_u32 s3, s55, 4096
    buffer_load_dwordx4 v[196:199], v126, s[8:11], s3 offen offset:512
    v_dot2_f32_bf16 v121, v134, v125, v121
    v_dot2_f32_bf16 v123, v134, v134, v123
    v_dot2_f32_bf16 v122, v135, v125, v122
    v_dot2_f32_bf16 v124, v135, v135, v124
    v_dot2_f32_bf16 v121, v136, v125, v121
    v_dot2_f32_bf16 v123, v136, v136, v123
    v_dot2_f32_bf16 v122, v137, v125, v122
    v_dot2_f32_bf16 v124, v137, v137, v124
    s_add_u32 s3, s55, 8192
    buffer_load_dwordx4 v[200:203], v126, s[8:11], s3 offen offset:512
    v_dot2_f32_bf16 v121, v138, v125, v121
    v_dot2_f32_bf16 v123, v138, v138, v123
    v_dot2_f32_bf16 v122, v139, v125, v122
    v_dot2_f32_bf16 v124, v139, v139, v124
    v_dot2_f32_bf16 v121, v140, v125, v121
    v_dot2_f32_bf16 v123, v140, v140, v123
    v_dot2_f32_bf16 v122, v141, v125, v122
    v_dot2_f32_bf16 v124, v141, v141, v124
    s_add_u32 s3, s55, 12288
    buffer_load_dwordx4 v[204:207], v126, s[8:11], s3 offen offset:512
    v_dot2_f32_bf16 v121, v142, v125, v121
    v_dot2_f32_bf16 v123, v142, v142, v123
    v_dot2_f32_bf16 v122, v143, v125, v122
    v_dot2_f32_bf16 v124, v143, v143, v124
    v_dot2_f32_bf16 v121, v144, v125, v121
    v_dot2_f32_bf16 v123, v144, v144, v123
    v_dot2_f32_bf16 v122, v145, v125, v122
    v_dot2_f32_bf16 v124, v145, v145, v124
    s_add_u32 s3, s55, 16384
    buffer_load_dwordx4 v[208:211], v126, s[8:11], s3 offen offset:512
    v_dot2_f32_bf16 v121, v146, v125, v121
    v_dot2_f32_bf16 v123, v146, v146, v123
    v_dot2_f32_bf16 v122, v147, v125, v122
    v_dot2_f32_bf16 v124, v147, v147, v124
    v_dot2_f32_bf16 v121, v148, v125, v121
    v_dot2_f32_bf16 v123, v148, v148, v123
    v_dot2_f32_bf16 v122, v149, v125, v122
    v_dot2_f32_bf16 v124, v149, v149, v124
    s_add_u32 s3, s55, 20480
    buffer_load_dwordx4 v[212:215], v126, s[8:11], s3 offen offset:512
    v_dot2_f32_bf16 v121, v150, v125, v121
    v_dot2_f32_bf16 v123, v150, v150, v123
    v_dot2_f32_bf16 v122, v151, v125, v122
    v_dot2_f32_bf16 v124, v151, v151, v124
    v_dot2_f32_bf16 v121, v152, v125, v121
    v_dot2_f32_bf16 v123, v152, v152, v123
    v_dot2_f32_bf16 v122, v153, v125, v122
    v_dot2_f32_bf16 v124, v153, v153, v124
    s_add_u32 s3, s55, 24576
    buffer_load_dwordx4 v[216:219], v126, s[8:11], s3 offen offset:512
    v_dot2_f32_bf16 v121, v154, v125, v121
    v_dot2_f32_bf16 v123, v154, v154, v123
    v_dot2_f32_bf16 v122, v155, v125, v122
    v_dot2_f32_bf16 v124, v155, v155, v124
    v_dot2_f32_bf16 v121, v156, v125, v121
    v_dot2_f32_bf16 v123, v156, v156, v123
    v_dot2_f32_bf16 v122, v157, v125, v122
    v_dot2_f32_bf16 v124, v157, v157, v124
    s_add_u32 s3, s55, 28672
    buffer_load_dwordx4 v[220:223], v126, s[8:11], s3 offen offset:512
    v_dot2_f32_bf16 v121, v158, v125, v121
    v_dot2_f32_bf16 v123, v158, v158, v123
    v_dot2_f32_bf16 v122, v159, v125, v122
    v_dot2_f32_bf16 v124, v159, v159, v124
    s_waitcnt vmcnt(16)
    ds_write_b128 v108, v[160:163] offset:0
    ds_write_b128 v109, v[164:167] offset:1024
    ds_write_b128 v110, v[168:171] offset:2048
    ds_write_b128 v111, v[172:175] offset:3072
    ds_write_b128 v108, v[176:179] offset:4096
    ds_write_b128 v109, v[180:183] offset:5120
    ds_write_b128 v110, v[184:187] offset:6144
    ds_write_b128 v111, v[188:191] offset:7168
    s_waitcnt lgkmcnt(0)
    ds_read_b128 v[160:163], v112
    ds_read_b128 v[164:167], v113
    ds_read_b128 v[168:171], v114
    ds_read_b128 v[172:175], v115
    ds_read_b128 v[176:179], v116
    ds_read_b128 v[180:183], v117
    ds_read_b128 v[184:187], v118
    ds_read_b128 v[188:191], v119
    s_waitcnt lgkmcnt(0)
    v_dot2_f32_bf16 v121, v160, v125, v121
    v_dot2_f32_bf16 v123, v160, v160, v123
    v_dot2_f32_bf16 v122, v161, v125, v122
    v_dot2_f32_bf16 v124, v161, v161, v124
    s_add_u32 s3, s55, 0
    buffer_load_dwordx4 v[224:227], v126, s[8:11], s3 offen offset:768
    v_dot2_f32_bf16 v121, v162, v125, v121
    v_dot2_f32_bf16 v123, v162, v162, v123
    v_dot2_f32_bf16 v122, v163, v125, v122
    v_dot2_f32_bf16 v124, v163, v163, v124
    v_dot2_f32_bf16 v121, v164, v125, v121
    v_dot2_f32_bf16 v123, v164, v164, v123
    v_dot2_f32_bf16 v122, v165, v125, v122
    v_dot2_f32_bf16 v124, v165, v165, v124
    s_add_u32 s3, s55, 4096
    buffer_load_dwordx4 v[228:231], v126, s[8:11], s3 offen offset:768
    v_dot2_f32_bf16 v121, v166, v125, v121
    v_dot2_f32_bf16 v123, v166, v166, v123
    v_dot2_f32_bf16 v122, v167, v125, v122
    v_dot2_f32_bf16 v124, v167, v167, v124
    v_dot2_f32_bf16 v121, v168, v125, v121
    v_dot2_f32_bf16 v123, v168, v168, v123
    v_dot2_f32_bf16 v122, v169, v125, v122
    v_dot2_f32_bf16 v124, v169, v169, v124
    s_add_u32 s3, s55, 8192
    buffer_load_dwordx4 v[232:235], v126, s[8:11], s3 offen offset:768
    v_dot2_f32_bf16 v121, v170, v125, v121
    v_dot2_f32_bf16 v123, v170, v170, v123
    v_dot2_f32_bf16 v122, v171, v125, v122
    v_dot2_f32_bf16 v124, v171, v171, v124
    v_dot2_f32_bf16 v121, v172, v125, v121
    v_dot2_f32_bf16 v123, v172, v172, v123
    v_dot2_f32_bf16 v122, v173, v125, v122
    v_dot2_f32_bf16 v124, v173, v173, v124
    s_add_u32 s3, s55, 12288
    buffer_load_dwordx4 v[236:239], v126, s[8:11], s3 offen offset:768
    v_dot2_f32_bf16 v121, v174, v125, v121
    v_dot2_f32_bf16 v123, v174, v174, v123
    v_dot2_f32_bf16 v122, v175, v125, v122
    v_dot2_f32_bf16 v124, v175, v175, v124
    v_dot2_f32_bf16 v121, v176, v125, v121
    v_dot2_f32_bf16 v123, v176, v176, v123
    v_dot2_f32_bf16 v122, v177, v125, v122
    v_dot2_f32_bf16 v124, v177, v177, v124
    s_add_u32 s3, s55, 16384
    buffer_load_dwordx4 v[240:243], v126, s[8:11], s3 offen offset:768
    v_dot2_f32_bf16 v121, v178, v125, v121
    v_dot2_f32_bf16 v123, v178, v178, v123
    v_dot2_f32_bf16 v122, v179, v125, v122
    v_dot2_f32_bf16 v124, v179, v179, v124
    v_dot2_f32_bf16 v121, v180, v125, v121
    v_dot2_f32_bf16 v123, v180, v180, v123
    v_dot2_f32_bf16 v122, v181, v125, v122
    v_dot2_f32_bf16 v124, v181, v181, v124
    s_add_u32 s3, s55, 20480
    buffer_load_dwordx4 v[244:247], v126, s[8:11], s3 offen offset:768
    v_dot2_f32_bf16 v121, v182, v125, v121
    v_dot2_f32_bf16 v123, v182, v182, v123
    v_dot2_f32_bf16 v122, v183, v125, v122
    v_dot2_f32_bf16 v124, v183, v183, v124
    v_dot2_f32_bf16 v121, v184, v125, v121
    v_dot2_f32_bf16 v123, v184, v184, v123
    v_dot2_f32_bf16 v122, v185, v125, v122
    v_dot2_f32_bf16 v124, v185, v185, v124
    s_add_u32 s3, s55, 24576
    buffer_load_dwordx4 v[248:251], v126, s[8:11], s3 offen offset:768
    v_dot2_f32_bf16 v121, v186, v125, v121
    v_dot2_f32_bf16 v123, v186, v186, v123
    v_dot2_f32_bf16 v122, v187, v125, v122
    v_dot2_f32_bf16 v124, v187, v187, v124
    v_dot2_f32_bf16 v121, v188, v125, v121
    v_dot2_f32_bf16 v123, v188, v188, v123
    v_dot2_f32_bf16 v122, v189, v125, v122
    v_dot2_f32_bf16 v124, v189, v189, v124
    s_add_u32 s3, s55, 28672
    buffer_load_dwordx4 v[252:255], v126, s[8:11], s3 offen offset:768
    v_dot2_f32_bf16 v121, v190, v125, v121
    v_dot2_f32_bf16 v123, v190, v190, v123
    v_dot2_f32_bf16 v122, v191, v125, v122
    v_dot2_f32_bf16 v124, v191, v191, v124
    s_waitcnt vmcnt(8)
    ds_write_b128 v108, v[192:195] offset:0
    ds_write_b128 v109, v[196:199] offset:1024
    ds_write_b128 v110, v[200:203] offset:2048
    ds_write_b128 v111, v[204:207] offset:3072
    ds_write_b128 v108, v[208:211] offset:4096
    ds_write_b128 v109, v[212:215] offset:5120
    ds_write_b128 v110, v[216:219] offset:6144
    ds_write_b128 v111, v[220:223] offset:7168
    s_waitcnt lgkmcnt(0)
    ds_read_b128 v[192:195], v112
    ds_read_b128 v[196:199], v113
    ds_read_b128 v[200:203], v114
    ds_read_b128 v[204:207], v115
    ds_read_b128 v[208:211], v116
    ds_read_b128 v[212:215], v117
    ds_read_b128 v[216:219], v118
    ds_read_b128 v[220:223], v119
    s_waitcnt lgkmcnt(0)
    v_dot2_f32_bf16 v121, v192, v125, v121
    v_dot2_f32_bf16 v123, v192, v192, v123
    v_dot2_f32_bf16 v122, v193, v125, v122
    v_dot2_f32_bf16 v124, v193, v193, v124
    s_add_u32 m0, s57, 32768
    s_add_u32 s3, s56, 393216
    buffer_load_dwordx4 v120, s[12:15], s3 offen lds
    v_dot2_f32_bf16 v121, v194, v125, v121
    v_dot2_f32_bf16 v123, v194, v194, v123
    v_dot2_f32_bf16 v122, v195, v125, v122
    v_dot2_f32_bf16 v124, v195, v195, v124
    v_dot2_f32_bf16 v121, v196, v125, v121
    v_dot2_f32_bf16 v123, v196, v196, v123
    v_dot2_f32_bf16 v122, v197, v125, v122
    v_dot2_f32_bf16 v124, v197, v197, v124
    s_add_u32 m0, s57, 33792
    s_add_u32 s3, s56, 405504
    buffer_load_dwordx4 v120, s[12:15], s3 offen lds
    v_dot2_f32_bf16 v121, v198, v125, v121
    v_dot2_f32_bf16 v123, v198, v198, v123
    v_dot2_f32_bf16 v122, v199, v125, v122
    v_dot2_f32_bf16 v124, v199, v199, v124
    v_dot2_f32_bf16 v121, v200, v125, v121
    v_dot2_f32_bf16 v123, v200, v200, v123
    v_dot2_f32_bf16 v122, v201, v125, v122
    v_dot2_f32_bf16 v124, v201, v201, v124
    s_add_u32 m0, s57, 34816
    s_add_u32 s3, s56, 417792
    buffer_load_dwordx4 v120, s[12:15], s3 offen lds
    v_dot2_f32_bf16 v121, v202, v125, v121
    v_dot2_f32_bf16 v123, v202, v202, v123
    v_dot2_f32_bf16 v122, v203, v125, v122
    v_dot2_f32_bf16 v124, v203, v203, v124
    v_dot2_f32_bf16 v121, v204, v125, v121
    v_dot2_f32_bf16 v123, v204, v204, v123
    v_dot2_f32_bf16 v122, v205, v125, v122
    v_dot2_f32_bf16 v124, v205, v205, v124
    s_add_u32 m0, s57, 35840
    s_add_u32 s3, s56, 430080
    buffer_load_dwordx4 v120, s[12:15], s3 offen lds
    v_dot2_f32_bf16 v121, v206, v125, v121
    v_dot2_f32_bf16 v123, v206, v206, v123
    v_dot2_f32_bf16 v122, v207, v125, v122
    v_dot2_f32_bf16 v124, v207, v207, v124
    v_dot2_f32_bf16 v121, v208, v125, v121
    v_dot2_f32_bf16 v123, v208, v208, v123
    v_dot2_f32_bf16 v122, v209, v125, v122
    v_dot2_f32_bf16 v124, v209, v209, v124
    s_add_u32 m0, s57, 36864
    s_add_u32 s3, s56, 442368
    buffer_load_dwordx4 v120, s[12:15], s3 offen lds
    v_dot2_f32_bf16 v121, v210, v125, v121
    v_dot2_f32_bf16 v123, v210, v210, v123
    v_dot2_f32_bf16 v122, v211, v125, v122
    v_dot2_f32_bf16 v124, v211, v211, v124
    v_dot2_f32_bf16 v121, v212, v125, v121
    v_dot2_f32_bf16 v123, v212, v212, v123
    v_dot2_f32_bf16 v122, v213, v125, v122
    v_dot2_f32_bf16 v124, v213, v213, v124
    s_add_u32 m0, s57, 37888
    s_add_u32 s3, s56, 454656
    buffer_load_dwordx4 v120, s[12:15], s3 offen lds
    v_dot2_f32_bf16 v121, v214, v125, v121
    v_dot2_f32_bf16 v123, v214, v214, v123
    v_dot2_f32_bf16 v122, v215, v125, v122
    v_dot2_f32_bf16 v124, v215, v215, v124
    v_dot2_f32_bf16 v121, v216, v125, v121
    v_dot2_f32_bf16 v123, v216, v216, v123
    v_dot2_f32_bf16 v122, v217, v125, v122
    v_dot2_f32_bf16 v124, v217, v217, v124
    s_add_u32 m0, s57, 38912
    s_add_u32 s3, s56, 466944
    buffer_load_dwordx4 v120, s[12:15], s3 offen lds
    v_dot2_f32_bf16 v121, v218, v125, v121
    v_dot2_f32_bf16 v123, v218, v218, v123
    v_dot2_f32_bf16 v122, v219, v125, v122
    v_dot2_f32_bf16 v124, v219, v219, v124
    v_dot2_f32_bf16 v121, v220, v125, v121
    v_dot2_f32_bf16 v123, v220, v220, v123
    v_dot2_f32_bf16 v122, v221, v125, v122
    v_dot2_f32_bf16 v124, v221, v221, v124
    s_add_u32 m0, s57, 39936
    s_add_u32 s3, s56, 479232
    buffer_load_dwordx4 v120, s[12:15], s3 offen lds
    v_dot2_f32_bf16 v121, v222, v125, v121
    v_dot2_f32_bf16 v123, v222, v222, v123
    v_dot2_f32_bf16 v122, v223, v125, v122
    v_dot2_f32_bf16 v124, v223, v223, v124
    buffer_load_dwordx4 v[24:27], v16, s[48:51], s60 offen sc0 sc1
    buffer_load_dwordx4 v[28:31], v16, s[48:51], s60 offen offset:16 sc0 sc1
    s_waitcnt vmcnt(10)
    ds_write_b128 v108, v[224:227] offset:0
    ds_write_b128 v109, v[228:231] offset:1024
    ds_write_b128 v110, v[232:235] offset:2048
    ds_write_b128 v111, v[236:239] offset:3072
    ds_write_b128 v108, v[240:243] offset:4096
    ds_write_b128 v109, v[244:247] offset:5120
    ds_write_b128 v110, v[248:251] offset:6144
    ds_write_b128 v111, v[252:255] offset:7168
    s_waitcnt lgkmcnt(0)
    ds_read_b128 v[224:227], v112
    ds_read_b128 v[228:231], v113
    ds_read_b128 v[232:235], v114
    ds_read_b128 v[236:239], v115
    ds_read_b128 v[240:243], v116
    ds_read_b128 v[244:247], v117
    ds_read_b128 v[248:251], v118
    ds_read_b128 v[252:255], v119
    s_waitcnt lgkmcnt(0)
    v_dot2_f32_bf16 v121, v224, v125, v121
    v_dot2_f32_bf16 v123, v224, v224, v123
    v_dot2_f32_bf16 v122, v225, v125, v122
    v_dot2_f32_bf16 v124, v225, v225, v124
    s_add_u32 m0, s57, 65536
    s_add_u32 s3, s56, 786432
    buffer_load_dwordx4 v120, s[12:15], s3 offen lds
    v_dot2_f32_bf16 v121, v226, v125, v121
    v_dot2_f32_bf16 v123, v226, v226, v123
    v_dot2_f32_bf16 v122, v227, v125, v122
    v_dot2_f32_bf16 v124, v227, v227, v124
    v_dot2_f32_bf16 v121, v228, v125, v121
    v_dot2_f32_bf16 v123, v228, v228, v123
    v_dot2_f32_bf16 v122, v229, v125, v122
    v_dot2_f32_bf16 v124, v229, v229, v124
    s_add_u32 m0, s57, 66560
    s_add_u32 s3, s56, 798720
    buffer_load_dwordx4 v120, s[12:15], s3 offen lds
    v_dot2_f32_bf16 v121, v230, v125, v121
    v_dot2_f32_bf16 v123, v230, v230, v123
    v_dot2_f32_bf16 v122, v231, v125, v122
    v_dot2_f32_bf16 v124, v231, v231, v124
    v_dot2_f32_bf16 v121, v232, v125, v121
    v_dot2_f32_bf16 v123, v232, v232, v123
    v_dot2_f32_bf16 v122, v233, v125, v122
    v_dot2_f32_bf16 v124, v233, v233, v124
    s_add_u32 m0, s57, 67584
    s_add_u32 s3, s56, 811008
    buffer_load_dwordx4 v120, s[12:15], s3 offen lds
    v_dot2_f32_bf16 v121, v234, v125, v121
    v_dot2_f32_bf16 v123, v234, v234, v123
    v_dot2_f32_bf16 v122, v235, v125, v122
    v_dot2_f32_bf16 v124, v235, v235, v124
    v_dot2_f32_bf16 v121, v236, v125, v121
    v_dot2_f32_bf16 v123, v236, v236, v123
    v_dot2_f32_bf16 v122, v237, v125, v122
    v_dot2_f32_bf16 v124, v237, v237, v124
    s_add_u32 m0, s57, 68608
    s_add_u32 s3, s56, 823296
    buffer_load_dwordx4 v120, s[12:15], s3 offen lds
    v_dot2_f32_bf16 v121, v238, v125, v121
    v_dot2_f32_bf16 v123, v238, v238, v123
    v_dot2_f32_bf16 v122, v239, v125, v122
    v_dot2_f32_bf16 v124, v239, v239, v124
    v_dot2_f32_bf16 v121, v240, v125, v121
    v_dot2_f32_bf16 v123, v240, v240, v123
    v_dot2_f32_bf16 v122, v241, v125, v122
    v_dot2_f32_bf16 v124, v241, v241, v124
    s_add_u32 m0, s57, 69632
    s_add_u32 s3, s56, 835584
    buffer_load_dwordx4 v120, s[12:15], s3 offen lds
    v_dot2_f32_bf16 v121, v242, v125, v121
    v_dot2_f32_bf16 v123, v242, v242, v123
    v_dot2_f32_bf16 v122, v243, v125, v122
    v_dot2_f32_bf16 v124, v243, v243, v124
    v_dot2_f32_bf16 v121, v244, v125, v121
    v_dot2_f32_bf16 v123, v244, v244, v123
    v_dot2_f32_bf16 v122, v245, v125, v122
    v_dot2_f32_bf16 v124, v245, v245, v124
    s_add_u32 m0, s57, 70656
    s_add_u32 s3, s56, 847872
    buffer_load_dwordx4 v120, s[12:15], s3 offen lds
    v_dot2_f32_bf16 v121, v246, v125, v121
    v_dot2_f32_bf16 v123, v246, v246, v123
    v_dot2_f32_bf16 v122, v247, v125, v122
    v_dot2_f32_bf16 v124, v247, v247, v124
    v_dot2_f32_bf16 v121, v248, v125, v121
    v_dot2_f32_bf16 v123, v248, v248, v123
    v_dot2_f32_bf16 v122, v249, v125, v122
    v_dot2_f32_bf16 v124, v249, v249, v124
    s_add_u32 m0, s57, 71680
    s_add_u32 s3, s56, 860160
    buffer_load_dwordx4 v120, s[12:15], s3 offen lds
    v_dot2_f32_bf16 v121, v250, v125, v121
    v_dot2_f32_bf16 v123, v250, v250, v123
    v_dot2_f32_bf16 v122, v251, v125, v122
    v_dot2_f32_bf16 v124, v251, v251, v124
    v_dot2_f32_bf16 v121, v252, v125, v121
    v_dot2_f32_bf16 v123, v252, v252, v123
    v_dot2_f32_bf16 v122, v253, v125, v122
    v_dot2_f32_bf16 v124, v253, v253, v124
    s_add_u32 m0, s57, 72704
    s_add_u32 s3, s56, 872448
    buffer_load_dwordx4 v120, s[12:15], s3 offen lds
    v_dot2_f32_bf16 v121, v254, v125, v121
    v_dot2_f32_bf16 v123, v254, v254, v123
    v_dot2_f32_bf16 v122, v255, v125, v122
    v_dot2_f32_bf16 v124, v255, v255, v124
    s_nop 1
    v_add_f32 v20, v121, v122
    v_add_f32 v22, v123, v124
    v_mov_b32 v21, v20
    v_mov_b32 v23, v22
    s_nop 1
    v_permlane32_swap_b32 v20, v21
    v_permlane32_swap_b32 v22, v23
    v_add_f32 v20, v20, v21
    v_add_f32 v22, v22, v23
    v_mul_f32 v20, 0x3b000000, v20
    v_mul_f32 v22, 0x3b000000, v22
    v_fma_f32 v22, -v20, v20, v22
    v_max_f32 v22, 0, v22
    v_add_f32 v22, 0x3727c5ac, v22
    v_rsq_f32 v4, v22
    s_nop 0
    v_mul_f32 v5, v20, v4
    v_sub_f32 v5, 0, v5
    v_bfe_u32 v12, v1, 2, 2
    v_lshl_add_u32 v13, v3, 3, v12
    v_lshlrev_b32 v13, 8, v13
    v_bfe_u32 v14, v1, 4, 1
    v_lshl_add_u32 v13, v14, 5, v13
    v_and_b32 v14, 3, v1
    v_lshl_add_u32 v13, v14, 3, v13
    s_add_u32 s3, s6, 0
    s_and_b32 s62, s3, 3
    v_xor_b32 v14, s62, v12
    v_lshl_add_u32 v8, v14, 6, v13
    s_add_u32 s3, s6, 1
    s_and_b32 s63, s3, 3
    v_xor_b32 v14, s63, v12
    v_lshl_add_u32 v9, v14, 6, v13
    s_add_u32 s3, s6, 2
    s_and_b32 s64, s3, 3
    v_xor_b32 v14, s64, v12
    v_lshl_add_u32 v10, v14, 6, v13
    s_add_u32 s3, s6, 3
    s_and_b32 s65, s3, 3
    v_xor_b32 v14, s65, v12
    v_lshl_add_u32 v11, v14, 6, v13
    s_mov_b32 s52, 262144
    s_waitcnt vmcnt(8)
    s_branch PG_11
PG_9:
    buffer_load_dwordx4 v[24:27], v16, s[48:51], s60 offen sc0 sc1
    buffer_load_dwordx4 v[28:31], v16, s[48:51], s60 offen offset:16 sc0 sc1
    s_waitcnt vmcnt(0)
PG_11:
    v_xor_b32 v32, s7, v25
    v_xor_b32 v33, s7, v27
    v_xor_b32 v34, s7, v29
    v_xor_b32 v35, s7, v31
    v_or3_b32 v32, v32, v33, v34
    v_or_b32 v32, v32, v35
    v_cmp_ne_u32 vcc, 0, v32
    s_cbranch_vccz PG_10
    s_sub_u32 s52, s52, 1
    s_cmp_lg_u32 s52, 0
    s_cbranch_scc1 PG_9
PG_10:
    s_cmp_ge_u32 s6, 2
    s_cselect_b32 s3, 1.0, 0
    v_add_f32 v24, s3, v24
    v_add_f32 v25, s3, v26
    v_add_f32 v26, s3, v28
    v_add_f32 v27, s3, v30
    v_cvt_pk_bf16_f32 v28, v24, v25
    v_cvt_pk_bf16_f32 v29, v26, v27
    v_lshlrev_b32 v16, 4, v0
    v_add_u32 v16, 2048, v16
    v_and_b32 v16, 4095, v16
    v_lshrrev_b32 v17, 1, v16
    v_add_u32 v16, 131072, v16
    v_add_u32 v17, 135168, v17
    v_lshlrev_b32 v24, 16, v28
    v_and_b32 v25, 0xffff0000, v28
    v_lshlrev_b32 v26, 16, v29
    v_and_b32 v27, 0xffff0000, v29
    s_barrier
    ds_write_b128 v16, v[24:27]
    ds_write_b64 v17, v[28:29]
    v_bfe_u32 v16, v1, 3, 1
    v_lshlrev_b32 v16, 6, v16
    v_lshl_add_u32 v16, v3, 5, v16
    v_and_b32 v17, 7, v1
    v_lshl_add_u32 v16, v17, 2, v16
    v_add_u32 v16, 131072, v16
    v_and_b32 v7, 1, v1
    v_lshlrev_b32 v7, 10, v7
    v_lshl_add_u32 v7, v3, 4, v7
    v_add_u32 v7, 135168, v7
    s_waitcnt lgkmcnt(0)
    s_barrier
    ds_read_b32 v28, v16 offset:0
    ds_read_b32 v29, v16 offset:128
    ds_read_b32 v30, v16 offset:256
    ds_read_b32 v31, v16 offset:384
    ds_read_b32 v32, v16 offset:512
    ds_read_b32 v33, v16 offset:640
    ds_read_b32 v34, v16 offset:768
    ds_read_b32 v35, v16 offset:896
    ds_read_b32 v36, v16 offset:1024
    ds_read_b32 v37, v16 offset:1152
    ds_read_b32 v38, v16 offset:1280
    ds_read_b32 v39, v16 offset:1408
    ds_read_b32 v40, v16 offset:1536
    ds_read_b32 v41, v16 offset:1664
    ds_read_b32 v42, v16 offset:1792
    ds_read_b32 v43, v16 offset:1920
    ds_read_b128 a[128:131], v7 offset:0
    ds_read_b128 a[132:135], v7 offset:32
    ds_read_b128 a[136:139], v7 offset:64
    ds_read_b128 a[140:143], v7 offset:96
    ds_read_b128 a[144:147], v7 offset:128
    ds_read_b128 a[148:151], v7 offset:160
    ds_read_b128 a[152:155], v7 offset:192
    ds_read_b128 a[156:159], v7 offset:224
    ds_read_b128 a[160:163], v7 offset:256
    ds_read_b128 a[164:167], v7 offset:288
    ds_read_b128 a[168:171], v7 offset:320
    ds_read_b128 a[172:175], v7 offset:352
    ds_read_b128 a[176:179], v7 offset:384
    ds_read_b128 a[180:183], v7 offset:416
    ds_read_b128 a[184:187], v7 offset:448
    ds_read_b128 a[188:191], v7 offset:480
    ds_read_b128 a[192:195], v7 offset:512
    ds_read_b128 a[196:199], v7 offset:544
    ds_read_b128 a[200:203], v7 offset:576
    ds_read_b128 a[204:207], v7 offset:608
    ds_read_b128 a[208:211], v7 offset:640
    ds_read_b128 a[212:215], v7 offset:672
    ds_read_b128 a[216:219], v7 offset:704
    ds_read_b128 a[220:223], v7 offset:736
    ds_read_b128 a[224:227], v7 offset:768
    ds_read_b128 a[228:231], v7 offset:800
    ds_read_b128 a[232:235], v7 offset:832
    ds_read_b128 a[236:239], v7 offset:864
    ds_read_b128 a[240:243], v7 offset:896
    ds_read_b128 a[244:247], v7 offset:928
    ds_read_b128 a[248:251], v7 offset:960
    ds_read_b128 a[252:255], v7 offset:992
    s_cmp_ge_u32 s54, 8
    s_cbranch_scc1 P1V
    ds_read_b64_tr_b16 v[60:61], v8 offset:0
    ds_read_b64_tr_b16 v[62:63], v8 offset:1024
    ds_read_b64_tr_b16 v[64:65], v9 offset:0
    ds_read_b64_tr_b16 v[66:67], v9 offset:1024
    ds_read_b64_tr_b16 v[68:69], v10 offset:0
    ds_read_b64_tr_b16 v[70:71], v10 offset:1024
    ds_read_b64_tr_b16 v[72:73], v11 offset:0
    ds_read_b64_tr_b16 v[74:75], v11 offset:1024
    ds_read_b64_tr_b16 v[76:77], v8 offset:4096
    ds_read_b64_tr_b16 v[78:79], v8 offset:5120
    ds_read_b64_tr_b16 v[80:81], v9 offset:4096
    ds_read_b64_tr_b16 v[82:83], v9 offset:5120
    ds_read_b64_tr_b16 v[84:85], v10 offset:4096
    ds_read_b64_tr_b16 v[86:87], v10 offset:5120
    ds_read_b64_tr_b16 v[88:89], v11 offset:4096
    ds_read_b64_tr_b16 v[90:91], v11 offset:5120
    v_lshlrev_b32 v20, 16, v128
    v_and_b32 v21, 0xffff0000, v128
    v_lshlrev_b32 v22, 16, v129
    v_and_b32 v23, 0xffff0000, v129
    v_lshlrev_b32 v24, 16, v130
    v_and_b32 v25, 0xffff0000, v130
    v_lshlrev_b32 v26, 16, v131
    v_and_b32 v27, 0xffff0000, v131
    s_waitcnt lgkmcnt(15)
    v_mul_f32_dpp v20, v28, v20 row_newbcast:0 row_mask:0xf bank_mask:0xf
    v_mul_f32_dpp v21, v28, v21 row_newbcast:1 row_mask:0xf bank_mask:0xf
    v_mul_f32_dpp v22, v28, v22 row_newbcast:2 row_mask:0xf bank_mask:0xf
    v_mul_f32_dpp v23, v28, v23 row_newbcast:3 row_mask:0xf bank_mask:0xf
    v_mul_f32_dpp v24, v28, v24 row_newbcast:4 row_mask:0xf bank_mask:0xf
    v_mul_f32_dpp v25, v28, v25 row_newbcast:5 row_mask:0xf bank_mask:0xf
    v_mul_f32_dpp v26, v28, v26 row_newbcast:6 row_mask:0xf bank_mask:0xf
    v_mul_f32_dpp v27, v28, v27 row_newbcast:7 row_mask:0xf bank_mask:0xf
    v_cvt_pk_bf16_f32 v12, v20, v21
    v_cvt_pk_bf16_f32 v13, v22, v23
    v_cvt_pk_bf16_f32 v14, v24, v25
    v_cvt_pk_bf16_f32 v15, v26, v27
    s_waitcnt lgkmcnt(8)
    s_nop 0
    v_mfma_f32_32x32x16_bf16 a[64:79], v[60:63], v[12:15], 0
    v_lshlrev_b32 v20, 16, v132
    v_and_b32 v21, 0xffff0000, v132
    v_lshlrev_b32 v22, 16, v133
    v_and_b32 v23, 0xffff0000, v133
    ds_read_b64_tr_b16 v[92:93], v8 offset:8192
    ds_read_b64_tr_b16 v[94:95], v8 offset:9216
    v_mfma_f32_32x32x16_bf16 a[80:95], v[64:67], v[12:15], 0
    s_add_u32 m0, s57, 98304
    s_add_u32 s3, s56, 1179648
    buffer_load_dwordx4 v120, s[12:15], s3 offen lds
    v_lshlrev_b32 v24, 16, v134
    v_and_b32 v25, 0xffff0000, v134
    v_lshlrev_b32 v26, 16, v135
    v_and_b32 v27, 0xffff0000, v135
    ds_read_b64_tr_b16 v[96:97], v9 offset:8192
    ds_read_b64_tr_b16 v[98:99], v9 offset:9216
    v_mfma_f32_32x32x16_bf16 a[96:111], v[68:71], v[12:15], 0
    v_mul_f32_dpp v20, v28, v20 row_newbcast:8 row_mask:0xf bank_mask:0xf
    v_mul_f32_dpp v21, v28, v21 row_newbcast:9 row_mask:0xf bank_mask:0xf
    v_mul_f32_dpp v22, v28, v22 row_newbcast:10 row_mask:0xf bank_mask:0xf
    v_mul_f32_dpp v23, v28, v23 row_newbcast:11 row_mask:0xf bank_mask:0xf
    ds_read_b64_tr_b16 v[100:101], v10 offset:8192
    v_mfma_f32_32x32x16_bf16 a[112:127], v[72:75], v[12:15], 0
    v_mul_f32_dpp v24, v28, v24 row_newbcast:12 row_mask:0xf bank_mask:0xf
    v_mul_f32_dpp v25, v28, v25 row_newbcast:13 row_mask:0xf bank_mask:0xf
    v_mul_f32_dpp v26, v28, v26 row_newbcast:14 row_mask:0xf bank_mask:0xf
    v_mul_f32_dpp v27, v28, v27 row_newbcast:15 row_mask:0xf bank_mask:0xf
    ds_read_b64_tr_b16 v[102:103], v10 offset:9216
    v_mfma_f32_32x32x16_bf16 v[44:59], v[60:63], a[128:131], 0
    v_cvt_pk_bf16_f32 v16, v20, v21
    v_cvt_pk_bf16_f32 v17, v22, v23
    v_cvt_pk_bf16_f32 v18, v24, v25
    v_cvt_pk_bf16_f32 v19, v26, v27
    ds_read_b64_tr_b16 v[104:105], v11 offset:8192
    ds_read_b64_tr_b16 v[106:107], v11 offset:9216
    s_waitcnt lgkmcnt(8)
    v_mfma_f32_32x32x16_bf16 a[64:79], v[76:79], v[16:19], a[64:79]
    v_lshlrev_b32 v20, 16, v136
    v_and_b32 v21, 0xffff0000, v136
    v_lshlrev_b32 v22, 16, v137
    v_and_b32 v23, 0xffff0000, v137
    ds_read_b64_tr_b16 v[60:61], v8 offset:12288
    ds_read_b64_tr_b16 v[62:63], v8 offset:13312
    v_mfma_f32_32x32x16_bf16 a[80:95], v[80:83], v[16:19], a[80:95]
    s_add_u32 m0, s57, 99328
    s_add_u32 s3, s56, 1191936
    buffer_load_dwordx4 v120, s[12:15], s3 offen lds
    v_lshlrev_b32 v24, 16, v138
    v_and_b32 v25, 0xffff0000, v138
    v_lshlrev_b32 v26, 16, v139
    v_and_b32 v27, 0xffff0000, v139
    ds_read_b64_tr_b16 v[64:65], v9 offset:12288
    ds_read_b64_tr_b16 v[66:67], v9 offset:13312
    v_mfma_f32_32x32x16_bf16 a[96:111], v[84:87], v[16:19], a[96:111]
    v_mul_f32_dpp v20, v29, v20 row_newbcast:0 row_mask:0xf bank_mask:0xf
    v_mul_f32_dpp v21, v29, v21 row_newbcast:1 row_mask:0xf bank_mask:0xf
    v_mul_f32_dpp v22, v29, v22 row_newbcast:2 row_mask:0xf bank_mask:0xf
    v_mul_f32_dpp v23, v29, v23 row_newbcast:3 row_mask:0xf bank_mask:0xf
    ds_read_b64_tr_b16 v[68:69], v10 offset:12288
    v_mfma_f32_32x32x16_bf16 a[112:127], v[88:91], v[16:19], a[112:127]
    v_mul_f32_dpp v24, v29, v24 row_newbcast:4 row_mask:0xf bank_mask:0xf
    v_mul_f32_dpp v25, v29, v25 row_newbcast:5 row_mask:0xf bank_mask:0xf
    v_mul_f32_dpp v26, v29, v26 row_newbcast:6 row_mask:0xf bank_mask:0xf
    v_mul_f32_dpp v27, v29, v27 row_newbcast:7 row_mask:0xf bank_mask:0xf
    ds_read_b64_tr_b16 v[70:71], v10 offset:13312
    v_mfma_f32_32x32x16_bf16 v[44:59], v[76:79], a[132:135], v[44:59]
    v_cvt_pk_bf16_f32 v12, v20, v21
    v_cvt_pk_bf16_f32 v13, v22, v23
    v_cvt_pk_bf16_f32 v14, v24, v25
    v_cvt_pk_bf16_f32 v15, v26, v27
    ds_read_b64_tr_b16 v[72:73], v11 offset:12288
    ds_read_b64_tr_b16 v[74:75], v11 offset:13312
    s_waitcnt lgkmcnt(8)
    v_mfma_f32_32x32x16_bf16 a[64:79], v[92:95], v[12:15], a[64:79]
    v_lshlrev_b32 v20, 16, v140
    v_and_b32 v21, 0xffff0000, v140
    v_lshlrev_b32 v22, 16, v141
    v_and_b32 v23, 0xffff0000, v141
    ds_read_b64_tr_b16 v[76:77], v8 offset:16384
    ds_read_b64_tr_b16 v[78:79], v8 offset:17408
    v_mfma_f32_32x32x16_bf16 a[80:95], v[96:99], v[12:15], a[80:95]
    s_add_u32 m0, s57, 100352
    s_add_u32 s3, s56, 1204224
    buffer_load_dwordx4 v120, s[12:15], s3 offen lds
    v_lshlrev_b32 v24, 16, v142
    v_and_b32 v25, 0xffff0000, v142
    v_lshlrev_b32 v26, 16, v143
    v_and_b32 v27, 0xffff0000, v143
    ds_read_b64_tr_b16 v[80:81], v9 offset:16384
    ds_read_b64_tr_b16 v[82:83], v9 offset:17408
    v_mfma_f32_32x32x16_bf16 a[96:111], v[100:103], v[12:15], a[96:111]
    v_mul_f32_dpp v20, v29, v20 row_newbcast:8 row_mask:0xf bank_mask:0xf
    v_mul_f32_dpp v21, v29, v21 row_newbcast:9 row_mask:0xf bank_mask:0xf
    v_mul_f32_dpp v22, v29, v22 row_newbcast:10 row_mask:0xf bank_mask:0xf
    v_mul_f32_dpp v23, v29, v23 row_newbcast:11 row_mask:0xf bank_mask:0xf
    ds_read_b64_tr_b16 v[84:85], v10 offset:16384
    v_mfma_f32_32x32x16_bf16 a[112:127], v[104:107], v[12:15], a[112:127]
    v_mul_f32_dpp v24, v29, v24 row_newbcast:12 row_mask:0xf bank_mask:0xf
    v_mul_f32_dpp v25, v29, v25 row_newbcast:13 row_mask:0xf bank_mask:0xf
    v_mul_f32_dpp v26, v29, v26 row_newbcast:14 row_mask:0xf bank_mask:0xf
    v_mul_f32_dpp v27, v29, v27 row_newbcast:15 row_mask:0xf bank_mask:0xf
    ds_read_b64_tr_b16 v[86:87], v10 offset:17408
    v_mfma_f32_32x32x16_bf16 v[44:59], v[92:95], a[136:139], v[44:59]
    v_cvt_pk_bf16_f32 v16, v20, v21
    v_cvt_pk_bf16_f32 v17, v22, v23
    v_cvt_pk_bf16_f32 v18, v24, v25
    v_cvt_pk_bf16_f32 v19, v26, v27
    ds_read_b64_tr_b16 v[88:89], v11 offset:16384
    ds_read_b64_tr_b16 v[90:91], v11 offset:17408
    s_waitcnt lgkmcnt(8)
    v_mfma_f32_32x32x16_bf16 a[64:79], v[60:63], v[16:19], a[64:79]
    v_lshlrev_b32 v20, 16, v144
    v_and_b32 v21, 0xffff0000, v144
    v_lshlrev_b32 v22, 16, v145
    v_and_b32 v23, 0xffff0000, v145
    ds_read_b64_tr_b16 v[92:93], v8 offset:20480
    ds_read_b64_tr_b16 v[94:95], v8 offset:21504
    v_mfma_f32_32x32x16_bf16 a[80:95], v[64:67], v[16:19], a[80:95]
    s_add_u32 m0, s57, 101376
    s_add_u32 s3, s56, 1216512
    buffer_load_dwordx4 v120, s[12:15], s3 offen lds
    v_lshlrev_b32 v24, 16, v146
    v_and_b32 v25, 0xffff0000, v146
    v_lshlrev_b32 v26, 16, v147
    v_and_b32 v27, 0xffff0000, v147
    ds_read_b64_tr_b16 v[96:97], v9 offset:20480
    ds_read_b64_tr_b16 v[98:99], v9 offset:21504
    v_mfma_f32_32x32x16_bf16 a[96:111], v[68:71], v[16:19], a[96:111]
    v_mul_f32_dpp v20, v30, v20 row_newbcast:0 row_mask:0xf bank_mask:0xf
    v_mul_f32_dpp v21, v30, v21 row_newbcast:1 row_mask:0xf bank_mask:0xf
    v_mul_f32_dpp v22, v30, v22 row_newbcast:2 row_mask:0xf bank_mask:0xf
    v_mul_f32_dpp v23, v30, v23 row_newbcast:3 row_mask:0xf bank_mask:0xf
    ds_read_b64_tr_b16 v[100:101], v10 offset:20480
    v_mfma_f32_32x32x16_bf16 a[112:127], v[72:75], v[16:19], a[112:127]
    v_mul_f32_dpp v24, v30, v24 row_newbcast:4 row_mask:0xf bank_mask:0xf
    v_mul_f32_dpp v25, v30, v25 row_newbcast:5 row_mask:0xf bank_mask:0xf
    v_mul_f32_dpp v26, v30, v26 row_newbcast:6 row_mask:0xf bank_mask:0xf
    v_mul_f32_dpp v27, v30, v27 row_newbcast:7 row_mask:0xf bank_mask:0xf
    ds_read_b64_tr_b16 v[102:103], v10 offset:21504
    v_mfma_f32_32x32x16_bf16 v[44:59], v[60:63], a[140:143], v[44:59]
    v_cvt_pk_bf16_f32 v12, v20, v21
    v_cvt_pk_bf16_f32 v13, v22, v23
    v_cvt_pk_bf16_f32 v14, v24, v25
    v_cvt_pk_bf16_f32 v15, v26, v27
    ds_read_b64_tr_b16 v[104:105], v11 offset:20480
    ds_read_b64_tr_b16 v[106:107], v11 offset:21504
    s_waitcnt lgkmcnt(8)
    v_mfma_f32_32x32x16_bf16 a[64:79], v[76:79], v[12:15], a[64:79]
    v_lshlrev_b32 v20, 16, v148
    v_and_b32 v21, 0xffff0000, v148
    v_lshlrev_b32 v22, 16, v149
    v_and_b32 v23, 0xffff0000, v149
    ds_read_b64_tr_b16 v[60:61], v8 offset:24576
    ds_read_b64_tr_b16 v[62:63], v8 offset:25600
    v_mfma_f32_32x32x16_bf16 a[80:95], v[80:83], v[12:15], a[80:95]
    s_add_u32 m0, s57, 102400
    s_add_u32 s3, s56, 1228800
    buffer_load_dwordx4 v120, s[12:15], s3 offen lds
    v_lshlrev_b32 v24, 16, v150
    v_and_b32 v25, 0xffff0000, v150
    v_lshlrev_b32 v26, 16, v151
    v_and_b32 v27, 0xffff0000, v151
    ds_read_b64_tr_b16 v[64:65], v9 offset:24576
    ds_read_b64_tr_b16 v[66:67], v9 offset:25600
    v_mfma_f32_32x32x16_bf16 a[96:111], v[84:87], v[12:15], a[96:111]
    v_mul_f32_dpp v20, v30, v20 row_newbcast:8 row_mask:0xf bank_mask:0xf
    v_mul_f32_dpp v21, v30, v21 row_newbcast:9 row_mask:0xf bank_mask:0xf
    v_mul_f32_dpp v22, v30, v22 row_newbcast:10 row_mask:0xf bank_mask:0xf
    v_mul_f32_dpp v23, v30, v23 row_newbcast:11 row_mask:0xf bank_mask:0xf
    ds_read_b64_tr_b16 v[68:69], v10 offset:24576
    v_mfma_f32_32x32x16_bf16 a[112:127], v[88:91], v[12:15], a[112:127]
    v_mul_f32_dpp v24, v30, v24 row_newbcast:12 row_mask:0xf bank_mask:0xf
    v_mul_f32_dpp v25, v30, v25 row_newbcast:13 row_mask:0xf bank_mask:0xf
    v_mul_f32_dpp v26, v30, v26 row_newbcast:14 row_mask:0xf bank_mask:0xf
    v_mul_f32_dpp v27, v30, v27 row_newbcast:15 row_mask:0xf bank_mask:0xf
    ds_read_b64_tr_b16 v[70:71], v10 offset:25600
    v_mfma_f32_32x32x16_bf16 v[44:59], v[76:79], a[144:147], v[44:59]
    v_cvt_pk_bf16_f32 v16, v20, v21
    v_cvt_pk_bf16_f32 v17, v22, v23
    v_cvt_pk_bf16_f32 v18, v24, v25
    v_cvt_pk_bf16_f32 v19, v26, v27
    ds_read_b64_tr_b16 v[72:73], v11 offset:24576
    ds_read_b64_tr_b16 v[74:75], v11 offset:25600
    s_waitcnt lgkmcnt(8)
    v_mfma_f32_32x32x16_bf16 a[64:79], v[92:95], v[16:19], a[64:79]
    v_lshlrev_b32 v20, 16, v152
    v_and_b32 v21, 0xffff0000, v152
    v_lshlrev_b32 v22, 16, v153
    v_and_b32 v23, 0xffff0000, v153
    ds_read_b64_tr_b16 v[76:77], v8 offset:28672
    ds_read_b64_tr_b16 v[78:79], v8 offset:29696
    v_mfma_f32_32x32x16_bf16 a[80:95], v[96:99], v[16:19], a[80:95]
    s_add_u32 m0, s57, 103424
    s_add_u32 s3, s56, 1241088
    buffer_load_dwordx4 v120, s[12:15], s3 offen lds
    v_lshlrev_b32 v24, 16, v154
    v_and_b32 v25, 0xffff0000, v154
    v_lshlrev_b32 v26, 16, v155
    v_and_b32 v27, 0xffff0000, v155
    ds_read_b64_tr_b16 v[80:81], v9 offset:28672
    ds_read_b64_tr_b16 v[82:83], v9 offset:29696
    v_mfma_f32_32x32x16_bf16 a[96:111], v[100:103], v[16:19], a[96:111]
    v_mul_f32_dpp v20, v31, v20 row_newbcast:0 row_mask:0xf bank_mask:0xf
    v_mul_f32_dpp v21, v31, v21 row_newbcast:1 row_mask:0xf bank_mask:0xf
    v_mul_f32_dpp v22, v31, v22 row_newbcast:2 row_mask:0xf bank_mask:0xf
    v_mul_f32_dpp v23, v31, v23 row_newbcast:3 row_mask:0xf bank_mask:0xf
    ds_read_b64_tr_b16 v[84:85], v10 offset:28672
    v_mfma_f32_32x32x16_bf16 a[112:127], v[104:107], v[16:19], a[112:127]
    v_mul_f32_dpp v24, v31, v24 row_newbcast:4 row_mask:0xf bank_mask:0xf
    v_mul_f32_dpp v25, v31, v25 row_newbcast:5 row_mask:0xf bank_mask:0xf
    v_mul_f32_dpp v26, v31, v26 row_newbcast:6 row_mask:0xf bank_mask:0xf
    v_mul_f32_dpp v27, v31, v27 row_newbcast:7 row_mask:0xf bank_mask:0xf
    ds_read_b64_tr_b16 v[86:87], v10 offset:29696
    v_mfma_f32_32x32x16_bf16 v[44:59], v[92:95], a[148:151], v[44:59]
    v_cvt_pk_bf16_f32 v12, v20, v21
    v_cvt_pk_bf16_f32 v13, v22, v23
    v_cvt_pk_bf16_f32 v14, v24, v25
    v_cvt_pk_bf16_f32 v15, v26, v27
    ds_read_b64_tr_b16 v[88:89], v11 offset:28672
    ds_read_b64_tr_b16 v[90:91], v11 offset:29696
    s_waitcnt lgkmcnt(8)
    v_mfma_f32_32x32x16_bf16 a[64:79], v[60:63], v[12:15], a[64:79]
    v_lshlrev_b32 v20, 16, v156
    v_and_b32 v21, 0xffff0000, v156
    v_lshlrev_b32 v22, 16, v157
    v_and_b32 v23, 0xffff0000, v157
    ds_read_b64_tr_b16 v[92:93], v8 offset:32768
    ds_read_b64_tr_b16 v[94:95], v8 offset:33792
    v_mfma_f32_32x32x16_bf16 a[80:95], v[64:67], v[12:15], a[80:95]
    s_add_u32 m0, s57, 104448
    s_add_u32 s3, s56, 1253376
    buffer_load_dwordx4 v120, s[12:15], s3 offen lds
    v_lshlrev_b32 v24, 16, v158
    v_and_b32 v25, 0xffff0000, v158
    v_lshlrev_b32 v26, 16, v159
    v_and_b32 v27, 0xffff0000, v159
    ds_read_b64_tr_b16 v[96:97], v9 offset:32768
    ds_read_b64_tr_b16 v[98:99], v9 offset:33792
    v_mfma_f32_32x32x16_bf16 a[96:111], v[68:71], v[12:15], a[96:111]
    v_mul_f32_dpp v20, v31, v20 row_newbcast:8 row_mask:0xf bank_mask:0xf
    v_mul_f32_dpp v21, v31, v21 row_newbcast:9 row_mask:0xf bank_mask:0xf
    v_mul_f32_dpp v22, v31, v22 row_newbcast:10 row_mask:0xf bank_mask:0xf
    v_mul_f32_dpp v23, v31, v23 row_newbcast:11 row_mask:0xf bank_mask:0xf
    ds_read_b64_tr_b16 v[100:101], v10 offset:32768
    v_mfma_f32_32x32x16_bf16 a[112:127], v[72:75], v[12:15], a[112:127]
    v_mul_f32_dpp v24, v31, v24 row_newbcast:12 row_mask:0xf bank_mask:0xf
    v_mul_f32_dpp v25, v31, v25 row_newbcast:13 row_mask:0xf bank_mask:0xf
    v_mul_f32_dpp v26, v31, v26 row_newbcast:14 row_mask:0xf bank_mask:0xf
    v_mul_f32_dpp v27, v31, v27 row_newbcast:15 row_mask:0xf bank_mask:0xf
    ds_read_b64_tr_b16 v[102:103], v10 offset:33792
    v_mfma_f32_32x32x16_bf16 v[44:59], v[60:63], a[152:155], v[44:59]
    v_cvt_pk_bf16_f32 v16, v20, v21
    v_cvt_pk_bf16_f32 v17, v22, v23
    v_cvt_pk_bf16_f32 v18, v24, v25
    v_cvt_pk_bf16_f32 v19, v26, v27
    ds_read_b64_tr_b16 v[104:105], v11 offset:32768
    ds_read_b64_tr_b16 v[106:107], v11 offset:33792
    s_waitcnt lgkmcnt(8)
    v_mfma_f32_32x32x16_bf16 a[64:79], v[76:79], v[16:19], a[64:79]
    v_lshlrev_b32 v20, 16, v160
    v_and_b32 v21, 0xffff0000, v160
    v_lshlrev_b32 v22, 16, v161
    v_and_b32 v23, 0xffff0000, v161
    ds_read_b64_tr_b16 v[60:61], v8 offset:36864
    ds_read_b64_tr_b16 v[62:63], v8 offset:37888
    v_mfma_f32_32x32x16_bf16 a[80:95], v[80:83], v[16:19], a[80:95]
    s_add_u32 m0, s57, 105472
    s_add_u32 s3, s56, 1265664
    buffer_load_dwordx4 v120, s[12:15], s3 offen lds
    v_lshlrev_b32 v24, 16, v162
    v_and_b32 v25, 0xffff0000, v162
    v_lshlrev_b32 v26, 16, v163
    v_and_b32 v27, 0xffff0000, v163
    ds_read_b64_tr_b16 v[64:65], v9 offset:36864
    ds_read_b64_tr_b16 v[66:67], v9 offset:37888
    v_mfma_f32_32x32x16_bf16 a[96:111], v[84:87], v[16:19], a[96:111]
    v_mul_f32_dpp v20, v32, v20 row_newbcast:0 row_mask:0xf bank_mask:0xf
    v_mul_f32_dpp v21, v32, v21 row_newbcast:1 row_mask:0xf bank_mask:0xf
    v_mul_f32_dpp v22, v32, v22 row_newbcast:2 row_mask:0xf bank_mask:0xf
    v_mul_f32_dpp v23, v32, v23 row_newbcast:3 row_mask:0xf bank_mask:0xf
    ds_read_b64_tr_b16 v[68:69], v10 offset:36864
    v_mfma_f32_32x32x16_bf16 a[112:127], v[88:91], v[16:19], a[112:127]
    v_mul_f32_dpp v24, v32, v24 row_newbcast:4 row_mask:0xf bank_mask:0xf
    v_mul_f32_dpp v25, v32, v25 row_newbcast:5 row_mask:0xf bank_mask:0xf
    v_mul_f32_dpp v26, v32, v26 row_newbcast:6 row_mask:0xf bank_mask:0xf
    v_mul_f32_dpp v27, v32, v27 row_newbcast:7 row_mask:0xf bank_mask:0xf
    ds_read_b64_tr_b16 v[70:71], v10 offset:37888
    v_mfma_f32_32x32x16_bf16 v[44:59], v[76:79], a[156:159], v[44:59]
    v_cvt_pk_bf16_f32 v12, v20, v21
    v_cvt_pk_bf16_f32 v13, v22, v23
    v_cvt_pk_bf16_f32 v14, v24, v25
    v_cvt_pk_bf16_f32 v15, v26, v27
    ds_read_b64_tr_b16 v[72:73], v11 offset:36864
    ds_read_b64_tr_b16 v[74:75], v11 offset:37888
    s_waitcnt lgkmcnt(8)
    v_mfma_f32_32x32x16_bf16 a[64:79], v[92:95], v[12:15], a[64:79]
    v_lshlrev_b32 v20, 16, v164
    v_and_b32 v21, 0xffff0000, v164
    v_lshlrev_b32 v22, 16, v165
    v_and_b32 v23, 0xffff0000, v165
    ds_read_b64_tr_b16 v[76:77], v8 offset:40960
    ds_read_b64_tr_b16 v[78:79], v8 offset:41984
    v_mfma_f32_32x32x16_bf16 a[80:95], v[96:99], v[12:15], a[80:95]
    v_lshlrev_b32 v24, 16, v166
    v_and_b32 v25, 0xffff0000, v166
    v_lshlrev_b32 v26, 16, v167
    v_and_b32 v27, 0xffff0000, v167
    ds_read_b64_tr_b16 v[80:81], v9 offset:40960
    ds_read_b64_tr_b16 v[82:83], v9 offset:41984
    v_mfma_f32_32x32x16_bf16 a[96:111], v[100:103], v[12:15], a[96:111]
    v_mul_f32_dpp v20, v32, v20 row_newbcast:8 row_mask:0xf bank_mask:0xf
    v_mul_f32_dpp v21, v32, v21 row_newbcast:9 row_mask:0xf bank_mask:0xf
    v_mul_f32_dpp v22, v32, v22 row_newbcast:10 row_mask:0xf bank_mask:0xf
    v_mul_f32_dpp v23, v32, v23 row_newbcast:11 row_mask:0xf bank_mask:0xf
    ds_read_b64_tr_b16 v[84:85], v10 offset:40960
    v_mfma_f32_32x32x16_bf16 a[112:127], v[104:107], v[12:15], a[112:127]
    v_mul_f32_dpp v24, v32, v24 row_newbcast:12 row_mask:0xf bank_mask:0xf
    v_mul_f32_dpp v25, v32, v25 row_newbcast:13 row_mask:0xf bank_mask:0xf
    v_mul_f32_dpp v26, v32, v26 row_newbcast:14 row_mask:0xf bank_mask:0xf
    v_mul_f32_dpp v27, v32, v27 row_newbcast:15 row_mask:0xf bank_mask:0xf
    ds_read_b64_tr_b16 v[86:87], v10 offset:41984
    v_mfma_f32_32x32x16_bf16 v[44:59], v[92:95], a[160:163], v[44:59]
    v_cvt_pk_bf16_f32 v16, v20, v21
    v_cvt_pk_bf16_f32 v17, v22, v23
    v_cvt_pk_bf16_f32 v18, v24, v25
    v_cvt_pk_bf16_f32 v19, v26, v27
    ds_read_b64_tr_b16 v[88:89], v11 offset:40960
    ds_read_b64_tr_b16 v[90:91], v11 offset:41984
    s_waitcnt lgkmcnt(8)
    v_mfma_f32_32x32x16_bf16 a[64:79], v[60:63], v[16:19], a[64:79]
    v_lshlrev_b32 v20, 16, v168
    v_and_b32 v21, 0xffff0000, v168
    v_lshlrev_b32 v22, 16, v169
    v_and_b32 v23, 0xffff0000, v169
    ds_read_b64_tr_b16 v[92:93], v8 offset:45056
    ds_read_b64_tr_b16 v[94:95], v8 offset:46080
    v_mfma_f32_32x32x16_bf16 a[80:95], v[64:67], v[16:19], a[80:95]
    v_lshlrev_b32 v24, 16, v170
    v_and_b32 v25, 0xffff0000, v170
    v_lshlrev_b32 v26, 16, v171
    v_and_b32 v27, 0xffff0000, v171
    ds_read_b64_tr_b16 v[96:97], v9 offset:45056
    ds_read_b64_tr_b16 v[98:99], v9 offset:46080
    v_mfma_f32_32x32x16_bf16 a[96:111], v[68:71], v[16:19], a[96:111]
    v_mul_f32_dpp v20, v33, v20 row_newbcast:0 row_mask:0xf bank_mask:0xf
    v_mul_f32_dpp v21, v33, v21 row_newbcast:1 row_mask:0xf bank_mask:0xf
    v_mul_f32_dpp v22, v33, v22 row_newbcast:2 row_mask:0xf bank_mask:0xf
    v_mul_f32_dpp v23, v33, v23 row_newbcast:3 row_mask:0xf bank_mask:0xf
    ds_read_b64_tr_b16 v[100:101], v10 offset:45056
    v_mfma_f32_32x32x16_bf16 a[112:127], v[72:75], v[16:19], a[112:127]
    v_mul_f32_dpp v24, v33, v24 row_newbcast:4 row_mask:0xf bank_mask:0xf
    v_mul_f32_dpp v25, v33, v25 row_newbcast:5 row_mask:0xf bank_mask:0xf
    v_mul_f32_dpp v26, v33, v26 row_newbcast:6 row_mask:0xf bank_mask:0xf
    v_mul_f32_dpp v27, v33, v27 row_newbcast:7 row_mask:0xf bank_mask:0xf
    ds_read_b64_tr_b16 v[102:103], v10 offset:46080
    v_mfma_f32_32x32x16_bf16 v[44:59], v[60:63], a[164:167], v[44:59]
    v_cvt_pk_bf16_f32 v12, v20, v21
    v_cvt_pk_bf16_f32 v13, v22, v23
    v_cvt_pk_bf16_f32 v14, v24, v25
    v_cvt_pk_bf16_f32 v15, v26, v27
    ds_read_b64_tr_b16 v[104:105], v11 offset:45056
    ds_read_b64_tr_b16 v[106:107], v11 offset:46080
    s_waitcnt lgkmcnt(8)
    v_mfma_f32_32x32x16_bf16 a[64:79], v[76:79], v[12:15], a[64:79]
    v_lshlrev_b32 v20, 16, v172
    v_and_b32 v21, 0xffff0000, v172
    v_lshlrev_b32 v22, 16, v173
    v_and_b32 v23, 0xffff0000, v173
    ds_read_b64_tr_b16 v[60:61], v8 offset:49152
    ds_read_b64_tr_b16 v[62:63], v8 offset:50176
    v_mfma_f32_32x32x16_bf16 a[80:95], v[80:83], v[12:15], a[80:95]
    v_lshlrev_b32 v24, 16, v174
    v_and_b32 v25, 0xffff0000, v174
    v_lshlrev_b32 v26, 16, v175
    v_and_b32 v27, 0xffff0000, v175
    ds_read_b64_tr_b16 v[64:65], v9 offset:49152
    ds_read_b64_tr_b16 v[66:67], v9 offset:50176
    v_mfma_f32_32x32x16_bf16 a[96:111], v[84:87], v[12:15], a[96:111]
    v_mul_f32_dpp v20, v33, v20 row_newbcast:8 row_mask:0xf bank_mask:0xf
    v_mul_f32_dpp v21, v33, v21 row_newbcast:9 row_mask:0xf bank_mask:0xf
    v_mul_f32_dpp v22, v33, v22 row_newbcast:10 row_mask:0xf bank_mask:0xf
    v_mul_f32_dpp v23, v33, v23 row_newbcast:11 row_mask:0xf bank_mask:0xf
    ds_read_b64_tr_b16 v[68:69], v10 offset:49152
    v_mfma_f32_32x32x16_bf16 a[112:127], v[88:91], v[12:15], a[112:127]
    v_mul_f32_dpp v24, v33, v24 row_newbcast:12 row_mask:0xf bank_mask:0xf
    v_mul_f32_dpp v25, v33, v25 row_newbcast:13 row_mask:0xf bank_mask:0xf
    v_mul_f32_dpp v26, v33, v26 row_newbcast:14 row_mask:0xf bank_mask:0xf
    v_mul_f32_dpp v27, v33, v27 row_newbcast:15 row_mask:0xf bank_mask:0xf
    ds_read_b64_tr_b16 v[70:71], v10 offset:50176
    v_mfma_f32_32x32x16_bf16 v[44:59], v[76:79], a[168:171], v[44:59]
    v_cvt_pk_bf16_f32 v16, v20, v21
    v_cvt_pk_bf16_f32 v17, v22, v23
    v_cvt_pk_bf16_f32 v18, v24, v25
    v_cvt_pk_bf16_f32 v19, v26, v27
    ds_read_b64_tr_b16 v[72:73], v11 offset:49152
    ds_read_b64_tr_b16 v[74:75], v11 offset:50176
    s_waitcnt lgkmcnt(8)
    v_mfma_f32_32x32x16_bf16 a[64:79], v[92:95], v[16:19], a[64:79]
    v_lshlrev_b32 v20, 16, v176
    v_and_b32 v21, 0xffff0000, v176
    v_lshlrev_b32 v22, 16, v177
    v_and_b32 v23, 0xffff0000, v177
    ds_read_b64_tr_b16 v[76:77], v8 offset:53248
    ds_read_b64_tr_b16 v[78:79], v8 offset:54272
    v_mfma_f32_32x32x16_bf16 a[80:95], v[96:99], v[16:19], a[80:95]
    v_lshlrev_b32 v24, 16, v178
    v_and_b32 v25, 0xffff0000, v178
    v_lshlrev_b32 v26, 16, v179
    v_and_b32 v27, 0xffff0000, v179
    ds_read_b64_tr_b16 v[80:81], v9 offset:53248
    ds_read_b64_tr_b16 v[82:83], v9 offset:54272
    v_mfma_f32_32x32x16_bf16 a[96:111], v[100:103], v[16:19], a[96:111]
    v_mul_f32_dpp v20, v34, v20 row_newbcast:0 row_mask:0xf bank_mask:0xf
    v_mul_f32_dpp v21, v34, v21 row_newbcast:1 row_mask:0xf bank_mask:0xf
    v_mul_f32_dpp v22, v34, v22 row_newbcast:2 row_mask:0xf bank_mask:0xf
    v_mul_f32_dpp v23, v34, v23 row_newbcast:3 row_mask:0xf bank_mask:0xf
    ds_read_b64_tr_b16 v[84:85], v10 offset:53248
    v_mfma_f32_32x32x16_bf16 a[112:127], v[104:107], v[16:19], a[112:127]
    v_mul_f32_dpp v24, v34, v24 row_newbcast:4 row_mask:0xf bank_mask:0xf
    v_mul_f32_dpp v25, v34, v25 row_newbcast:5 row_mask:0xf bank_mask:0xf
    v_mul_f32_dpp v26, v34, v26 row_newbcast:6 row_mask:0xf bank_mask:0xf
    v_mul_f32_dpp v27, v34, v27 row_newbcast:7 row_mask:0xf bank_mask:0xf
    ds_read_b64_tr_b16 v[86:87], v10 offset:54272
    v_mfma_f32_32x32x16_bf16 v[44:59], v[92:95], a[172:175], v[44:59]
    v_cvt_pk_bf16_f32 v12, v20, v21
    v_cvt_pk_bf16_f32 v13, v22, v23
    v_cvt_pk_bf16_f32 v14, v24, v25
    v_cvt_pk_bf16_f32 v15, v26, v27
    ds_read_b64_tr_b16 v[88:89], v11 offset:53248
    ds_read_b64_tr_b16 v[90:91], v11 offset:54272
    s_waitcnt lgkmcnt(8)
    v_mfma_f32_32x32x16_bf16 a[64:79], v[60:63], v[12:15], a[64:79]
    v_lshlrev_b32 v20, 16, v180
    v_and_b32 v21, 0xffff0000, v180
    v_lshlrev_b32 v22, 16, v181
    v_and_b32 v23, 0xffff0000, v181
    ds_read_b64_tr_b16 v[92:93], v8 offset:57344
    ds_read_b64_tr_b16 v[94:95], v8 offset:58368
    v_mfma_f32_32x32x16_bf16 a[80:95], v[64:67], v[12:15], a[80:95]
    v_lshlrev_b32 v24, 16, v182
    v_and_b32 v25, 0xffff0000, v182
    v_lshlrev_b32 v26, 16, v183
    v_and_b32 v27, 0xffff0000, v183
    ds_read_b64_tr_b16 v[96:97], v9 offset:57344
    ds_read_b64_tr_b16 v[98:99], v9 offset:58368
    v_mfma_f32_32x32x16_bf16 a[96:111], v[68:71], v[12:15], a[96:111]
    v_mul_f32_dpp v20, v34, v20 row_newbcast:8 row_mask:0xf bank_mask:0xf
    v_mul_f32_dpp v21, v34, v21 row_newbcast:9 row_mask:0xf bank_mask:0xf
    v_mul_f32_dpp v22, v34, v22 row_newbcast:10 row_mask:0xf bank_mask:0xf
    v_mul_f32_dpp v23, v34, v23 row_newbcast:11 row_mask:0xf bank_mask:0xf
    ds_read_b64_tr_b16 v[100:101], v10 offset:57344
    v_mfma_f32_32x32x16_bf16 a[112:127], v[72:75], v[12:15], a[112:127]
    v_mul_f32_dpp v24, v34, v24 row_newbcast:12 row_mask:0xf bank_mask:0xf
    v_mul_f32_dpp v25, v34, v25 row_newbcast:13 row_mask:0xf bank_mask:0xf
    v_mul_f32_dpp v26, v34, v26 row_newbcast:14 row_mask:0xf bank_mask:0xf
    v_mul_f32_dpp v27, v34, v27 row_newbcast:15 row_mask:0xf bank_mask:0xf
    ds_read_b64_tr_b16 v[102:103], v10 offset:58368
    v_mfma_f32_32x32x16_bf16 v[44:59], v[60:63], a[176:179], v[44:59]
    v_cvt_pk_bf16_f32 v16, v20, v21
    v_cvt_pk_bf16_f32 v17, v22, v23
    v_cvt_pk_bf16_f32 v18, v24, v25
    v_cvt_pk_bf16_f32 v19, v26, v27
    ds_read_b64_tr_b16 v[104:105], v11 offset:57344
    ds_read_b64_tr_b16 v[106:107], v11 offset:58368
    s_waitcnt lgkmcnt(8)
    v_mfma_f32_32x32x16_bf16 a[64:79], v[76:79], v[16:19], a[64:79]
    v_lshlrev_b32 v20, 16, v184
    v_and_b32 v21, 0xffff0000, v184
    v_lshlrev_b32 v22, 16, v185
    v_and_b32 v23, 0xffff0000, v185
    ds_read_b64_tr_b16 v[60:61], v8 offset:61440
    ds_read_b64_tr_b16 v[62:63], v8 offset:62464
    v_mfma_f32_32x32x16_bf16 a[80:95], v[80:83], v[16:19], a[80:95]
    v_lshlrev_b32 v24, 16, v186
    v_and_b32 v25, 0xffff0000, v186
    v_lshlrev_b32 v26, 16, v187
    v_and_b32 v27, 0xffff0000, v187
    ds_read_b64_tr_b16 v[64:65], v9 offset:61440
    ds_read_b64_tr_b16 v[66:67], v9 offset:62464
    v_mfma_f32_32x32x16_bf16 a[96:111], v[84:87], v[16:19], a[96:111]
    v_mul_f32_dpp v20, v35, v20 row_newbcast:0 row_mask:0xf bank_mask:0xf
    v_mul_f32_dpp v21, v35, v21 row_newbcast:1 row_mask:0xf bank_mask:0xf
    v_mul_f32_dpp v22, v35, v22 row_newbcast:2 row_mask:0xf bank_mask:0xf
    v_mul_f32_dpp v23, v35, v23 row_newbcast:3 row_mask:0xf bank_mask:0xf
    ds_read_b64_tr_b16 v[68:69], v10 offset:61440
    v_mfma_f32_32x32x16_bf16 a[112:127], v[88:91], v[16:19], a[112:127]
    v_mul_f32_dpp v24, v35, v24 row_newbcast:4 row_mask:0xf bank_mask:0xf
    v_mul_f32_dpp v25, v35, v25 row_newbcast:5 row_mask:0xf bank_mask:0xf
    v_mul_f32_dpp v26, v35, v26 row_newbcast:6 row_mask:0xf bank_mask:0xf
    v_mul_f32_dpp v27, v35, v27 row_newbcast:7 row_mask:0xf bank_mask:0xf
    ds_read_b64_tr_b16 v[70:71], v10 offset:62464
    v_mfma_f32_32x32x16_bf16 v[44:59], v[76:79], a[180:183], v[44:59]
    v_cvt_pk_bf16_f32 v12, v20, v21
    v_cvt_pk_bf16_f32 v13, v22, v23
    v_cvt_pk_bf16_f32 v14, v24, v25
    v_cvt_pk_bf16_f32 v15, v26, v27
    ds_read_b64_tr_b16 v[72:73], v11 offset:61440
    ds_read_b64_tr_b16 v[74:75], v11 offset:62464
    s_waitcnt vmcnt(0)
    s_barrier
    s_waitcnt lgkmcnt(8)
    v_mfma_f32_32x32x16_bf16 a[64:79], v[92:95], v[12:15], a[64:79]
    v_lshlrev_b32 v20, 16, v188
    v_and_b32 v21, 0xffff0000, v188
    v_lshlrev_b32 v22, 16, v189
    v_and_b32 v23, 0xffff0000, v189
    v_add_u32 v8, 0x10000, v8
    ds_read_b64_tr_b16 v[76:77], v8 offset:0
    ds_read_b64_tr_b16 v[78:79], v8 offset:1024
    v_mfma_f32_32x32x16_bf16 a[80:95], v[96:99], v[12:15], a[80:95]
    v_lshlrev_b32 v24, 16, v190
    v_and_b32 v25, 0xffff0000, v190
    v_lshlrev_b32 v26, 16, v191
    v_and_b32 v27, 0xffff0000, v191
    v_add_u32 v9, 0x10000, v9
    ds_read_b64_tr_b16 v[80:81], v9 offset:0
    ds_read_b64_tr_b16 v[82:83], v9 offset:1024
    v_mfma_f32_32x32x16_bf16 a[96:111], v[100:103], v[12:15], a[96:111]
    v_mul_f32_dpp v20, v35, v20 row_newbcast:8 row_mask:0xf bank_mask:0xf
    v_mul_f32_dpp v21, v35, v21 row_newbcast:9 row_mask:0xf bank_mask:0xf
    v_mul_f32_dpp v22, v35, v22 row_newbcast:10 row_mask:0xf bank_mask:0xf
    v_mul_f32_dpp v23, v35, v23 row_newbcast:11 row_mask:0xf bank_mask:0xf
    v_add_u32 v10, 0x10000, v10
    ds_read_b64_tr_b16 v[84:85], v10 offset:0
    v_mfma_f32_32x32x16_bf16 a[112:127], v[104:107], v[12:15], a[112:127]
    v_mul_f32_dpp v24, v35, v24 row_newbcast:12 row_mask:0xf bank_mask:0xf
    v_mul_f32_dpp v25, v35, v25 row_newbcast:13 row_mask:0xf bank_mask:0xf
    v_mul_f32_dpp v26, v35, v26 row_newbcast:14 row_mask:0xf bank_mask:0xf
    v_mul_f32_dpp v27, v35, v27 row_newbcast:15 row_mask:0xf bank_mask:0xf
    ds_read_b64_tr_b16 v[86:87], v10 offset:1024
    v_mfma_f32_32x32x16_bf16 v[44:59], v[92:95], a[184:187], v[44:59]
    v_cvt_pk_bf16_f32 v16, v20, v21
    v_cvt_pk_bf16_f32 v17, v22, v23
    v_cvt_pk_bf16_f32 v18, v24, v25
    v_cvt_pk_bf16_f32 v19, v26, v27
    v_add_u32 v11, 0x10000, v11
    ds_read_b64_tr_b16 v[88:89], v11 offset:0
    ds_read_b64_tr_b16 v[90:91], v11 offset:1024
    s_waitcnt lgkmcnt(8)
    v_mfma_f32_32x32x16_bf16 a[64:79], v[60:63], v[16:19], a[64:79]
    v_lshlrev_b32 v20, 16, v192
    v_and_b32 v21, 0xffff0000, v192
    v_lshlrev_b32 v22, 16, v193
    v_and_b32 v23, 0xffff0000, v193
    ds_read_b64_tr_b16 v[92:93], v8 offset:4096
    ds_read_b64_tr_b16 v[94:95], v8 offset:5120
    v_mfma_f32_32x32x16_bf16 a[80:95], v[64:67], v[16:19], a[80:95]
    v_lshlrev_b32 v24, 16, v194
    v_and_b32 v25, 0xffff0000, v194
    v_lshlrev_b32 v26, 16, v195
    v_and_b32 v27, 0xffff0000, v195
    ds_read_b64_tr_b16 v[96:97], v9 offset:4096
    ds_read_b64_tr_b16 v[98:99], v9 offset:5120
    v_mfma_f32_32x32x16_bf16 a[96:111], v[68:71], v[16:19], a[96:111]
    v_mul_f32_dpp v20, v36, v20 row_newbcast:0 row_mask:0xf bank_mask:0xf
    v_mul_f32_dpp v21, v36, v21 row_newbcast:1 row_mask:0xf bank_mask:0xf
    v_mul_f32_dpp v22, v36, v22 row_newbcast:2 row_mask:0xf bank_mask:0xf
    v_mul_f32_dpp v23, v36, v23 row_newbcast:3 row_mask:0xf bank_mask:0xf
    ds_read_b64_tr_b16 v[100:101], v10 offset:4096
    v_mfma_f32_32x32x16_bf16 a[112:127], v[72:75], v[16:19], a[112:127]
    v_mul_f32_dpp v24, v36, v24 row_newbcast:4 row_mask:0xf bank_mask:0xf
    v_mul_f32_dpp v25, v36, v25 row_newbcast:5 row_mask:0xf bank_mask:0xf
    v_mul_f32_dpp v26, v36, v26 row_newbcast:6 row_mask:0xf bank_mask:0xf
    v_mul_f32_dpp v27, v36, v27 row_newbcast:7 row_mask:0xf bank_mask:0xf
    ds_read_b64_tr_b16 v[102:103], v10 offset:5120
    v_mfma_f32_32x32x16_bf16 v[44:59], v[60:63], a[188:191], v[44:59]
    v_cvt_pk_bf16_f32 v12, v20, v21
    v_cvt_pk_bf16_f32 v13, v22, v23
    v_cvt_pk_bf16_f32 v14, v24, v25
    v_cvt_pk_bf16_f32 v15, v26, v27
    ds_read_b64_tr_b16 v[104:105], v11 offset:4096
    ds_read_b64_tr_b16 v[106:107], v11 offset:5120
    s_waitcnt lgkmcnt(8)
    v_mfma_f32_32x32x16_bf16 a[64:79], v[76:79], v[12:15], a[64:79]
    v_lshlrev_b32 v20, 16, v196
    v_and_b32 v21, 0xffff0000, v196
    v_lshlrev_b32 v22, 16, v197
    v_and_b32 v23, 0xffff0000, v197
    ds_read_b64_tr_b16 v[60:61], v8 offset:8192
    ds_read_b64_tr_b16 v[62:63], v8 offset:9216
    v_mfma_f32_32x32x16_bf16 a[80:95], v[80:83], v[12:15], a[80:95]
    v_lshlrev_b32 v24, 16, v198
    v_and_b32 v25, 0xffff0000, v198
    v_lshlrev_b32 v26, 16, v199
    v_and_b32 v27, 0xffff0000, v199
    ds_read_b64_tr_b16 v[64:65], v9 offset:8192
    ds_read_b64_tr_b16 v[66:67], v9 offset:9216
    v_mfma_f32_32x32x16_bf16 a[96:111], v[84:87], v[12:15], a[96:111]
    v_mul_f32_dpp v20, v36, v20 row_newbcast:8 row_mask:0xf bank_mask:0xf
    v_mul_f32_dpp v21, v36, v21 row_newbcast:9 row_mask:0xf bank_mask:0xf
    v_mul_f32_dpp v22, v36, v22 row_newbcast:10 row_mask:0xf bank_mask:0xf
    v_mul_f32_dpp v23, v36, v23 row_newbcast:11 row_mask:0xf bank_mask:0xf
    ds_read_b64_tr_b16 v[68:69], v10 offset:8192
    v_mfma_f32_32x32x16_bf16 a[112:127], v[88:91], v[12:15], a[112:127]
    v_mul_f32_dpp v24, v36, v24 row_newbcast:12 row_mask:0xf bank_mask:0xf
    v_mul_f32_dpp v25, v36, v25 row_newbcast:13 row_mask:0xf bank_mask:0xf
    v_mul_f32_dpp v26, v36, v26 row_newbcast:14 row_mask:0xf bank_mask:0xf
    v_mul_f32_dpp v27, v36, v27 row_newbcast:15 row_mask:0xf bank_mask:0xf
    ds_read_b64_tr_b16 v[70:71], v10 offset:9216
    v_mfma_f32_32x32x16_bf16 v[44:59], v[76:79], a[192:195], v[44:59]
    v_cvt_pk_bf16_f32 v16, v20, v21
    v_cvt_pk_bf16_f32 v17, v22, v23
    v_cvt_pk_bf16_f32 v18, v24, v25
    v_cvt_pk_bf16_f32 v19, v26, v27
    ds_read_b64_tr_b16 v[72:73], v11 offset:8192
    ds_read_b64_tr_b16 v[74:75], v11 offset:9216
    s_waitcnt lgkmcnt(8)
    v_mfma_f32_32x32x16_bf16 a[64:79], v[92:95], v[16:19], a[64:79]
    v_lshlrev_b32 v20, 16, v200
    v_and_b32 v21, 0xffff0000, v200
    v_lshlrev_b32 v22, 16, v201
    v_and_b32 v23, 0xffff0000, v201
    ds_read_b64_tr_b16 v[76:77], v8 offset:12288
    ds_read_b64_tr_b16 v[78:79], v8 offset:13312
    v_mfma_f32_32x32x16_bf16 a[80:95], v[96:99], v[16:19], a[80:95]
    v_lshlrev_b32 v24, 16, v202
    v_and_b32 v25, 0xffff0000, v202
    v_lshlrev_b32 v26, 16, v203
    v_and_b32 v27, 0xffff0000, v203
    ds_read_b64_tr_b16 v[80:81], v9 offset:12288
    ds_read_b64_tr_b16 v[82:83], v9 offset:13312
    v_mfma_f32_32x32x16_bf16 a[96:111], v[100:103], v[16:19], a[96:111]
    v_mul_f32_dpp v20, v37, v20 row_newbcast:0 row_mask:0xf bank_mask:0xf
    v_mul_f32_dpp v21, v37, v21 row_newbcast:1 row_mask:0xf bank_mask:0xf
    v_mul_f32_dpp v22, v37, v22 row_newbcast:2 row_mask:0xf bank_mask:0xf
    v_mul_f32_dpp v23, v37, v23 row_newbcast:3 row_mask:0xf bank_mask:0xf
    ds_read_b64_tr_b16 v[84:85], v10 offset:12288
    v_mfma_f32_32x32x16_bf16 a[112:127], v[104:107], v[16:19], a[112:127]
    v_mul_f32_dpp v24, v37, v24 row_newbcast:4 row_mask:0xf bank_mask:0xf
    v_mul_f32_dpp v25, v37, v25 row_newbcast:5 row_mask:0xf bank_mask:0xf
    v_mul_f32_dpp v26, v37, v26 row_newbcast:6 row_mask:0xf bank_mask:0xf
    v_mul_f32_dpp v27, v37, v27 row_newbcast:7 row_mask:0xf bank_mask:0xf
    ds_read_b64_tr_b16 v[86:87], v10 offset:13312
    v_mfma_f32_32x32x16_bf16 v[44:59], v[92:95], a[196:199], v[44:59]
    v_cvt_pk_bf16_f32 v12, v20, v21
    v_cvt_pk_bf16_f32 v13, v22, v23
    v_cvt_pk_bf16_f32 v14, v24, v25
    v_cvt_pk_bf16_f32 v15, v26, v27
    ds_read_b64_tr_b16 v[88:89], v11 offset:12288
    ds_read_b64_tr_b16 v[90:91], v11 offset:13312
    s_waitcnt lgkmcnt(8)
    v_mfma_f32_32x32x16_bf16 a[64:79], v[60:63], v[12:15], a[64:79]
    v_lshlrev_b32 v20, 16, v204
    v_and_b32 v21, 0xffff0000, v204
    v_lshlrev_b32 v22, 16, v205
    v_and_b32 v23, 0xffff0000, v205
    ds_read_b64_tr_b16 v[92:93], v8 offset:16384
    ds_read_b64_tr_b16 v[94:95], v8 offset:17408
    v_mfma_f32_32x32x16_bf16 a[80:95], v[64:67], v[12:15], a[80:95]
    v_lshlrev_b32 v24, 16, v206
    v_and_b32 v25, 0xffff0000, v206
    v_lshlrev_b32 v26, 16, v207
    v_and_b32 v27, 0xffff0000, v207
    ds_read_b64_tr_b16 v[96:97], v9 offset:16384
    ds_read_b64_tr_b16 v[98:99], v9 offset:17408
    v_mfma_f32_32x32x16_bf16 a[96:111], v[68:71], v[12:15], a[96:111]
    v_mul_f32_dpp v20, v37, v20 row_newbcast:8 row_mask:0xf bank_mask:0xf
    v_mul_f32_dpp v21, v37, v21 row_newbcast:9 row_mask:0xf bank_mask:0xf
    v_mul_f32_dpp v22, v37, v22 row_newbcast:10 row_mask:0xf bank_mask:0xf
    v_mul_f32_dpp v23, v37, v23 row_newbcast:11 row_mask:0xf bank_mask:0xf
    ds_read_b64_tr_b16 v[100:101], v10 offset:16384
    v_mfma_f32_32x32x16_bf16 a[112:127], v[72:75], v[12:15], a[112:127]
    v_mul_f32_dpp v24, v37, v24 row_newbcast:12 row_mask:0xf bank_mask:0xf
    v_mul_f32_dpp v25, v37, v25 row_newbcast:13 row_mask:0xf bank_mask:0xf
    v_mul_f32_dpp v26, v37, v26 row_newbcast:14 row_mask:0xf bank_mask:0xf
    v_mul_f32_dpp v27, v37, v27 row_newbcast:15 row_mask:0xf bank_mask:0xf
    ds_read_b64_tr_b16 v[102:103], v10 offset:17408
    v_mfma_f32_32x32x16_bf16 v[44:59], v[60:63], a[200:203], v[44:59]
    v_cvt_pk_bf16_f32 v16, v20, v21
    v_cvt_pk_bf16_f32 v17, v22, v23
    v_cvt_pk_bf16_f32 v18, v24, v25
    v_cvt_pk_bf16_f32 v19, v26, v27
    ds_read_b64_tr_b16 v[104:105], v11 offset:16384
    ds_read_b64_tr_b16 v[106:107], v11 offset:17408
    s_waitcnt lgkmcnt(8)
    v_mfma_f32_32x32x16_bf16 a[64:79], v[76:79], v[16:19], a[64:79]
    v_lshlrev_b32 v20, 16, v208
    v_and_b32 v21, 0xffff0000, v208
    v_lshlrev_b32 v22, 16, v209
    v_and_b32 v23, 0xffff0000, v209
    ds_read_b64_tr_b16 v[60:61], v8 offset:20480
    ds_read_b64_tr_b16 v[62:63], v8 offset:21504
    v_mfma_f32_32x32x16_bf16 a[80:95], v[80:83], v[16:19], a[80:95]
    v_lshlrev_b32 v24, 16, v210
    v_and_b32 v25, 0xffff0000, v210
    v_lshlrev_b32 v26, 16, v211
    v_and_b32 v27, 0xffff0000, v211
    ds_read_b64_tr_b16 v[64:65], v9 offset:20480
    ds_read_b64_tr_b16 v[66:67], v9 offset:21504
    v_mfma_f32_32x32x16_bf16 a[96:111], v[84:87], v[16:19], a[96:111]
    v_mul_f32_dpp v20, v38, v20 row_newbcast:0 row_mask:0xf bank_mask:0xf
    v_mul_f32_dpp v21, v38, v21 row_newbcast:1 row_mask:0xf bank_mask:0xf
    v_mul_f32_dpp v22, v38, v22 row_newbcast:2 row_mask:0xf bank_mask:0xf
    v_mul_f32_dpp v23, v38, v23 row_newbcast:3 row_mask:0xf bank_mask:0xf
    ds_read_b64_tr_b16 v[68:69], v10 offset:20480
    v_mfma_f32_32x32x16_bf16 a[112:127], v[88:91], v[16:19], a[112:127]
    v_mul_f32_dpp v24, v38, v24 row_newbcast:4 row_mask:0xf bank_mask:0xf
    v_mul_f32_dpp v25, v38, v25 row_newbcast:5 row_mask:0xf bank_mask:0xf
    v_mul_f32_dpp v26, v38, v26 row_newbcast:6 row_mask:0xf bank_mask:0xf
    v_mul_f32_dpp v27, v38, v27 row_newbcast:7 row_mask:0xf bank_mask:0xf
    ds_read_b64_tr_b16 v[70:71], v10 offset:21504
    v_mfma_f32_32x32x16_bf16 v[44:59], v[76:79], a[204:207], v[44:59]
    v_cvt_pk_bf16_f32 v12, v20, v21
    v_cvt_pk_bf16_f32 v13, v22, v23
    v_cvt_pk_bf16_f32 v14, v24, v25
    v_cvt_pk_bf16_f32 v15, v26, v27
    ds_read_b64_tr_b16 v[72:73], v11 offset:20480
    ds_read_b64_tr_b16 v[74:75], v11 offset:21504
    s_waitcnt lgkmcnt(8)
    v_mfma_f32_32x32x16_bf16 a[64:79], v[92:95], v[12:15], a[64:79]
    v_lshlrev_b32 v20, 16, v212
    v_and_b32 v21, 0xffff0000, v212
    v_lshlrev_b32 v22, 16, v213
    v_and_b32 v23, 0xffff0000, v213
    ds_read_b64_tr_b16 v[76:77], v8 offset:24576
    ds_read_b64_tr_b16 v[78:79], v8 offset:25600
    v_mfma_f32_32x32x16_bf16 a[80:95], v[96:99], v[12:15], a[80:95]
    v_lshlrev_b32 v24, 16, v214
    v_and_b32 v25, 0xffff0000, v214
    v_lshlrev_b32 v26, 16, v215
    v_and_b32 v27, 0xffff0000, v215
    ds_read_b64_tr_b16 v[80:81], v9 offset:24576
    ds_read_b64_tr_b16 v[82:83], v9 offset:25600
    v_mfma_f32_32x32x16_bf16 a[96:111], v[100:103], v[12:15], a[96:111]
    v_mul_f32_dpp v20, v38, v20 row_newbcast:8 row_mask:0xf bank_mask:0xf
    v_mul_f32_dpp v21, v38, v21 row_newbcast:9 row_mask:0xf bank_mask:0xf
    v_mul_f32_dpp v22, v38, v22 row_newbcast:10 row_mask:0xf bank_mask:0xf
    v_mul_f32_dpp v23, v38, v23 row_newbcast:11 row_mask:0xf bank_mask:0xf
    ds_read_b64_tr_b16 v[84:85], v10 offset:24576
    v_mfma_f32_32x32x16_bf16 a[112:127], v[104:107], v[12:15], a[112:127]
    v_mul_f32_dpp v24, v38, v24 row_newbcast:12 row_mask:0xf bank_mask:0xf
    v_mul_f32_dpp v25, v38, v25 row_newbcast:13 row_mask:0xf bank_mask:0xf
    v_mul_f32_dpp v26, v38, v26 row_newbcast:14 row_mask:0xf bank_mask:0xf
    v_mul_f32_dpp v27, v38, v27 row_newbcast:15 row_mask:0xf bank_mask:0xf
    ds_read_b64_tr_b16 v[86:87], v10 offset:25600
    v_mfma_f32_32x32x16_bf16 v[44:59], v[92:95], a[208:211], v[44:59]
    v_cvt_pk_bf16_f32 v16, v20, v21
    v_cvt_pk_bf16_f32 v17, v22, v23
    v_cvt_pk_bf16_f32 v18, v24, v25
    v_cvt_pk_bf16_f32 v19, v26, v27
    ds_read_b64_tr_b16 v[88:89], v11 offset:24576
    ds_read_b64_tr_b16 v[90:91], v11 offset:25600
    s_waitcnt lgkmcnt(8)
    v_mfma_f32_32x32x16_bf16 a[64:79], v[60:63], v[16:19], a[64:79]
    v_lshlrev_b32 v20, 16, v216
    v_and_b32 v21, 0xffff0000, v216
    v_lshlrev_b32 v22, 16, v217
    v_and_b32 v23, 0xffff0000, v217
    ds_read_b64_tr_b16 v[92:93], v8 offset:28672
    ds_read_b64_tr_b16 v[94:95], v8 offset:29696
    v_mfma_f32_32x32x16_bf16 a[80:95], v[64:67], v[16:19], a[80:95]
    v_lshlrev_b32 v24, 16, v218
    v_and_b32 v25, 0xffff0000, v218
    v_lshlrev_b32 v26, 16, v219
    v_and_b32 v27, 0xffff0000, v219
    ds_read_b64_tr_b16 v[96:97], v9 offset:28672
    ds_read_b64_tr_b16 v[98:99], v9 offset:29696
    v_mfma_f32_32x32x16_bf16 a[96:111], v[68:71], v[16:19], a[96:111]
    v_mul_f32_dpp v20, v39, v20 row_newbcast:0 row_mask:0xf bank_mask:0xf
    v_mul_f32_dpp v21, v39, v21 row_newbcast:1 row_mask:0xf bank_mask:0xf
    v_mul_f32_dpp v22, v39, v22 row_newbcast:2 row_mask:0xf bank_mask:0xf
    v_mul_f32_dpp v23, v39, v23 row_newbcast:3 row_mask:0xf bank_mask:0xf
    ds_read_b64_tr_b16 v[100:101], v10 offset:28672
    v_mfma_f32_32x32x16_bf16 a[112:127], v[72:75], v[16:19], a[112:127]
    v_mul_f32_dpp v24, v39, v24 row_newbcast:4 row_mask:0xf bank_mask:0xf
    v_mul_f32_dpp v25, v39, v25 row_newbcast:5 row_mask:0xf bank_mask:0xf
    v_mul_f32_dpp v26, v39, v26 row_newbcast:6 row_mask:0xf bank_mask:0xf
    v_mul_f32_dpp v27, v39, v27 row_newbcast:7 row_mask:0xf bank_mask:0xf
    ds_read_b64_tr_b16 v[102:103], v10 offset:29696
    v_mfma_f32_32x32x16_bf16 v[44:59], v[60:63], a[212:215], v[44:59]
    v_cvt_pk_bf16_f32 v12, v20, v21
    v_cvt_pk_bf16_f32 v13, v22, v23
    v_cvt_pk_bf16_f32 v14, v24, v25
    v_cvt_pk_bf16_f32 v15, v26, v27
    ds_read_b64_tr_b16 v[104:105], v11 offset:28672
    ds_read_b64_tr_b16 v[106:107], v11 offset:29696
    s_waitcnt lgkmcnt(8)
    v_mfma_f32_32x32x16_bf16 a[64:79], v[76:79], v[12:15], a[64:79]
    v_lshlrev_b32 v20, 16, v220
    v_and_b32 v21, 0xffff0000, v220
    v_lshlrev_b32 v22, 16, v221
    v_and_b32 v23, 0xffff0000, v221
    ds_read_b64_tr_b16 v[60:61], v8 offset:32768
    ds_read_b64_tr_b16 v[62:63], v8 offset:33792
    v_mfma_f32_32x32x16_bf16 a[80:95], v[80:83], v[12:15], a[80:95]
    v_lshlrev_b32 v24, 16, v222
    v_and_b32 v25, 0xffff0000, v222
    v_lshlrev_b32 v26, 16, v223
    v_and_b32 v27, 0xffff0000, v223
    ds_read_b64_tr_b16 v[64:65], v9 offset:32768
    ds_read_b64_tr_b16 v[66:67], v9 offset:33792
    v_mfma_f32_32x32x16_bf16 a[96:111], v[84:87], v[12:15], a[96:111]
    v_mul_f32_dpp v20, v39, v20 row_newbcast:8 row_mask:0xf bank_mask:0xf
    v_mul_f32_dpp v21, v39, v21 row_newbcast:9 row_mask:0xf bank_mask:0xf
    v_mul_f32_dpp v22, v39, v22 row_newbcast:10 row_mask:0xf bank_mask:0xf
    v_mul_f32_dpp v23, v39, v23 row_newbcast:11 row_mask:0xf bank_mask:0xf
    ds_read_b64_tr_b16 v[68:69], v10 offset:32768
    v_mfma_f32_32x32x16_bf16 a[112:127], v[88:91], v[12:15], a[112:127]
    v_mul_f32_dpp v24, v39, v24 row_newbcast:12 row_mask:0xf bank_mask:0xf
    v_mul_f32_dpp v25, v39, v25 row_newbcast:13 row_mask:0xf bank_mask:0xf
    v_mul_f32_dpp v26, v39, v26 row_newbcast:14 row_mask:0xf bank_mask:0xf
    v_mul_f32_dpp v27, v39, v27 row_newbcast:15 row_mask:0xf bank_mask:0xf
    ds_read_b64_tr_b16 v[70:71], v10 offset:33792
    v_mfma_f32_32x32x16_bf16 v[44:59], v[76:79], a[216:219], v[44:59]
    v_cvt_pk_bf16_f32 v16, v20, v21
    v_cvt_pk_bf16_f32 v17, v22, v23
    v_cvt_pk_bf16_f32 v18, v24, v25
    v_cvt_pk_bf16_f32 v19, v26, v27
    ds_read_b64_tr_b16 v[72:73], v11 offset:32768
    ds_read_b64_tr_b16 v[74:75], v11 offset:33792
    s_waitcnt lgkmcnt(8)
    v_mfma_f32_32x32x16_bf16 a[64:79], v[92:95], v[16:19], a[64:79]
    v_lshlrev_b32 v20, 16, v224
    v_and_b32 v21, 0xffff0000, v224
    v_lshlrev_b32 v22, 16, v225
    v_and_b32 v23, 0xffff0000, v225
    ds_read_b64_tr_b16 v[76:77], v8 offset:36864
    ds_read_b64_tr_b16 v[78:79], v8 offset:37888
    v_mfma_f32_32x32x16_bf16 a[80:95], v[96:99], v[16:19], a[80:95]
    v_lshlrev_b32 v24, 16, v226
    v_and_b32 v25, 0xffff0000, v226
    v_lshlrev_b32 v26, 16, v227
    v_and_b32 v27, 0xffff0000, v227
    ds_read_b64_tr_b16 v[80:81], v9 offset:36864
    ds_read_b64_tr_b16 v[82:83], v9 offset:37888
    v_mfma_f32_32x32x16_bf16 a[96:111], v[100:103], v[16:19], a[96:111]
    v_mul_f32_dpp v20, v40, v20 row_newbcast:0 row_mask:0xf bank_mask:0xf
    v_mul_f32_dpp v21, v40, v21 row_newbcast:1 row_mask:0xf bank_mask:0xf
    v_mul_f32_dpp v22, v40, v22 row_newbcast:2 row_mask:0xf bank_mask:0xf
    v_mul_f32_dpp v23, v40, v23 row_newbcast:3 row_mask:0xf bank_mask:0xf
    ds_read_b64_tr_b16 v[84:85], v10 offset:36864
    v_mfma_f32_32x32x16_bf16 a[112:127], v[104:107], v[16:19], a[112:127]
    v_mul_f32_dpp v24, v40, v24 row_newbcast:4 row_mask:0xf bank_mask:0xf
    v_mul_f32_dpp v25, v40, v25 row_newbcast:5 row_mask:0xf bank_mask:0xf
    v_mul_f32_dpp v26, v40, v26 row_newbcast:6 row_mask:0xf bank_mask:0xf
    v_mul_f32_dpp v27, v40, v27 row_newbcast:7 row_mask:0xf bank_mask:0xf
    ds_read_b64_tr_b16 v[86:87], v10 offset:37888
    v_mfma_f32_32x32x16_bf16 v[44:59], v[92:95], a[220:223], v[44:59]
    v_cvt_pk_bf16_f32 v12, v20, v21
    v_cvt_pk_bf16_f32 v13, v22, v23
    v_cvt_pk_bf16_f32 v14, v24, v25
    v_cvt_pk_bf16_f32 v15, v26, v27
    ds_read_b64_tr_b16 v[88:89], v11 offset:36864
    ds_read_b64_tr_b16 v[90:91], v11 offset:37888
    s_waitcnt lgkmcnt(8)
    v_mfma_f32_32x32x16_bf16 a[64:79], v[60:63], v[12:15], a[64:79]
    v_lshlrev_b32 v20, 16, v228
    v_and_b32 v21, 0xffff0000, v228
    v_lshlrev_b32 v22, 16, v229
    v_and_b32 v23, 0xffff0000, v229
    ds_read_b64_tr_b16 v[92:93], v8 offset:40960
    ds_read_b64_tr_b16 v[94:95], v8 offset:41984
    v_mfma_f32_32x32x16_bf16 a[80:95], v[64:67], v[12:15], a[80:95]
    v_lshlrev_b32 v24, 16, v230
    v_and_b32 v25, 0xffff0000, v230
    v_lshlrev_b32 v26, 16, v231
    v_and_b32 v27, 0xffff0000, v231
    ds_read_b64_tr_b16 v[96:97], v9 offset:40960
    ds_read_b64_tr_b16 v[98:99], v9 offset:41984
    v_mfma_f32_32x32x16_bf16 a[96:111], v[68:71], v[12:15], a[96:111]
    v_mul_f32_dpp v20, v40, v20 row_newbcast:8 row_mask:0xf bank_mask:0xf
    v_mul_f32_dpp v21, v40, v21 row_newbcast:9 row_mask:0xf bank_mask:0xf
    v_mul_f32_dpp v22, v40, v22 row_newbcast:10 row_mask:0xf bank_mask:0xf
    v_mul_f32_dpp v23, v40, v23 row_newbcast:11 row_mask:0xf bank_mask:0xf
    ds_read_b64_tr_b16 v[100:101], v10 offset:40960
    v_mfma_f32_32x32x16_bf16 a[112:127], v[72:75], v[12:15], a[112:127]
    v_mul_f32_dpp v24, v40, v24 row_newbcast:12 row_mask:0xf bank_mask:0xf
    v_mul_f32_dpp v25, v40, v25 row_newbcast:13 row_mask:0xf bank_mask:0xf
    v_mul_f32_dpp v26, v40, v26 row_newbcast:14 row_mask:0xf bank_mask:0xf
    v_mul_f32_dpp v27, v40, v27 row_newbcast:15 row_mask:0xf bank_mask:0xf
    ds_read_b64_tr_b16 v[102:103], v10 offset:41984
    v_mfma_f32_32x32x16_bf16 v[44:59], v[60:63], a[224:227], v[44:59]
    v_cvt_pk_bf16_f32 v16, v20, v21
    v_cvt_pk_bf16_f32 v17, v22, v23
    v_cvt_pk_bf16_f32 v18, v24, v25
    v_cvt_pk_bf16_f32 v19, v26, v27
    ds_read_b64_tr_b16 v[104:105], v11 offset:40960
    ds_read_b64_tr_b16 v[106:107], v11 offset:41984
    s_waitcnt lgkmcnt(8)
    v_mfma_f32_32x32x16_bf16 a[64:79], v[76:79], v[16:19], a[64:79]
    v_lshlrev_b32 v20, 16, v232
    v_and_b32 v21, 0xffff0000, v232
    v_lshlrev_b32 v22, 16, v233
    v_and_b32 v23, 0xffff0000, v233
    ds_read_b64_tr_b16 v[60:61], v8 offset:45056
    ds_read_b64_tr_b16 v[62:63], v8 offset:46080
    v_mfma_f32_32x32x16_bf16 a[80:95], v[80:83], v[16:19], a[80:95]
    v_lshlrev_b32 v24, 16, v234
    v_and_b32 v25, 0xffff0000, v234
    v_lshlrev_b32 v26, 16, v235
    v_and_b32 v27, 0xffff0000, v235
    ds_read_b64_tr_b16 v[64:65], v9 offset:45056
    ds_read_b64_tr_b16 v[66:67], v9 offset:46080
    v_mfma_f32_32x32x16_bf16 a[96:111], v[84:87], v[16:19], a[96:111]
    v_mul_f32_dpp v20, v41, v20 row_newbcast:0 row_mask:0xf bank_mask:0xf
    v_mul_f32_dpp v21, v41, v21 row_newbcast:1 row_mask:0xf bank_mask:0xf
    v_mul_f32_dpp v22, v41, v22 row_newbcast:2 row_mask:0xf bank_mask:0xf
    v_mul_f32_dpp v23, v41, v23 row_newbcast:3 row_mask:0xf bank_mask:0xf
    ds_read_b64_tr_b16 v[68:69], v10 offset:45056
    v_mfma_f32_32x32x16_bf16 a[112:127], v[88:91], v[16:19], a[112:127]
    v_mul_f32_dpp v24, v41, v24 row_newbcast:4 row_mask:0xf bank_mask:0xf
    v_mul_f32_dpp v25, v41, v25 row_newbcast:5 row_mask:0xf bank_mask:0xf
    v_mul_f32_dpp v26, v41, v26 row_newbcast:6 row_mask:0xf bank_mask:0xf
    v_mul_f32_dpp v27, v41, v27 row_newbcast:7 row_mask:0xf bank_mask:0xf
    ds_read_b64_tr_b16 v[70:71], v10 offset:46080
    v_mfma_f32_32x32x16_bf16 v[44:59], v[76:79], a[228:231], v[44:59]
    v_cvt_pk_bf16_f32 v12, v20, v21
    v_cvt_pk_bf16_f32 v13, v22, v23
    v_cvt_pk_bf16_f32 v14, v24, v25
    v_cvt_pk_bf16_f32 v15, v26, v27
    ds_read_b64_tr_b16 v[72:73], v11 offset:45056
    ds_read_b64_tr_b16 v[74:75], v11 offset:46080
    s_waitcnt lgkmcnt(8)
    v_mfma_f32_32x32x16_bf16 a[64:79], v[92:95], v[12:15], a[64:79]
    v_lshlrev_b32 v20, 16, v236
    v_and_b32 v21, 0xffff0000, v236
    v_lshlrev_b32 v22, 16, v237
    v_and_b32 v23, 0xffff0000, v237
    ds_read_b64_tr_b16 v[76:77], v8 offset:49152
    ds_read_b64_tr_b16 v[78:79], v8 offset:50176
    v_mfma_f32_32x32x16_bf16 a[80:95], v[96:99], v[12:15], a[80:95]
    v_lshlrev_b32 v24, 16, v238
    v_and_b32 v25, 0xffff0000, v238
    v_lshlrev_b32 v26, 16, v239
    v_and_b32 v27, 0xffff0000, v239
    ds_read_b64_tr_b16 v[80:81], v9 offset:49152
    ds_read_b64_tr_b16 v[82:83], v9 offset:50176
    v_mfma_f32_32x32x16_bf16 a[96:111], v[100:103], v[12:15], a[96:111]
    v_mul_f32_dpp v20, v41, v20 row_newbcast:8 row_mask:0xf bank_mask:0xf
    v_mul_f32_dpp v21, v41, v21 row_newbcast:9 row_mask:0xf bank_mask:0xf
    v_mul_f32_dpp v22, v41, v22 row_newbcast:10 row_mask:0xf bank_mask:0xf
    v_mul_f32_dpp v23, v41, v23 row_newbcast:11 row_mask:0xf bank_mask:0xf
    ds_read_b64_tr_b16 v[84:85], v10 offset:49152
    v_mfma_f32_32x32x16_bf16 a[112:127], v[104:107], v[12:15], a[112:127]
    v_mul_f32_dpp v24, v41, v24 row_newbcast:12 row_mask:0xf bank_mask:0xf
    v_mul_f32_dpp v25, v41, v25 row_newbcast:13 row_mask:0xf bank_mask:0xf
    v_mul_f32_dpp v26, v41, v26 row_newbcast:14 row_mask:0xf bank_mask:0xf
    v_mul_f32_dpp v27, v41, v27 row_newbcast:15 row_mask:0xf bank_mask:0xf
    ds_read_b64_tr_b16 v[86:87], v10 offset:50176
    v_mfma_f32_32x32x16_bf16 v[44:59], v[92:95], a[232:235], v[44:59]
    v_cvt_pk_bf16_f32 v16, v20, v21
    v_cvt_pk_bf16_f32 v17, v22, v23
    v_cvt_pk_bf16_f32 v18, v24, v25
    v_cvt_pk_bf16_f32 v19, v26, v27
    ds_read_b64_tr_b16 v[88:89], v11 offset:49152
    ds_read_b64_tr_b16 v[90:91], v11 offset:50176
    s_waitcnt lgkmcnt(8)
    v_mfma_f32_32x32x16_bf16 a[64:79], v[60:63], v[16:19], a[64:79]
    v_lshlrev_b32 v20, 16, v240
    v_and_b32 v21, 0xffff0000, v240
    v_lshlrev_b32 v22, 16, v241
    v_and_b32 v23, 0xffff0000, v241
    ds_read_b64_tr_b16 v[92:93], v8 offset:53248
    ds_read_b64_tr_b16 v[94:95], v8 offset:54272
    v_mfma_f32_32x32x16_bf16 a[80:95], v[64:67], v[16:19], a[80:95]
    v_lshlrev_b32 v24, 16, v242
    v_and_b32 v25, 0xffff0000, v242
    v_lshlrev_b32 v26, 16, v243
    v_and_b32 v27, 0xffff0000, v243
    ds_read_b64_tr_b16 v[96:97], v9 offset:53248
    ds_read_b64_tr_b16 v[98:99], v9 offset:54272
    v_mfma_f32_32x32x16_bf16 a[96:111], v[68:71], v[16:19], a[96:111]
    v_mul_f32_dpp v20, v42, v20 row_newbcast:0 row_mask:0xf bank_mask:0xf
    v_mul_f32_dpp v21, v42, v21 row_newbcast:1 row_mask:0xf bank_mask:0xf
    v_mul_f32_dpp v22, v42, v22 row_newbcast:2 row_mask:0xf bank_mask:0xf
    v_mul_f32_dpp v23, v42, v23 row_newbcast:3 row_mask:0xf bank_mask:0xf
    ds_read_b64_tr_b16 v[100:101], v10 offset:53248
    v_mfma_f32_32x32x16_bf16 a[112:127], v[72:75], v[16:19], a[112:127]
    v_mul_f32_dpp v24, v42, v24 row_newbcast:4 row_mask:0xf bank_mask:0xf
    v_mul_f32_dpp v25, v42, v25 row_newbcast:5 row_mask:0xf bank_mask:0xf
    v_mul_f32_dpp v26, v42, v26 row_newbcast:6 row_mask:0xf bank_mask:0xf
    v_mul_f32_dpp v27, v42, v27 row_newbcast:7 row_mask:0xf bank_mask:0xf
    ds_read_b64_tr_b16 v[102:103], v10 offset:54272
    v_mfma_f32_32x32x16_bf16 v[44:59], v[60:63], a[236:239], v[44:59]
    v_cvt_pk_bf16_f32 v12, v20, v21
    v_cvt_pk_bf16_f32 v13, v22, v23
    v_cvt_pk_bf16_f32 v14, v24, v25
    v_cvt_pk_bf16_f32 v15, v26, v27
    ds_read_b64_tr_b16 v[104:105], v11 offset:53248
    ds_read_b64_tr_b16 v[106:107], v11 offset:54272
    s_waitcnt lgkmcnt(8)
    v_mfma_f32_32x32x16_bf16 a[64:79], v[76:79], v[12:15], a[64:79]
    v_lshlrev_b32 v20, 16, v244
    v_and_b32 v21, 0xffff0000, v244
    v_lshlrev_b32 v22, 16, v245
    v_and_b32 v23, 0xffff0000, v245
    ds_read_b64_tr_b16 v[60:61], v8 offset:57344
    ds_read_b64_tr_b16 v[62:63], v8 offset:58368
    v_mfma_f32_32x32x16_bf16 a[80:95], v[80:83], v[12:15], a[80:95]
    v_lshlrev_b32 v24, 16, v246
    v_and_b32 v25, 0xffff0000, v246
    v_lshlrev_b32 v26, 16, v247
    v_and_b32 v27, 0xffff0000, v247
    ds_read_b64_tr_b16 v[64:65], v9 offset:57344
    ds_read_b64_tr_b16 v[66:67], v9 offset:58368
    v_mfma_f32_32x32x16_bf16 a[96:111], v[84:87], v[12:15], a[96:111]
    v_mul_f32_dpp v20, v42, v20 row_newbcast:8 row_mask:0xf bank_mask:0xf
    v_mul_f32_dpp v21, v42, v21 row_newbcast:9 row_mask:0xf bank_mask:0xf
    v_mul_f32_dpp v22, v42, v22 row_newbcast:10 row_mask:0xf bank_mask:0xf
    v_mul_f32_dpp v23, v42, v23 row_newbcast:11 row_mask:0xf bank_mask:0xf
    ds_read_b64_tr_b16 v[68:69], v10 offset:57344
    v_mfma_f32_32x32x16_bf16 a[112:127], v[88:91], v[12:15], a[112:127]
    v_mul_f32_dpp v24, v42, v24 row_newbcast:12 row_mask:0xf bank_mask:0xf
    v_mul_f32_dpp v25, v42, v25 row_newbcast:13 row_mask:0xf bank_mask:0xf
    v_mul_f32_dpp v26, v42, v26 row_newbcast:14 row_mask:0xf bank_mask:0xf
    v_mul_f32_dpp v27, v42, v27 row_newbcast:15 row_mask:0xf bank_mask:0xf
    ds_read_b64_tr_b16 v[70:71], v10 offset:58368
    v_mfma_f32_32x32x16_bf16 v[44:59], v[76:79], a[240:243], v[44:59]
    v_cvt_pk_bf16_f32 v16, v20, v21
    v_cvt_pk_bf16_f32 v17, v22, v23
    v_cvt_pk_bf16_f32 v18, v24, v25
    v_cvt_pk_bf16_f32 v19, v26, v27
    ds_read_b64_tr_b16 v[72:73], v11 offset:57344
    ds_read_b64_tr_b16 v[74:75], v11 offset:58368
    s_waitcnt lgkmcnt(8)
    v_mfma_f32_32x32x16_bf16 a[64:79], v[92:95], v[16:19], a[64:79]
    v_lshlrev_b32 v20, 16, v248
    v_and_b32 v21, 0xffff0000, v248
    v_lshlrev_b32 v22, 16, v249
    v_and_b32 v23, 0xffff0000, v249
    ds_read_b64_tr_b16 v[76:77], v8 offset:61440
    ds_read_b64_tr_b16 v[78:79], v8 offset:62464
    v_mfma_f32_32x32x16_bf16 a[80:95], v[96:99], v[16:19], a[80:95]
    v_lshlrev_b32 v24, 16, v250
    v_and_b32 v25, 0xffff0000, v250
    v_lshlrev_b32 v26, 16, v251
    v_and_b32 v27, 0xffff0000, v251
    ds_read_b64_tr_b16 v[80:81], v9 offset:61440
    ds_read_b64_tr_b16 v[82:83], v9 offset:62464
    v_mfma_f32_32x32x16_bf16 a[96:111], v[100:103], v[16:19], a[96:111]
    v_mul_f32_dpp v20, v43, v20 row_newbcast:0 row_mask:0xf bank_mask:0xf
    v_mul_f32_dpp v21, v43, v21 row_newbcast:1 row_mask:0xf bank_mask:0xf
    v_mul_f32_dpp v22, v43, v22 row_newbcast:2 row_mask:0xf bank_mask:0xf
    v_mul_f32_dpp v23, v43, v23 row_newbcast:3 row_mask:0xf bank_mask:0xf
    ds_read_b64_tr_b16 v[84:85], v10 offset:61440
    v_mfma_f32_32x32x16_bf16 a[112:127], v[104:107], v[16:19], a[112:127]
    v_mul_f32_dpp v24, v43, v24 row_newbcast:4 row_mask:0xf bank_mask:0xf
    v_mul_f32_dpp v25, v43, v25 row_newbcast:5 row_mask:0xf bank_mask:0xf
    v_mul_f32_dpp v26, v43, v26 row_newbcast:6 row_mask:0xf bank_mask:0xf
    v_mul_f32_dpp v27, v43, v27 row_newbcast:7 row_mask:0xf bank_mask:0xf
    ds_read_b64_tr_b16 v[86:87], v10 offset:62464
    v_mfma_f32_32x32x16_bf16 v[44:59], v[92:95], a[244:247], v[44:59]
    v_cvt_pk_bf16_f32 v12, v20, v21
    v_cvt_pk_bf16_f32 v13, v22, v23
    v_cvt_pk_bf16_f32 v14, v24, v25
    v_cvt_pk_bf16_f32 v15, v26, v27
    ds_read_b64_tr_b16 v[88:89], v11 offset:61440
    ds_read_b64_tr_b16 v[90:91], v11 offset:62464
    s_waitcnt lgkmcnt(8)
    v_mfma_f32_32x32x16_bf16 a[64:79], v[60:63], v[12:15], a[64:79]
    v_lshlrev_b32 v20, 16, v252
    v_and_b32 v21, 0xffff0000, v252
    v_lshlrev_b32 v22, 16, v253
    v_and_b32 v23, 0xffff0000, v253
    v_mfma_f32_32x32x16_bf16 a[80:95], v[64:67], v[12:15], a[80:95]
    v_lshlrev_b32 v24, 16, v254
    v_and_b32 v25, 0xffff0000, v254
    v_lshlrev_b32 v26, 16, v255
    v_and_b32 v27, 0xffff0000, v255
    v_mfma_f32_32x32x16_bf16 a[96:111], v[68:71], v[12:15], a[96:111]
    v_mul_f32_dpp v20, v43, v20 row_newbcast:8 row_mask:0xf bank_mask:0xf
    v_mul_f32_dpp v21, v43, v21 row_newbcast:9 row_mask:0xf bank_mask:0xf
    v_mul_f32_dpp v22, v43, v22 row_newbcast:10 row_mask:0xf bank_mask:0xf
    v_mul_f32_dpp v23, v43, v23 row_newbcast:11 row_mask:0xf bank_mask:0xf
    v_mfma_f32_32x32x16_bf16 a[112:127], v[72:75], v[12:15], a[112:127]
    v_mul_f32_dpp v24, v43, v24 row_newbcast:12 row_mask:0xf bank_mask:0xf
    v_mul_f32_dpp v25, v43, v25 row_newbcast:13 row_mask:0xf bank_mask:0xf
    v_mul_f32_dpp v26, v43, v26 row_newbcast:14 row_mask:0xf bank_mask:0xf
    v_mul_f32_dpp v27, v43, v27 row_newbcast:15 row_mask:0xf bank_mask:0xf
    v_mfma_f32_32x32x16_bf16 v[44:59], v[60:63], a[248:251], v[44:59]
    v_cvt_pk_bf16_f32 v16, v20, v21
    v_cvt_pk_bf16_f32 v17, v22, v23
    v_cvt_pk_bf16_f32 v18, v24, v25
    v_cvt_pk_bf16_f32 v19, v26, v27
    s_waitcnt lgkmcnt(0)
    s_nop 0
    v_mfma_f32_32x32x16_bf16 a[64:79], v[76:79], v[16:19], a[64:79]
    v_mfma_f32_32x32x16_bf16 a[80:95], v[80:83], v[16:19], a[80:95]
    v_mfma_f32_32x32x16_bf16 a[96:111], v[84:87], v[16:19], a[96:111]
    v_mfma_f32_32x32x16_bf16 a[112:127], v[88:91], v[16:19], a[112:127]
    v_mfma_f32_32x32x16_bf16 v[44:59], v[76:79], a[252:255], v[44:59]
    v_and_b32 v14, 1, v1
    v_lshlrev_b32 v14, 9, v14
    v_lshl_add_u32 v14, v3, 4, v14
    s_lshl_b32 s3, s6, 7
    s_add_u32 s3, s3, 139264
    v_add_u32 v14, s3, v14
    s_mov_b32 exec_lo, 3
    s_mov_b32 exec_hi, 3
    s_nop 7
    ds_write_b128 v14, v[44:47] offset:0
    ds_write_b128 v14, v[48:51] offset:32
    ds_write_b128 v14, v[52:55] offset:64
    ds_write_b128 v14, v[56:59] offset:96
    s_mov_b64 exec, -1
    v_accvgpr_read_b32 v60, a64
    v_accvgpr_read_b32 v61, a65
    v_accvgpr_read_b32 v62, a66
    v_accvgpr_read_b32 v63, a67
    v_accvgpr_read_b32 v64, a68
    v_accvgpr_read_b32 v65, a69
    v_accvgpr_read_b32 v66, a70
    v_accvgpr_read_b32 v67, a71
    v_accvgpr_read_b32 v68, a72
    v_accvgpr_read_b32 v69, a73
    v_accvgpr_read_b32 v70, a74
    v_accvgpr_read_b32 v71, a75
    v_accvgpr_read_b32 v72, a76
    v_accvgpr_read_b32 v73, a77
    v_accvgpr_read_b32 v74, a78
    v_accvgpr_read_b32 v75, a79
    v_accvgpr_read_b32 v76, a80
    v_accvgpr_read_b32 v77, a81
    v_accvgpr_read_b32 v78, a82
    v_accvgpr_read_b32 v79, a83
    v_accvgpr_read_b32 v80, a84
    v_accvgpr_read_b32 v81, a85
    v_accvgpr_read_b32 v82, a86
    v_accvgpr_read_b32 v83, a87
    v_accvgpr_read_b32 v84, a88
    v_accvgpr_read_b32 v85, a89
    v_accvgpr_read_b32 v86, a90
    v_accvgpr_read_b32 v87, a91
    v_accvgpr_read_b32 v88, a92
    v_accvgpr_read_b32 v89, a93
    v_accvgpr_read_b32 v90, a94
    v_accvgpr_read_b32 v91, a95
    v_accvgpr_read_b32 v92, a96
    v_accvgpr_read_b32 v93, a97
    v_accvgpr_read_b32 v94, a98
    v_accvgpr_read_b32 v95, a99
    v_accvgpr_read_b32 v96, a100
    v_accvgpr_read_b32 v97, a101
    v_accvgpr_read_b32 v98, a102
    v_accvgpr_read_b32 v99, a103
    v_accvgpr_read_b32 v100, a104
    v_accvgpr_read_b32 v101, a105
    v_accvgpr_read_b32 v102, a106
    v_accvgpr_read_b32 v103, a107
    v_accvgpr_read_b32 v104, a108
    v_accvgpr_read_b32 v105, a109
    v_accvgpr_read_b32 v106, a110
    v_accvgpr_read_b32 v107, a111
    v_accvgpr_read_b32 v108, a112
    v_accvgpr_read_b32 v109, a113
    v_accvgpr_read_b32 v110, a114
    v_accvgpr_read_b32 v111, a115
    v_accvgpr_read_b32 v112, a116
    v_accvgpr_read_b32 v113, a117
    v_accvgpr_read_b32 v114, a118
    v_accvgpr_read_b32 v115, a119
    v_accvgpr_read_b32 v116, a120
    v_accvgpr_read_b32 v117, a121
    v_accvgpr_read_b32 v118, a122
    v_accvgpr_read_b32 v119, a123
    v_accvgpr_read_b32 v120, a124
    v_accvgpr_read_b32 v121, a125
    v_accvgpr_read_b32 v122, a126
    v_accvgpr_read_b32 v123, a127
    s_waitcnt lgkmcnt(0)
    s_barrier
    s_lshl_b32 s3, s62, 7
    s_add_u32 s3, s3, 139264
    v_lshlrev_b32 v14, 4, v3
    v_add_u32 v14, s3, v14
    ds_read_b128 v[128:131], v14 offset:0
    ds_read_b128 v[144:147], v14 offset:512
    ds_read_b128 v[132:135], v14 offset:32
    ds_read_b128 v[148:151], v14 offset:544
    ds_read_b128 v[136:139], v14 offset:64
    ds_read_b128 v[152:155], v14 offset:576
    ds_read_b128 v[140:143], v14 offset:96
    ds_read_b128 v[156:159], v14 offset:608
    s_lshl_b32 s3, s63, 7
    s_add_u32 s3, s3, 139264
    v_lshlrev_b32 v14, 4, v3
    v_add_u32 v14, s3, v14
    ds_read_b128 v[160:163], v14 offset:0
    ds_read_b128 v[176:179], v14 offset:512
    ds_read_b128 v[164:167], v14 offset:32
    ds_read_b128 v[180:183], v14 offset:544
    ds_read_b128 v[168:171], v14 offset:64
    ds_read_b128 v[184:187], v14 offset:576
    ds_read_b128 v[172:175], v14 offset:96
    ds_read_b128 v[188:191], v14 offset:608
    s_waitcnt lgkmcnt(8)
    v_pk_fma_f32 v[128:129], v[128:129], v[4:5], v[144:145] op_sel:[0,1,0] op_sel_hi:[1,1,1]
    v_pk_fma_f32 v[130:131], v[130:131], v[4:5], v[146:147] op_sel:[0,1,0] op_sel_hi:[1,1,1]
    v_pk_fma_f32 v[132:133], v[132:133], v[4:5], v[148:149] op_sel:[0,1,0] op_sel_hi:[1,1,1]
    v_pk_fma_f32 v[134:135], v[134:135], v[4:5], v[150:151] op_sel:[0,1,0] op_sel_hi:[1,1,1]
    v_pk_fma_f32 v[136:137], v[136:137], v[4:5], v[152:153] op_sel:[0,1,0] op_sel_hi:[1,1,1]
    v_pk_fma_f32 v[138:139], v[138:139], v[4:5], v[154:155] op_sel:[0,1,0] op_sel_hi:[1,1,1]
    v_pk_fma_f32 v[140:141], v[140:141], v[4:5], v[156:157] op_sel:[0,1,0] op_sel_hi:[1,1,1]
    v_pk_fma_f32 v[142:143], v[142:143], v[4:5], v[158:159] op_sel:[0,1,0] op_sel_hi:[1,1,1]
    v_pk_fma_f32 v[60:61], v[60:61], v[4:5], v[128:129] op_sel_hi:[1,0,1]
    v_pk_fma_f32 v[62:63], v[62:63], v[4:5], v[130:131] op_sel_hi:[1,0,1]
    v_pk_fma_f32 v[64:65], v[64:65], v[4:5], v[132:133] op_sel_hi:[1,0,1]
    v_pk_fma_f32 v[66:67], v[66:67], v[4:5], v[134:135] op_sel_hi:[1,0,1]
    v_pk_fma_f32 v[68:69], v[68:69], v[4:5], v[136:137] op_sel_hi:[1,0,1]
    v_pk_fma_f32 v[70:71], v[70:71], v[4:5], v[138:139] op_sel_hi:[1,0,1]
    v_pk_fma_f32 v[72:73], v[72:73], v[4:5], v[140:141] op_sel_hi:[1,0,1]
    v_pk_fma_f32 v[74:75], v[74:75], v[4:5], v[142:143] op_sel_hi:[1,0,1]
    s_lshl_b32 s3, s64, 7
    s_add_u32 s3, s3, 139264
    v_lshlrev_b32 v14, 4, v3
    v_add_u32 v14, s3, v14
    ds_read_b128 v[128:131], v14 offset:0
    ds_read_b128 v[144:147], v14 offset:512
    ds_read_b128 v[132:135], v14 offset:32
    ds_read_b128 v[148:151], v14 offset:544
    ds_read_b128 v[136:139], v14 offset:64
    ds_read_b128 v[152:155], v14 offset:576
    ds_read_b128 v[140:143], v14 offset:96
    ds_read_b128 v[156:159], v14 offset:608
    s_waitcnt lgkmcnt(8)
    v_pk_fma_f32 v[160:161], v[160:161], v[4:5], v[176:177] op_sel:[0,1,0] op_sel_hi:[1,1,1]
    v_pk_fma_f32 v[162:163], v[162:163], v[4:5], v[178:179] op_sel:[0,1,0] op_sel_hi:[1,1,1]
    v_pk_fma_f32 v[164:165], v[164:165], v[4:5], v[180:181] op_sel:[0,1,0] op_sel_hi:[1,1,1]
    v_pk_fma_f32 v[166:167], v[166:167], v[4:5], v[182:183] op_sel:[0,1,0] op_sel_hi:[1,1,1]
    v_pk_fma_f32 v[168:169], v[168:169], v[4:5], v[184:185] op_sel:[0,1,0] op_sel_hi:[1,1,1]
    v_pk_fma_f32 v[170:171], v[170:171], v[4:5], v[186:187] op_sel:[0,1,0] op_sel_hi:[1,1,1]
    v_pk_fma_f32 v[172:173], v[172:173], v[4:5], v[188:189] op_sel:[0,1,0] op_sel_hi:[1,1,1]
    v_pk_fma_f32 v[174:175], v[174:175], v[4:5], v[190:191] op_sel:[0,1,0] op_sel_hi:[1,1,1]
    v_pk_fma_f32 v[76:77], v[76:77], v[4:5], v[160:161] op_sel_hi:[1,0,1]
    v_pk_fma_f32 v[78:79], v[78:79], v[4:5], v[162:163] op_sel_hi:[1,0,1]
    v_pk_fma_f32 v[80:81], v[80:81], v[4:5], v[164:165] op_sel_hi:[1,0,1]
    v_pk_fma_f32 v[82:83], v[82:83], v[4:5], v[166:167] op_sel_hi:[1,0,1]
    v_pk_fma_f32 v[84:85], v[84:85], v[4:5], v[168:169] op_sel_hi:[1,0,1]
    v_pk_fma_f32 v[86:87], v[86:87], v[4:5], v[170:171] op_sel_hi:[1,0,1]
    v_pk_fma_f32 v[88:89], v[88:89], v[4:5], v[172:173] op_sel_hi:[1,0,1]
    v_pk_fma_f32 v[90:91], v[90:91], v[4:5], v[174:175] op_sel_hi:[1,0,1]
    s_lshl_b32 s3, s65, 7
    s_add_u32 s3, s3, 139264
    v_lshlrev_b32 v14, 4, v3
    v_add_u32 v14, s3, v14
    ds_read_b128 v[160:163], v14 offset:0
    ds_read_b128 v[176:179], v14 offset:512
    ds_read_b128 v[164:167], v14 offset:32
    ds_read_b128 v[180:183], v14 offset:544
    ds_read_b128 v[168:171], v14 offset:64
    ds_read_b128 v[184:187], v14 offset:576
    ds_read_b128 v[172:175], v14 offset:96
    ds_read_b128 v[188:191], v14 offset:608
    s_waitcnt lgkmcnt(8)
    v_pk_fma_f32 v[128:129], v[128:129], v[4:5], v[144:145] op_sel:[0,1,0] op_sel_hi:[1,1,1]
    v_pk_fma_f32 v[130:131], v[130:131], v[4:5], v[146:147] op_sel:[0,1,0] op_sel_hi:[1,1,1]
    v_pk_fma_f32 v[132:133], v[132:133], v[4:5], v[148:149] op_sel:[0,1,0] op_sel_hi:[1,1,1]
    v_pk_fma_f32 v[134:135], v[134:135], v[4:5], v[150:151] op_sel:[0,1,0] op_sel_hi:[1,1,1]
    v_pk_fma_f32 v[136:137], v[136:137], v[4:5], v[152:153] op_sel:[0,1,0] op_sel_hi:[1,1,1]
    v_pk_fma_f32 v[138:139], v[138:139], v[4:5], v[154:155] op_sel:[0,1,0] op_sel_hi:[1,1,1]
    v_pk_fma_f32 v[140:141], v[140:141], v[4:5], v[156:157] op_sel:[0,1,0] op_sel_hi:[1,1,1]
    v_pk_fma_f32 v[142:143], v[142:143], v[4:5], v[158:159] op_sel:[0,1,0] op_sel_hi:[1,1,1]
    v_pk_fma_f32 v[92:93], v[92:93], v[4:5], v[128:129] op_sel_hi:[1,0,1]
    v_pk_fma_f32 v[94:95], v[94:95], v[4:5], v[130:131] op_sel_hi:[1,0,1]
    v_pk_fma_f32 v[96:97], v[96:97], v[4:5], v[132:133] op_sel_hi:[1,0,1]
    v_pk_fma_f32 v[98:99], v[98:99], v[4:5], v[134:135] op_sel_hi:[1,0,1]
    v_pk_fma_f32 v[100:101], v[100:101], v[4:5], v[136:137] op_sel_hi:[1,0,1]
    v_pk_fma_f32 v[102:103], v[102:103], v[4:5], v[138:139] op_sel_hi:[1,0,1]
    v_pk_fma_f32 v[104:105], v[104:105], v[4:5], v[140:141] op_sel_hi:[1,0,1]
    v_pk_fma_f32 v[106:107], v[106:107], v[4:5], v[142:143] op_sel_hi:[1,0,1]
    s_waitcnt lgkmcnt(0)
    v_pk_fma_f32 v[160:161], v[160:161], v[4:5], v[176:177] op_sel:[0,1,0] op_sel_hi:[1,1,1]
    v_pk_fma_f32 v[162:163], v[162:163], v[4:5], v[178:179] op_sel:[0,1,0] op_sel_hi:[1,1,1]
    v_pk_fma_f32 v[164:165], v[164:165], v[4:5], v[180:181] op_sel:[0,1,0] op_sel_hi:[1,1,1]
    v_pk_fma_f32 v[166:167], v[166:167], v[4:5], v[182:183] op_sel:[0,1,0] op_sel_hi:[1,1,1]
    v_pk_fma_f32 v[168:169], v[168:169], v[4:5], v[184:185] op_sel:[0,1,0] op_sel_hi:[1,1,1]
    v_pk_fma_f32 v[170:171], v[170:171], v[4:5], v[186:187] op_sel:[0,1,0] op_sel_hi:[1,1,1]
    v_pk_fma_f32 v[172:173], v[172:173], v[4:5], v[188:189] op_sel:[0,1,0] op_sel_hi:[1,1,1]
    v_pk_fma_f32 v[174:175], v[174:175], v[4:5], v[190:191] op_sel:[0,1,0] op_sel_hi:[1,1,1]
    v_pk_fma_f32 v[108:109], v[108:109], v[4:5], v[160:161] op_sel_hi:[1,0,1]
    v_pk_fma_f32 v[110:111], v[110:111], v[4:5], v[162:163] op_sel_hi:[1,0,1]
    v_pk_fma_f32 v[112:113], v[112:113], v[4:5], v[164:165] op_sel_hi:[1,0,1]
    v_pk_fma_f32 v[114:115], v[114:115], v[4:5], v[166:167] op_sel_hi:[1,0,1]
    v_pk_fma_f32 v[116:117], v[116:117], v[4:5], v[168:169] op_sel_hi:[1,0,1]
    v_pk_fma_f32 v[118:119], v[118:119], v[4:5], v[170:171] op_sel_hi:[1,0,1]
    v_pk_fma_f32 v[120:121], v[120:121], v[4:5], v[172:173] op_sel_hi:[1,0,1]
    v_pk_fma_f32 v[122:123], v[122:123], v[4:5], v[174:175] op_sel_hi:[1,0,1]
    s_lshl_b32 s55, s53, 2
    s_add_u32 s55, s55, s6
    s_lshr_b32 s3, s54, 2
    s_lshl_b32 s56, s3, 21
    s_add_u32 s56, s56, 2097152
    s_and_b32 s59, s54, 3
    s_lshl_b32 s57, s59, 19
    s_add_u32 s56, s56, s57
    s_lshl_b32 s57, s55, 10
    s_add_u32 s56, s56, s57
    v_lshlrev_b32 v8, 4, v1
    s_cmp_lt_u32 s54, 4
    s_cselect_b32 s58, 0x3eb8aa3b, 1.0
    v_pk_mul_f32 v[60:61], v[60:61], s[58:59] op_sel_hi:[1,0]
    v_pk_mul_f32 v[62:63], v[62:63], s[58:59] op_sel_hi:[1,0]
    v_pk_mul_f32 v[64:65], v[64:65], s[58:59] op_sel_hi:[1,0]
    v_pk_mul_f32 v[66:67], v[66:67], s[58:59] op_sel_hi:[1,0]
    v_cvt_pk_bf16_f32 v128, v60, v61
    v_cvt_pk_bf16_f32 v129, v62, v63
    v_cvt_pk_bf16_f32 v130, v64, v65
    v_cvt_pk_bf16_f32 v131, v66, v67
    s_nop 0
    v_permlane32_swap_b32 v128, v130
    v_permlane32_swap_b32 v129, v131
    s_lshl_b32 s57, s62, 17
    s_add_u32 s57, s57, s56
    s_add_u32 s57, s57, 0
    buffer_store_dwordx4 v[128:131], v8, s[48:51], s57 offen sc1
    v_pk_mul_f32 v[68:69], v[68:69], s[58:59] op_sel_hi:[1,0]
    v_pk_mul_f32 v[70:71], v[70:71], s[58:59] op_sel_hi:[1,0]
    v_pk_mul_f32 v[72:73], v[72:73], s[58:59] op_sel_hi:[1,0]
    v_pk_mul_f32 v[74:75], v[74:75], s[58:59] op_sel_hi:[1,0]
    v_cvt_pk_bf16_f32 v132, v68, v69
    v_cvt_pk_bf16_f32 v133, v70, v71
    v_cvt_pk_bf16_f32 v134, v72, v73
    v_cvt_pk_bf16_f32 v135, v74, v75
    s_nop 0
    v_permlane32_swap_b32 v132, v134
    v_permlane32_swap_b32 v133, v135
    s_lshl_b32 s57, s62, 17
    s_add_u32 s57, s57, s56
    s_add_u32 s57, s57, 65536
    buffer_store_dwordx4 v[132:135], v8, s[48:51], s57 offen sc1
    v_pk_mul_f32 v[76:77], v[76:77], s[58:59] op_sel_hi:[1,0]
    v_pk_mul_f32 v[78:79], v[78:79], s[58:59] op_sel_hi:[1,0]
    v_pk_mul_f32 v[80:81], v[80:81], s[58:59] op_sel_hi:[1,0]
    v_pk_mul_f32 v[82:83], v[82:83], s[58:59] op_sel_hi:[1,0]
    v_cvt_pk_bf16_f32 v136, v76, v77
    v_cvt_pk_bf16_f32 v137, v78, v79
    v_cvt_pk_bf16_f32 v138, v80, v81
    v_cvt_pk_bf16_f32 v139, v82, v83
    s_nop 0
    v_permlane32_swap_b32 v136, v138
    v_permlane32_swap_b32 v137, v139
    s_lshl_b32 s57, s63, 17
    s_add_u32 s57, s57, s56
    s_add_u32 s57, s57, 0
    buffer_store_dwordx4 v[136:139], v8, s[48:51], s57 offen sc1
    v_pk_mul_f32 v[84:85], v[84:85], s[58:59] op_sel_hi:[1,0]
    v_pk_mul_f32 v[86:87], v[86:87], s[58:59] op_sel_hi:[1,0]
    v_pk_mul_f32 v[88:89], v[88:89], s[58:59] op_sel_hi:[1,0]
    v_pk_mul_f32 v[90:91], v[90:91], s[58:59] op_sel_hi:[1,0]
    v_cvt_pk_bf16_f32 v140, v84, v85
    v_cvt_pk_bf16_f32 v141, v86, v87
    v_cvt_pk_bf16_f32 v142, v88, v89
    v_cvt_pk_bf16_f32 v143, v90, v91
    s_nop 0
    v_permlane32_swap_b32 v140, v142
    v_permlane32_swap_b32 v141, v143
    s_lshl_b32 s57, s63, 17
    s_add_u32 s57, s57, s56
    s_add_u32 s57, s57, 65536
    buffer_store_dwordx4 v[140:143], v8, s[48:51], s57 offen sc1
    v_pk_mul_f32 v[92:93], v[92:93], s[58:59] op_sel_hi:[1,0]
    v_pk_mul_f32 v[94:95], v[94:95], s[58:59] op_sel_hi:[1,0]
    v_pk_mul_f32 v[96:97], v[96:97], s[58:59] op_sel_hi:[1,0]
    v_pk_mul_f32 v[98:99], v[98:99], s[58:59] op_sel_hi:[1,0]
    v_cvt_pk_bf16_f32 v144, v92, v93
    v_cvt_pk_bf16_f32 v145, v94, v95
    v_cvt_pk_bf16_f32 v146, v96, v97
    v_cvt_pk_bf16_f32 v147, v98, v99
    s_nop 0
    v_permlane32_swap_b32 v144, v146
    v_permlane32_swap_b32 v145, v147
    s_lshl_b32 s57, s64, 17
    s_add_u32 s57, s57, s56
    s_add_u32 s57, s57, 0
    buffer_store_dwordx4 v[144:147], v8, s[48:51], s57 offen sc1
    v_pk_mul_f32 v[100:101], v[100:101], s[58:59] op_sel_hi:[1,0]
    v_pk_mul_f32 v[102:103], v[102:103], s[58:59] op_sel_hi:[1,0]
    v_pk_mul_f32 v[104:105], v[104:105], s[58:59] op_sel_hi:[1,0]
    v_pk_mul_f32 v[106:107], v[106:107], s[58:59] op_sel_hi:[1,0]
    v_cvt_pk_bf16_f32 v148, v100, v101
    v_cvt_pk_bf16_f32 v149, v102, v103
    v_cvt_pk_bf16_f32 v150, v104, v105
    v_cvt_pk_bf16_f32 v151, v106, v107
    s_nop 0
    v_permlane32_swap_b32 v148, v150
    v_permlane32_swap_b32 v149, v151
    s_lshl_b32 s57, s64, 17
    s_add_u32 s57, s57, s56
    s_add_u32 s57, s57, 65536
    buffer_store_dwordx4 v[148:151], v8, s[48:51], s57 offen sc1
    v_pk_mul_f32 v[108:109], v[108:109], s[58:59] op_sel_hi:[1,0]
    v_pk_mul_f32 v[110:111], v[110:111], s[58:59] op_sel_hi:[1,0]
    v_pk_mul_f32 v[112:113], v[112:113], s[58:59] op_sel_hi:[1,0]
    v_pk_mul_f32 v[114:115], v[114:115], s[58:59] op_sel_hi:[1,0]
    v_cvt_pk_bf16_f32 v152, v108, v109
    v_cvt_pk_bf16_f32 v153, v110, v111
    v_cvt_pk_bf16_f32 v154, v112, v113
    v_cvt_pk_bf16_f32 v155, v114, v115
    s_nop 0
    v_permlane32_swap_b32 v152, v154
    v_permlane32_swap_b32 v153, v155
    s_lshl_b32 s57, s65, 17
    s_add_u32 s57, s57, s56
    s_add_u32 s57, s57, 0
    buffer_store_dwordx4 v[152:155], v8, s[48:51], s57 offen sc1
    v_pk_mul_f32 v[116:117], v[116:117], s[58:59] op_sel_hi:[1,0]
    v_pk_mul_f32 v[118:119], v[118:119], s[58:59] op_sel_hi:[1,0]
    v_pk_mul_f32 v[120:121], v[120:121], s[58:59] op_sel_hi:[1,0]
    v_pk_mul_f32 v[122:123], v[122:123], s[58:59] op_sel_hi:[1,0]
    v_cvt_pk_bf16_f32 v156, v116, v117
    v_cvt_pk_bf16_f32 v157, v118, v119
    v_cvt_pk_bf16_f32 v158, v120, v121
    v_cvt_pk_bf16_f32 v159, v122, v123
    s_nop 0
    v_permlane32_swap_b32 v156, v158
    v_permlane32_swap_b32 v157, v159
    s_lshl_b32 s57, s65, 17
    s_add_u32 s57, s57, s56
    s_add_u32 s57, s57, 65536
    buffer_store_dwordx4 v[156:159], v8, s[48:51], s57 offen sc1
    v_mov_b32 v36, 0
    v_mov_b32 v37, 0
    v_mov_b32 v38, 0
    v_mov_b32 v39, 0
    v_mov_b32 v40, 0
    v_mov_b32 v41, 0
    v_mov_b32 v42, 0
    v_mov_b32 v43, 0
    v_dot2_f32_bf16 v36, v128, v128, v36
    v_dot2_f32_bf16 v37, v132, v132, v37
    v_dot2_f32_bf16 v38, v136, v136, v38
    v_dot2_f32_bf16 v39, v140, v140, v39
    v_dot2_f32_bf16 v40, v144, v144, v40
    v_dot2_f32_bf16 v41, v148, v148, v41
    v_dot2_f32_bf16 v42, v152, v152, v42
    v_dot2_f32_bf16 v43, v156, v156, v43
    v_dot2_f32_bf16 v36, v129, v129, v36
    v_dot2_f32_bf16 v37, v133, v133, v37
    v_dot2_f32_bf16 v38, v137, v137, v38
    v_dot2_f32_bf16 v39, v141, v141, v39
    v_dot2_f32_bf16 v40, v145, v145, v40
    v_dot2_f32_bf16 v41, v149, v149, v41
    v_dot2_f32_bf16 v42, v153, v153, v42
    v_dot2_f32_bf16 v43, v157, v157, v43
    v_dot2_f32_bf16 v36, v130, v130, v36
    v_dot2_f32_bf16 v37, v134, v134, v37
    v_dot2_f32_bf16 v38, v138, v138, v38
    v_dot2_f32_bf16 v39, v142, v142, v39
    v_dot2_f32_bf16 v40, v146, v146, v40
    v_dot2_f32_bf16 v41, v150, v150, v41
    v_dot2_f32_bf16 v42, v154, v154, v42
    v_dot2_f32_bf16 v43, v158, v158, v43
    v_dot2_f32_bf16 v36, v131, v131, v36
    v_dot2_f32_bf16 v37, v135, v135, v37
    v_dot2_f32_bf16 v38, v139, v139, v38
    v_dot2_f32_bf16 v39, v143, v143, v39
    v_dot2_f32_bf16 v40, v147, v147, v40
    v_dot2_f32_bf16 v41, v151, v151, v41
    v_dot2_f32_bf16 v42, v155, v155, v42
    v_dot2_f32_bf16 v43, v159, v159, v43
    s_nop 2
    v_mov_b32 v44, v36
    v_mov_b32 v45, v37
    v_mov_b32 v46, v38
    v_mov_b32 v47, v39
    v_mov_b32 v48, v40
    v_mov_b32 v49, v41
    v_mov_b32 v50, v42
    v_mov_b32 v51, v43
    v_permlane32_swap_b32 v36, v44
    v_permlane32_swap_b32 v37, v45
    v_permlane32_swap_b32 v38, v46
    v_permlane32_swap_b32 v39, v47
    v_permlane32_swap_b32 v40, v48
    v_permlane32_swap_b32 v41, v49
    v_permlane32_swap_b32 v42, v50
    v_permlane32_swap_b32 v43, v51
    v_add_f32 v36, v36, v44
    v_add_f32 v37, v37, v45
    v_add_f32 v38, v38, v46
    v_add_f32 v39, v39, v47
    v_add_f32 v40, v40, v48
    v_add_f32 v41, v41, v49
    v_add_f32 v42, v42, v50
    v_add_f32 v43, v43, v51
    v_max_f32_dpp v36, v36, v36 row_ror:1 row_mask:0xf bank_mask:0xf
    v_max_f32_dpp v37, v37, v37 row_ror:1 row_mask:0xf bank_mask:0xf
    v_max_f32_dpp v38, v38, v38 row_ror:1 row_mask:0xf bank_mask:0xf
    v_max_f32_dpp v39, v39, v39 row_ror:1 row_mask:0xf bank_mask:0xf
    v_max_f32_dpp v40, v40, v40 row_ror:1 row_mask:0xf bank_mask:0xf
    v_max_f32_dpp v41, v41, v41 row_ror:1 row_mask:0xf bank_mask:0xf
    v_max_f32_dpp v42, v42, v42 row_ror:1 row_mask:0xf bank_mask:0xf
    v_max_f32_dpp v43, v43, v43 row_ror:1 row_mask:0xf bank_mask:0xf
    v_max_f32_dpp v36, v36, v36 row_ror:2 row_mask:0xf bank_mask:0xf
    v_max_f32_dpp v37, v37, v37 row_ror:2 row_mask:0xf bank_mask:0xf
    v_max_f32_dpp v38, v38, v38 row_ror:2 row_mask:0xf bank_mask:0xf
    v_max_f32_dpp v39, v39, v39 row_ror:2 row_mask:0xf bank_mask:0xf
    v_max_f32_dpp v40, v40, v40 row_ror:2 row_mask:0xf bank_mask:0xf
    v_max_f32_dpp v41, v41, v41 row_ror:2 row_mask:0xf bank_mask:0xf
    v_max_f32_dpp v42, v42, v42 row_ror:2 row_mask:0xf bank_mask:0xf
    v_max_f32_dpp v43, v43, v43 row_ror:2 row_mask:0xf bank_mask:0xf
    v_max_f32_dpp v36, v36, v36 row_ror:4 row_mask:0xf bank_mask:0xf
    v_max_f32_dpp v37, v37, v37 row_ror:4 row_mask:0xf bank_mask:0xf
    v_max_f32_dpp v38, v38, v38 row_ror:4 row_mask:0xf bank_mask:0xf
    v_max_f32_dpp v39, v39, v39 row_ror:4 row_mask:0xf bank_mask:0xf
    v_max_f32_dpp v40, v40, v40 row_ror:4 row_mask:0xf bank_mask:0xf
    v_max_f32_dpp v41, v41, v41 row_ror:4 row_mask:0xf bank_mask:0xf
    v_max_f32_dpp v42, v42, v42 row_ror:4 row_mask:0xf bank_mask:0xf
    v_max_f32_dpp v43, v43, v43 row_ror:4 row_mask:0xf bank_mask:0xf
    v_max_f32_dpp v36, v36, v36 row_ror:8 row_mask:0xf bank_mask:0xf
    v_max_f32_dpp v37, v37, v37 row_ror:8 row_mask:0xf bank_mask:0xf
    v_max_f32_dpp v38, v38, v38 row_ror:8 row_mask:0xf bank_mask:0xf
    v_max_f32_dpp v39, v39, v39 row_ror:8 row_mask:0xf bank_mask:0xf
    v_max_f32_dpp v40, v40, v40 row_ror:8 row_mask:0xf bank_mask:0xf
    v_max_f32_dpp v41, v41, v41 row_ror:8 row_mask:0xf bank_mask:0xf
    v_max_f32_dpp v42, v42, v42 row_ror:8 row_mask:0xf bank_mask:0xf
    v_max_f32_dpp v43, v43, v43 row_ror:8 row_mask:0xf bank_mask:0xf
    v_mov_b32 v44, v36
    v_mov_b32 v45, v37
    v_mov_b32 v46, v38
    v_mov_b32 v47, v39
    v_mov_b32 v48, v40
    v_mov_b32 v49, v41
    v_mov_b32 v50, v42
    v_mov_b32 v51, v43
    v_permlane16_swap_b32 v36, v44
    v_permlane16_swap_b32 v37, v45
    v_permlane16_swap_b32 v38, v46
    v_permlane16_swap_b32 v39, v47
    v_permlane16_swap_b32 v40, v48
    v_permlane16_swap_b32 v41, v49
    v_permlane16_swap_b32 v42, v50
    v_permlane16_swap_b32 v43, v51
    v_max_f32 v36, v36, v44
    v_max_f32 v37, v37, v45
    v_max_f32 v38, v38, v46
    v_max_f32 v39, v39, v47
    v_max_f32 v40, v40, v48
    v_max_f32 v41, v41, v49
    v_max_f32 v42, v42, v50
    v_max_f32 v43, v43, v51
    v_cmp_eq_u32 vcc, 1, v1
    s_nop 1
    v_cndmask_b32 v36, v36, v37, vcc
    v_cmp_eq_u32 vcc, 2, v1
    s_nop 1
    v_cndmask_b32 v36, v36, v38, vcc
    v_cmp_eq_u32 vcc, 3, v1
    s_nop 1
    v_cndmask_b32 v36, v36, v39, vcc
    v_cmp_eq_u32 vcc, 4, v1
    s_nop 1
    v_cndmask_b32 v36, v36, v40, vcc
    v_cmp_eq_u32 vcc, 5, v1
    s_nop 1
    v_cndmask_b32 v36, v36, v41, vcc
    v_cmp_eq_u32 vcc, 6, v1
    s_nop 1
    v_cndmask_b32 v36, v36, v42, vcc
    v_cmp_eq_u32 vcc, 7, v1
    s_nop 1
    v_cndmask_b32 v36, v36, v43, vcc
    v_lshrrev_b32 v10, 1, v1
    v_add_u32 v10, s6, v10
    v_and_b32 v10, 3, v10
    v_lshlrev_b32 v10, 1, v10
    v_and_b32 v11, 1, v1
    v_add_u32 v10, v10, v11
    v_lshlrev_b32 v10, 8, v10
    s_lshr_b32 s3, s54, 2
    s_lshl_b32 s57, s3, 13
    s_lshl_b32 s3, s59, 11
    s_add_u32 s57, s57, s3
    s_lshl_b32 s3, s55, 2
    s_add_u32 s57, s57, s3
    s_add_u32 s57, s57, 294912
    s_mov_b64 exec, 255
    buffer_store_dword v36, v10, s[48:51], s57 offen sc1
    s_mov_b64 exec, -1
    s_branch P1SIG
P1V:
    ds_read_b64_tr_b16 v[60:61], v8 offset:0
    ds_read_b64_tr_b16 v[62:63], v8 offset:1024
    ds_read_b64_tr_b16 v[64:65], v9 offset:0
    ds_read_b64_tr_b16 v[66:67], v9 offset:1024
    ds_read_b64_tr_b16 v[68:69], v10 offset:0
    ds_read_b64_tr_b16 v[70:71], v10 offset:1024
    ds_read_b64_tr_b16 v[72:73], v11 offset:0
    ds_read_b64_tr_b16 v[74:75], v11 offset:1024
    ds_read_b64_tr_b16 v[76:77], v8 offset:4096
    ds_read_b64_tr_b16 v[78:79], v8 offset:5120
    ds_read_b64_tr_b16 v[80:81], v9 offset:4096
    ds_read_b64_tr_b16 v[82:83], v9 offset:5120
    ds_read_b64_tr_b16 v[84:85], v10 offset:4096
    ds_read_b64_tr_b16 v[86:87], v10 offset:5120
    ds_read_b64_tr_b16 v[88:89], v11 offset:4096
    ds_read_b64_tr_b16 v[90:91], v11 offset:5120
    v_lshlrev_b32 v20, 16, v128
    v_and_b32 v21, 0xffff0000, v128
    v_lshlrev_b32 v22, 16, v129
    v_and_b32 v23, 0xffff0000, v129
    v_lshlrev_b32 v24, 16, v130
    v_and_b32 v25, 0xffff0000, v130
    v_lshlrev_b32 v26, 16, v131
    v_and_b32 v27, 0xffff0000, v131
    s_waitcnt lgkmcnt(15)
    v_mul_f32_dpp v20, v28, v20 row_newbcast:0 row_mask:0xf bank_mask:0xf
    v_mul_f32_dpp v21, v28, v21 row_newbcast:1 row_mask:0xf bank_mask:0xf
    v_mul_f32_dpp v22, v28, v22 row_newbcast:2 row_mask:0xf bank_mask:0xf
    v_mul_f32_dpp v23, v28, v23 row_newbcast:3 row_mask:0xf bank_mask:0xf
    v_mul_f32_dpp v24, v28, v24 row_newbcast:4 row_mask:0xf bank_mask:0xf
    v_mul_f32_dpp v25, v28, v25 row_newbcast:5 row_mask:0xf bank_mask:0xf
    v_mul_f32_dpp v26, v28, v26 row_newbcast:6 row_mask:0xf bank_mask:0xf
    v_mul_f32_dpp v27, v28, v27 row_newbcast:7 row_mask:0xf bank_mask:0xf
    v_cvt_pk_bf16_f32 v12, v20, v21
    v_cvt_pk_bf16_f32 v13, v22, v23
    v_cvt_pk_bf16_f32 v14, v24, v25
    v_cvt_pk_bf16_f32 v15, v26, v27
    s_waitcnt lgkmcnt(8)
    s_nop 0
    v_mfma_f32_32x32x16_bf16 a[64:79], v[12:15], v[60:63], 0
    v_lshlrev_b32 v20, 16, v132
    v_and_b32 v21, 0xffff0000, v132
    v_lshlrev_b32 v22, 16, v133
    v_and_b32 v23, 0xffff0000, v133
    ds_read_b64_tr_b16 v[92:93], v8 offset:8192
    ds_read_b64_tr_b16 v[94:95], v8 offset:9216
    v_mfma_f32_32x32x16_bf16 a[80:95], v[12:15], v[64:67], 0
    s_add_u32 m0, s57, 98304
    s_add_u32 s3, s56, 1179648
    buffer_load_dwordx4 v120, s[12:15], s3 offen lds
    v_lshlrev_b32 v24, 16, v134
    v_and_b32 v25, 0xffff0000, v134
    v_lshlrev_b32 v26, 16, v135
    v_and_b32 v27, 0xffff0000, v135
    ds_read_b64_tr_b16 v[96:97], v9 offset:8192
    ds_read_b64_tr_b16 v[98:99], v9 offset:9216
    v_mfma_f32_32x32x16_bf16 a[96:111], v[12:15], v[68:71], 0
    v_mul_f32_dpp v20, v28, v20 row_newbcast:8 row_mask:0xf bank_mask:0xf
    v_mul_f32_dpp v21, v28, v21 row_newbcast:9 row_mask:0xf bank_mask:0xf
    v_mul_f32_dpp v22, v28, v22 row_newbcast:10 row_mask:0xf bank_mask:0xf
    v_mul_f32_dpp v23, v28, v23 row_newbcast:11 row_mask:0xf bank_mask:0xf
    ds_read_b64_tr_b16 v[100:101], v10 offset:8192
    v_mfma_f32_32x32x16_bf16 a[112:127], v[12:15], v[72:75], 0
    v_mul_f32_dpp v24, v28, v24 row_newbcast:12 row_mask:0xf bank_mask:0xf
    v_mul_f32_dpp v25, v28, v25 row_newbcast:13 row_mask:0xf bank_mask:0xf
    v_mul_f32_dpp v26, v28, v26 row_newbcast:14 row_mask:0xf bank_mask:0xf
    v_mul_f32_dpp v27, v28, v27 row_newbcast:15 row_mask:0xf bank_mask:0xf
    ds_read_b64_tr_b16 v[102:103], v10 offset:9216
    v_mfma_f32_32x32x16_bf16 v[44:59], v[60:63], a[128:131], 0
    v_cvt_pk_bf16_f32 v16, v20, v21
    v_cvt_pk_bf16_f32 v17, v22, v23
    v_cvt_pk_bf16_f32 v18, v24, v25
    v_cvt_pk_bf16_f32 v19, v26, v27
    ds_read_b64_tr_b16 v[104:105], v11 offset:8192
    ds_read_b64_tr_b16 v[106:107], v11 offset:9216
    s_waitcnt lgkmcnt(8)
    v_mfma_f32_32x32x16_bf16 a[64:79], v[16:19], v[76:79], a[64:79]
    v_lshlrev_b32 v20, 16, v136
    v_and_b32 v21, 0xffff0000, v136
    v_lshlrev_b32 v22, 16, v137
    v_and_b32 v23, 0xffff0000, v137
    ds_read_b64_tr_b16 v[60:61], v8 offset:12288
    ds_read_b64_tr_b16 v[62:63], v8 offset:13312
    v_mfma_f32_32x32x16_bf16 a[80:95], v[16:19], v[80:83], a[80:95]
    s_add_u32 m0, s57, 99328
    s_add_u32 s3, s56, 1191936
    buffer_load_dwordx4 v120, s[12:15], s3 offen lds
    v_lshlrev_b32 v24, 16, v138
    v_and_b32 v25, 0xffff0000, v138
    v_lshlrev_b32 v26, 16, v139
    v_and_b32 v27, 0xffff0000, v139
    ds_read_b64_tr_b16 v[64:65], v9 offset:12288
    ds_read_b64_tr_b16 v[66:67], v9 offset:13312
    v_mfma_f32_32x32x16_bf16 a[96:111], v[16:19], v[84:87], a[96:111]
    v_mul_f32_dpp v20, v29, v20 row_newbcast:0 row_mask:0xf bank_mask:0xf
    v_mul_f32_dpp v21, v29, v21 row_newbcast:1 row_mask:0xf bank_mask:0xf
    v_mul_f32_dpp v22, v29, v22 row_newbcast:2 row_mask:0xf bank_mask:0xf
    v_mul_f32_dpp v23, v29, v23 row_newbcast:3 row_mask:0xf bank_mask:0xf
    ds_read_b64_tr_b16 v[68:69], v10 offset:12288
    v_mfma_f32_32x32x16_bf16 a[112:127], v[16:19], v[88:91], a[112:127]
    v_mul_f32_dpp v24, v29, v24 row_newbcast:4 row_mask:0xf bank_mask:0xf
    v_mul_f32_dpp v25, v29, v25 row_newbcast:5 row_mask:0xf bank_mask:0xf
    v_mul_f32_dpp v26, v29, v26 row_newbcast:6 row_mask:0xf bank_mask:0xf
    v_mul_f32_dpp v27, v29, v27 row_newbcast:7 row_mask:0xf bank_mask:0xf
    ds_read_b64_tr_b16 v[70:71], v10 offset:13312
    v_mfma_f32_32x32x16_bf16 v[44:59], v[76:79], a[132:135], v[44:59]
    v_cvt_pk_bf16_f32 v12, v20, v21
    v_cvt_pk_bf16_f32 v13, v22, v23
    v_cvt_pk_bf16_f32 v14, v24, v25
    v_cvt_pk_bf16_f32 v15, v26, v27
    ds_read_b64_tr_b16 v[72:73], v11 offset:12288
    ds_read_b64_tr_b16 v[74:75], v11 offset:13312
    s_waitcnt lgkmcnt(8)
    v_mfma_f32_32x32x16_bf16 a[64:79], v[12:15], v[92:95], a[64:79]
    v_lshlrev_b32 v20, 16, v140
    v_and_b32 v21, 0xffff0000, v140
    v_lshlrev_b32 v22, 16, v141
    v_and_b32 v23, 0xffff0000, v141
    ds_read_b64_tr_b16 v[76:77], v8 offset:16384
    ds_read_b64_tr_b16 v[78:79], v8 offset:17408
    v_mfma_f32_32x32x16_bf16 a[80:95], v[12:15], v[96:99], a[80:95]
    s_add_u32 m0, s57, 100352
    s_add_u32 s3, s56, 1204224
    buffer_load_dwordx4 v120, s[12:15], s3 offen lds
    v_lshlrev_b32 v24, 16, v142
    v_and_b32 v25, 0xffff0000, v142
    v_lshlrev_b32 v26, 16, v143
    v_and_b32 v27, 0xffff0000, v143
    ds_read_b64_tr_b16 v[80:81], v9 offset:16384
    ds_read_b64_tr_b16 v[82:83], v9 offset:17408
    v_mfma_f32_32x32x16_bf16 a[96:111], v[12:15], v[100:103], a[96:111]
    v_mul_f32_dpp v20, v29, v20 row_newbcast:8 row_mask:0xf bank_mask:0xf
    v_mul_f32_dpp v21, v29, v21 row_newbcast:9 row_mask:0xf bank_mask:0xf
    v_mul_f32_dpp v22, v29, v22 row_newbcast:10 row_mask:0xf bank_mask:0xf
    v_mul_f32_dpp v23, v29, v23 row_newbcast:11 row_mask:0xf bank_mask:0xf
    ds_read_b64_tr_b16 v[84:85], v10 offset:16384
    v_mfma_f32_32x32x16_bf16 a[112:127], v[12:15], v[104:107], a[112:127]
    v_mul_f32_dpp v24, v29, v24 row_newbcast:12 row_mask:0xf bank_mask:0xf
    v_mul_f32_dpp v25, v29, v25 row_newbcast:13 row_mask:0xf bank_mask:0xf
    v_mul_f32_dpp v26, v29, v26 row_newbcast:14 row_mask:0xf bank_mask:0xf
    v_mul_f32_dpp v27, v29, v27 row_newbcast:15 row_mask:0xf bank_mask:0xf
    ds_read_b64_tr_b16 v[86:87], v10 offset:17408
    v_mfma_f32_32x32x16_bf16 v[44:59], v[92:95], a[136:139], v[44:59]
    v_cvt_pk_bf16_f32 v16, v20, v21
    v_cvt_pk_bf16_f32 v17, v22, v23
    v_cvt_pk_bf16_f32 v18, v24, v25
    v_cvt_pk_bf16_f32 v19, v26, v27
    ds_read_b64_tr_b16 v[88:89], v11 offset:16384
    ds_read_b64_tr_b16 v[90:91], v11 offset:17408
    s_waitcnt lgkmcnt(8)
    v_mfma_f32_32x32x16_bf16 a[64:79], v[16:19], v[60:63], a[64:79]
    v_lshlrev_b32 v20, 16, v144
    v_and_b32 v21, 0xffff0000, v144
    v_lshlrev_b32 v22, 16, v145
    v_and_b32 v23, 0xffff0000, v145
    ds_read_b64_tr_b16 v[92:93], v8 offset:20480
    ds_read_b64_tr_b16 v[94:95], v8 offset:21504
    v_mfma_f32_32x32x16_bf16 a[80:95], v[16:19], v[64:67], a[80:95]
    s_add_u32 m0, s57, 101376
    s_add_u32 s3, s56, 1216512
    buffer_load_dwordx4 v120, s[12:15], s3 offen lds
    v_lshlrev_b32 v24, 16, v146
    v_and_b32 v25, 0xffff0000, v146
    v_lshlrev_b32 v26, 16, v147
    v_and_b32 v27, 0xffff0000, v147
    ds_read_b64_tr_b16 v[96:97], v9 offset:20480
    ds_read_b64_tr_b16 v[98:99], v9 offset:21504
    v_mfma_f32_32x32x16_bf16 a[96:111], v[16:19], v[68:71], a[96:111]
    v_mul_f32_dpp v20, v30, v20 row_newbcast:0 row_mask:0xf bank_mask:0xf
    v_mul_f32_dpp v21, v30, v21 row_newbcast:1 row_mask:0xf bank_mask:0xf
    v_mul_f32_dpp v22, v30, v22 row_newbcast:2 row_mask:0xf bank_mask:0xf
    v_mul_f32_dpp v23, v30, v23 row_newbcast:3 row_mask:0xf bank_mask:0xf
    ds_read_b64_tr_b16 v[100:101], v10 offset:20480
    v_mfma_f32_32x32x16_bf16 a[112:127], v[16:19], v[72:75], a[112:127]
    v_mul_f32_dpp v24, v30, v24 row_newbcast:4 row_mask:0xf bank_mask:0xf
    v_mul_f32_dpp v25, v30, v25 row_newbcast:5 row_mask:0xf bank_mask:0xf
    v_mul_f32_dpp v26, v30, v26 row_newbcast:6 row_mask:0xf bank_mask:0xf
    v_mul_f32_dpp v27, v30, v27 row_newbcast:7 row_mask:0xf bank_mask:0xf
    ds_read_b64_tr_b16 v[102:103], v10 offset:21504
    v_mfma_f32_32x32x16_bf16 v[44:59], v[60:63], a[140:143], v[44:59]
    v_cvt_pk_bf16_f32 v12, v20, v21
    v_cvt_pk_bf16_f32 v13, v22, v23
    v_cvt_pk_bf16_f32 v14, v24, v25
    v_cvt_pk_bf16_f32 v15, v26, v27
    ds_read_b64_tr_b16 v[104:105], v11 offset:20480
    ds_read_b64_tr_b16 v[106:107], v11 offset:21504
    s_waitcnt lgkmcnt(8)
    v_mfma_f32_32x32x16_bf16 a[64:79], v[12:15], v[76:79], a[64:79]
    v_lshlrev_b32 v20, 16, v148
    v_and_b32 v21, 0xffff0000, v148
    v_lshlrev_b32 v22, 16, v149
    v_and_b32 v23, 0xffff0000, v149
    ds_read_b64_tr_b16 v[60:61], v8 offset:24576
    ds_read_b64_tr_b16 v[62:63], v8 offset:25600
    v_mfma_f32_32x32x16_bf16 a[80:95], v[12:15], v[80:83], a[80:95]
    s_add_u32 m0, s57, 102400
    s_add_u32 s3, s56, 1228800
    buffer_load_dwordx4 v120, s[12:15], s3 offen lds
    v_lshlrev_b32 v24, 16, v150
    v_and_b32 v25, 0xffff0000, v150
    v_lshlrev_b32 v26, 16, v151
    v_and_b32 v27, 0xffff0000, v151
    ds_read_b64_tr_b16 v[64:65], v9 offset:24576
    ds_read_b64_tr_b16 v[66:67], v9 offset:25600
    v_mfma_f32_32x32x16_bf16 a[96:111], v[12:15], v[84:87], a[96:111]
    v_mul_f32_dpp v20, v30, v20 row_newbcast:8 row_mask:0xf bank_mask:0xf
    v_mul_f32_dpp v21, v30, v21 row_newbcast:9 row_mask:0xf bank_mask:0xf
    v_mul_f32_dpp v22, v30, v22 row_newbcast:10 row_mask:0xf bank_mask:0xf
    v_mul_f32_dpp v23, v30, v23 row_newbcast:11 row_mask:0xf bank_mask:0xf
    ds_read_b64_tr_b16 v[68:69], v10 offset:24576
    v_mfma_f32_32x32x16_bf16 a[112:127], v[12:15], v[88:91], a[112:127]
    v_mul_f32_dpp v24, v30, v24 row_newbcast:12 row_mask:0xf bank_mask:0xf
    v_mul_f32_dpp v25, v30, v25 row_newbcast:13 row_mask:0xf bank_mask:0xf
    v_mul_f32_dpp v26, v30, v26 row_newbcast:14 row_mask:0xf bank_mask:0xf
    v_mul_f32_dpp v27, v30, v27 row_newbcast:15 row_mask:0xf bank_mask:0xf
    ds_read_b64_tr_b16 v[70:71], v10 offset:25600
    v_mfma_f32_32x32x16_bf16 v[44:59], v[76:79], a[144:147], v[44:59]
    v_cvt_pk_bf16_f32 v16, v20, v21
    v_cvt_pk_bf16_f32 v17, v22, v23
    v_cvt_pk_bf16_f32 v18, v24, v25
    v_cvt_pk_bf16_f32 v19, v26, v27
    ds_read_b64_tr_b16 v[72:73], v11 offset:24576
    ds_read_b64_tr_b16 v[74:75], v11 offset:25600
    s_waitcnt lgkmcnt(8)
    v_mfma_f32_32x32x16_bf16 a[64:79], v[16:19], v[92:95], a[64:79]
    v_lshlrev_b32 v20, 16, v152
    v_and_b32 v21, 0xffff0000, v152
    v_lshlrev_b32 v22, 16, v153
    v_and_b32 v23, 0xffff0000, v153
    ds_read_b64_tr_b16 v[76:77], v8 offset:28672
    ds_read_b64_tr_b16 v[78:79], v8 offset:29696
    v_mfma_f32_32x32x16_bf16 a[80:95], v[16:19], v[96:99], a[80:95]
    s_add_u32 m0, s57, 103424
    s_add_u32 s3, s56, 1241088
    buffer_load_dwordx4 v120, s[12:15], s3 offen lds
    v_lshlrev_b32 v24, 16, v154
    v_and_b32 v25, 0xffff0000, v154
    v_lshlrev_b32 v26, 16, v155
    v_and_b32 v27, 0xffff0000, v155
    ds_read_b64_tr_b16 v[80:81], v9 offset:28672
    ds_read_b64_tr_b16 v[82:83], v9 offset:29696
    v_mfma_f32_32x32x16_bf16 a[96:111], v[16:19], v[100:103], a[96:111]
    v_mul_f32_dpp v20, v31, v20 row_newbcast:0 row_mask:0xf bank_mask:0xf
    v_mul_f32_dpp v21, v31, v21 row_newbcast:1 row_mask:0xf bank_mask:0xf
    v_mul_f32_dpp v22, v31, v22 row_newbcast:2 row_mask:0xf bank_mask:0xf
    v_mul_f32_dpp v23, v31, v23 row_newbcast:3 row_mask:0xf bank_mask:0xf
    ds_read_b64_tr_b16 v[84:85], v10 offset:28672
    v_mfma_f32_32x32x16_bf16 a[112:127], v[16:19], v[104:107], a[112:127]
    v_mul_f32_dpp v24, v31, v24 row_newbcast:4 row_mask:0xf bank_mask:0xf
    v_mul_f32_dpp v25, v31, v25 row_newbcast:5 row_mask:0xf bank_mask:0xf
    v_mul_f32_dpp v26, v31, v26 row_newbcast:6 row_mask:0xf bank_mask:0xf
    v_mul_f32_dpp v27, v31, v27 row_newbcast:7 row_mask:0xf bank_mask:0xf
    ds_read_b64_tr_b16 v[86:87], v10 offset:29696
    v_mfma_f32_32x32x16_bf16 v[44:59], v[92:95], a[148:151], v[44:59]
    v_cvt_pk_bf16_f32 v12, v20, v21
    v_cvt_pk_bf16_f32 v13, v22, v23
    v_cvt_pk_bf16_f32 v14, v24, v25
    v_cvt_pk_bf16_f32 v15, v26, v27
    ds_read_b64_tr_b16 v[88:89], v11 offset:28672
    ds_read_b64_tr_b16 v[90:91], v11 offset:29696
    s_waitcnt lgkmcnt(8)
    v_mfma_f32_32x32x16_bf16 a[64:79], v[12:15], v[60:63], a[64:79]
    v_lshlrev_b32 v20, 16, v156
    v_and_b32 v21, 0xffff0000, v156
    v_lshlrev_b32 v22, 16, v157
    v_and_b32 v23, 0xffff0000, v157
    ds_read_b64_tr_b16 v[92:93], v8 offset:32768
    ds_read_b64_tr_b16 v[94:95], v8 offset:33792
    v_mfma_f32_32x32x16_bf16 a[80:95], v[12:15], v[64:67], a[80:95]
    s_add_u32 m0, s57, 104448
    s_add_u32 s3, s56, 1253376
    buffer_load_dwordx4 v120, s[12:15], s3 offen lds
    v_lshlrev_b32 v24, 16, v158
    v_and_b32 v25, 0xffff0000, v158
    v_lshlrev_b32 v26, 16, v159
    v_and_b32 v27, 0xffff0000, v159
    ds_read_b64_tr_b16 v[96:97], v9 offset:32768
    ds_read_b64_tr_b16 v[98:99], v9 offset:33792
    v_mfma_f32_32x32x16_bf16 a[96:111], v[12:15], v[68:71], a[96:111]
    v_mul_f32_dpp v20, v31, v20 row_newbcast:8 row_mask:0xf bank_mask:0xf
    v_mul_f32_dpp v21, v31, v21 row_newbcast:9 row_mask:0xf bank_mask:0xf
    v_mul_f32_dpp v22, v31, v22 row_newbcast:10 row_mask:0xf bank_mask:0xf
    v_mul_f32_dpp v23, v31, v23 row_newbcast:11 row_mask:0xf bank_mask:0xf
    ds_read_b64_tr_b16 v[100:101], v10 offset:32768
    v_mfma_f32_32x32x16_bf16 a[112:127], v[12:15], v[72:75], a[112:127]
    v_mul_f32_dpp v24, v31, v24 row_newbcast:12 row_mask:0xf bank_mask:0xf
    v_mul_f32_dpp v25, v31, v25 row_newbcast:13 row_mask:0xf bank_mask:0xf
    v_mul_f32_dpp v26, v31, v26 row_newbcast:14 row_mask:0xf bank_mask:0xf
    v_mul_f32_dpp v27, v31, v27 row_newbcast:15 row_mask:0xf bank_mask:0xf
    ds_read_b64_tr_b16 v[102:103], v10 offset:33792
    v_mfma_f32_32x32x16_bf16 v[44:59], v[60:63], a[152:155], v[44:59]
    v_cvt_pk_bf16_f32 v16, v20, v21
    v_cvt_pk_bf16_f32 v17, v22, v23
    v_cvt_pk_bf16_f32 v18, v24, v25
    v_cvt_pk_bf16_f32 v19, v26, v27
    ds_read_b64_tr_b16 v[104:105], v11 offset:32768
    ds_read_b64_tr_b16 v[106:107], v11 offset:33792
    s_waitcnt lgkmcnt(8)
    v_mfma_f32_32x32x16_bf16 a[64:79], v[16:19], v[76:79], a[64:79]
    v_lshlrev_b32 v20, 16, v160
    v_and_b32 v21, 0xffff0000, v160
    v_lshlrev_b32 v22, 16, v161
    v_and_b32 v23, 0xffff0000, v161
    ds_read_b64_tr_b16 v[60:61], v8 offset:36864
    ds_read_b64_tr_b16 v[62:63], v8 offset:37888
    v_mfma_f32_32x32x16_bf16 a[80:95], v[16:19], v[80:83], a[80:95]
    s_add_u32 m0, s57, 105472
    s_add_u32 s3, s56, 1265664
    buffer_load_dwordx4 v120, s[12:15], s3 offen lds
    v_lshlrev_b32 v24, 16, v162
    v_and_b32 v25, 0xffff0000, v162
    v_lshlrev_b32 v26, 16, v163
    v_and_b32 v27, 0xffff0000, v163
    ds_read_b64_tr_b16 v[64:65], v9 offset:36864
    ds_read_b64_tr_b16 v[66:67], v9 offset:37888
    v_mfma_f32_32x32x16_bf16 a[96:111], v[16:19], v[84:87], a[96:111]
    v_mul_f32_dpp v20, v32, v20 row_newbcast:0 row_mask:0xf bank_mask:0xf
    v_mul_f32_dpp v21, v32, v21 row_newbcast:1 row_mask:0xf bank_mask:0xf
    v_mul_f32_dpp v22, v32, v22 row_newbcast:2 row_mask:0xf bank_mask:0xf
    v_mul_f32_dpp v23, v32, v23 row_newbcast:3 row_mask:0xf bank_mask:0xf
    ds_read_b64_tr_b16 v[68:69], v10 offset:36864
    v_mfma_f32_32x32x16_bf16 a[112:127], v[16:19], v[88:91], a[112:127]
    v_mul_f32_dpp v24, v32, v24 row_newbcast:4 row_mask:0xf bank_mask:0xf
    v_mul_f32_dpp v25, v32, v25 row_newbcast:5 row_mask:0xf bank_mask:0xf
    v_mul_f32_dpp v26, v32, v26 row_newbcast:6 row_mask:0xf bank_mask:0xf
    v_mul_f32_dpp v27, v32, v27 row_newbcast:7 row_mask:0xf bank_mask:0xf
    ds_read_b64_tr_b16 v[70:71], v10 offset:37888
    v_mfma_f32_32x32x16_bf16 v[44:59], v[76:79], a[156:159], v[44:59]
    v_cvt_pk_bf16_f32 v12, v20, v21
    v_cvt_pk_bf16_f32 v13, v22, v23
    v_cvt_pk_bf16_f32 v14, v24, v25
    v_cvt_pk_bf16_f32 v15, v26, v27
    ds_read_b64_tr_b16 v[72:73], v11 offset:36864
    ds_read_b64_tr_b16 v[74:75], v11 offset:37888
    s_waitcnt lgkmcnt(8)
    v_mfma_f32_32x32x16_bf16 a[64:79], v[12:15], v[92:95], a[64:79]
    v_lshlrev_b32 v20, 16, v164
    v_and_b32 v21, 0xffff0000, v164
    v_lshlrev_b32 v22, 16, v165
    v_and_b32 v23, 0xffff0000, v165
    ds_read_b64_tr_b16 v[76:77], v8 offset:40960
    ds_read_b64_tr_b16 v[78:79], v8 offset:41984
    v_mfma_f32_32x32x16_bf16 a[80:95], v[12:15], v[96:99], a[80:95]
    v_lshlrev_b32 v24, 16, v166
    v_and_b32 v25, 0xffff0000, v166
    v_lshlrev_b32 v26, 16, v167
    v_and_b32 v27, 0xffff0000, v167
    ds_read_b64_tr_b16 v[80:81], v9 offset:40960
    ds_read_b64_tr_b16 v[82:83], v9 offset:41984
    v_mfma_f32_32x32x16_bf16 a[96:111], v[12:15], v[100:103], a[96:111]
    v_mul_f32_dpp v20, v32, v20 row_newbcast:8 row_mask:0xf bank_mask:0xf
    v_mul_f32_dpp v21, v32, v21 row_newbcast:9 row_mask:0xf bank_mask:0xf
    v_mul_f32_dpp v22, v32, v22 row_newbcast:10 row_mask:0xf bank_mask:0xf
    v_mul_f32_dpp v23, v32, v23 row_newbcast:11 row_mask:0xf bank_mask:0xf
    ds_read_b64_tr_b16 v[84:85], v10 offset:40960
    v_mfma_f32_32x32x16_bf16 a[112:127], v[12:15], v[104:107], a[112:127]
    v_mul_f32_dpp v24, v32, v24 row_newbcast:12 row_mask:0xf bank_mask:0xf
    v_mul_f32_dpp v25, v32, v25 row_newbcast:13 row_mask:0xf bank_mask:0xf
    v_mul_f32_dpp v26, v32, v26 row_newbcast:14 row_mask:0xf bank_mask:0xf
    v_mul_f32_dpp v27, v32, v27 row_newbcast:15 row_mask:0xf bank_mask:0xf
    ds_read_b64_tr_b16 v[86:87], v10 offset:41984
    v_mfma_f32_32x32x16_bf16 v[44:59], v[92:95], a[160:163], v[44:59]
    v_cvt_pk_bf16_f32 v16, v20, v21
    v_cvt_pk_bf16_f32 v17, v22, v23
    v_cvt_pk_bf16_f32 v18, v24, v25
    v_cvt_pk_bf16_f32 v19, v26, v27
    ds_read_b64_tr_b16 v[88:89], v11 offset:40960
    ds_read_b64_tr_b16 v[90:91], v11 offset:41984
    s_waitcnt lgkmcnt(8)
    v_mfma_f32_32x32x16_bf16 a[64:79], v[16:19], v[60:63], a[64:79]
    v_lshlrev_b32 v20, 16, v168
    v_and_b32 v21, 0xffff0000, v168
    v_lshlrev_b32 v22, 16, v169
    v_and_b32 v23, 0xffff0000, v169
    ds_read_b64_tr_b16 v[92:93], v8 offset:45056
    ds_read_b64_tr_b16 v[94:95], v8 offset:46080
    v_mfma_f32_32x32x16_bf16 a[80:95], v[16:19], v[64:67], a[80:95]
    v_lshlrev_b32 v24, 16, v170
    v_and_b32 v25, 0xffff0000, v170
    v_lshlrev_b32 v26, 16, v171
    v_and_b32 v27, 0xffff0000, v171
    ds_read_b64_tr_b16 v[96:97], v9 offset:45056
    ds_read_b64_tr_b16 v[98:99], v9 offset:46080
    v_mfma_f32_32x32x16_bf16 a[96:111], v[16:19], v[68:71], a[96:111]
    v_mul_f32_dpp v20, v33, v20 row_newbcast:0 row_mask:0xf bank_mask:0xf
    v_mul_f32_dpp v21, v33, v21 row_newbcast:1 row_mask:0xf bank_mask:0xf
    v_mul_f32_dpp v22, v33, v22 row_newbcast:2 row_mask:0xf bank_mask:0xf
    v_mul_f32_dpp v23, v33, v23 row_newbcast:3 row_mask:0xf bank_mask:0xf
    ds_read_b64_tr_b16 v[100:101], v10 offset:45056
    v_mfma_f32_32x32x16_bf16 a[112:127], v[16:19], v[72:75], a[112:127]
    v_mul_f32_dpp v24, v33, v24 row_newbcast:4 row_mask:0xf bank_mask:0xf
    v_mul_f32_dpp v25, v33, v25 row_newbcast:5 row_mask:0xf bank_mask:0xf
    v_mul_f32_dpp v26, v33, v26 row_newbcast:6 row_mask:0xf bank_mask:0xf
    v_mul_f32_dpp v27, v33, v27 row_newbcast:7 row_mask:0xf bank_mask:0xf
    ds_read_b64_tr_b16 v[102:103], v10 offset:46080
    v_mfma_f32_32x32x16_bf16 v[44:59], v[60:63], a[164:167], v[44:59]
    v_cvt_pk_bf16_f32 v12, v20, v21
    v_cvt_pk_bf16_f32 v13, v22, v23
    v_cvt_pk_bf16_f32 v14, v24, v25
    v_cvt_pk_bf16_f32 v15, v26, v27
    ds_read_b64_tr_b16 v[104:105], v11 offset:45056
    ds_read_b64_tr_b16 v[106:107], v11 offset:46080
    s_waitcnt lgkmcnt(8)
    v_mfma_f32_32x32x16_bf16 a[64:79], v[12:15], v[76:79], a[64:79]
    v_lshlrev_b32 v20, 16, v172
    v_and_b32 v21, 0xffff0000, v172
    v_lshlrev_b32 v22, 16, v173
    v_and_b32 v23, 0xffff0000, v173
    ds_read_b64_tr_b16 v[60:61], v8 offset:49152
    ds_read_b64_tr_b16 v[62:63], v8 offset:50176
    v_mfma_f32_32x32x16_bf16 a[80:95], v[12:15], v[80:83], a[80:95]
    v_lshlrev_b32 v24, 16, v174
    v_and_b32 v25, 0xffff0000, v174
    v_lshlrev_b32 v26, 16, v175
    v_and_b32 v27, 0xffff0000, v175
    ds_read_b64_tr_b16 v[64:65], v9 offset:49152
    ds_read_b64_tr_b16 v[66:67], v9 offset:50176
    v_mfma_f32_32x32x16_bf16 a[96:111], v[12:15], v[84:87], a[96:111]
    v_mul_f32_dpp v20, v33, v20 row_newbcast:8 row_mask:0xf bank_mask:0xf
    v_mul_f32_dpp v21, v33, v21 row_newbcast:9 row_mask:0xf bank_mask:0xf
    v_mul_f32_dpp v22, v33, v22 row_newbcast:10 row_mask:0xf bank_mask:0xf
    v_mul_f32_dpp v23, v33, v23 row_newbcast:11 row_mask:0xf bank_mask:0xf
    ds_read_b64_tr_b16 v[68:69], v10 offset:49152
    v_mfma_f32_32x32x16_bf16 a[112:127], v[12:15], v[88:91], a[112:127]
    v_mul_f32_dpp v24, v33, v24 row_newbcast:12 row_mask:0xf bank_mask:0xf
    v_mul_f32_dpp v25, v33, v25 row_newbcast:13 row_mask:0xf bank_mask:0xf
    v_mul_f32_dpp v26, v33, v26 row_newbcast:14 row_mask:0xf bank_mask:0xf
    v_mul_f32_dpp v27, v33, v27 row_newbcast:15 row_mask:0xf bank_mask:0xf
    ds_read_b64_tr_b16 v[70:71], v10 offset:50176
    v_mfma_f32_32x32x16_bf16 v[44:59], v[76:79], a[168:171], v[44:59]
    v_cvt_pk_bf16_f32 v16, v20, v21
    v_cvt_pk_bf16_f32 v17, v22, v23
    v_cvt_pk_bf16_f32 v18, v24, v25
    v_cvt_pk_bf16_f32 v19, v26, v27
    ds_read_b64_tr_b16 v[72:73], v11 offset:49152
    ds_read_b64_tr_b16 v[74:75], v11 offset:50176
    s_waitcnt lgkmcnt(8)
    v_mfma_f32_32x32x16_bf16 a[64:79], v[16:19], v[92:95], a[64:79]
    v_lshlrev_b32 v20, 16, v176
    v_and_b32 v21, 0xffff0000, v176
    v_lshlrev_b32 v22, 16, v177
    v_and_b32 v23, 0xffff0000, v177
    ds_read_b64_tr_b16 v[76:77], v8 offset:53248
    ds_read_b64_tr_b16 v[78:79], v8 offset:54272
    v_mfma_f32_32x32x16_bf16 a[80:95], v[16:19], v[96:99], a[80:95]
    v_lshlrev_b32 v24, 16, v178
    v_and_b32 v25, 0xffff0000, v178
    v_lshlrev_b32 v26, 16, v179
    v_and_b32 v27, 0xffff0000, v179
    ds_read_b64_tr_b16 v[80:81], v9 offset:53248
    ds_read_b64_tr_b16 v[82:83], v9 offset:54272
    v_mfma_f32_32x32x16_bf16 a[96:111], v[16:19], v[100:103], a[96:111]
    v_mul_f32_dpp v20, v34, v20 row_newbcast:0 row_mask:0xf bank_mask:0xf
    v_mul_f32_dpp v21, v34, v21 row_newbcast:1 row_mask:0xf bank_mask:0xf
    v_mul_f32_dpp v22, v34, v22 row_newbcast:2 row_mask:0xf bank_mask:0xf
    v_mul_f32_dpp v23, v34, v23 row_newbcast:3 row_mask:0xf bank_mask:0xf
    ds_read_b64_tr_b16 v[84:85], v10 offset:53248
    v_mfma_f32_32x32x16_bf16 a[112:127], v[16:19], v[104:107], a[112:127]
    v_mul_f32_dpp v24, v34, v24 row_newbcast:4 row_mask:0xf bank_mask:0xf
    v_mul_f32_dpp v25, v34, v25 row_newbcast:5 row_mask:0xf bank_mask:0xf
    v_mul_f32_dpp v26, v34, v26 row_newbcast:6 row_mask:0xf bank_mask:0xf
    v_mul_f32_dpp v27, v34, v27 row_newbcast:7 row_mask:0xf bank_mask:0xf
    ds_read_b64_tr_b16 v[86:87], v10 offset:54272
    v_mfma_f32_32x32x16_bf16 v[44:59], v[92:95], a[172:175], v[44:59]
    v_cvt_pk_bf16_f32 v12, v20, v21
    v_cvt_pk_bf16_f32 v13, v22, v23
    v_cvt_pk_bf16_f32 v14, v24, v25
    v_cvt_pk_bf16_f32 v15, v26, v27
    ds_read_b64_tr_b16 v[88:89], v11 offset:53248
    ds_read_b64_tr_b16 v[90:91], v11 offset:54272
    s_waitcnt lgkmcnt(8)
    v_mfma_f32_32x32x16_bf16 a[64:79], v[12:15], v[60:63], a[64:79]
    v_lshlrev_b32 v20, 16, v180
    v_and_b32 v21, 0xffff0000, v180
    v_lshlrev_b32 v22, 16, v181
    v_and_b32 v23, 0xffff0000, v181
    ds_read_b64_tr_b16 v[92:93], v8 offset:57344
    ds_read_b64_tr_b16 v[94:95], v8 offset:58368
    v_mfma_f32_32x32x16_bf16 a[80:95], v[12:15], v[64:67], a[80:95]
    v_lshlrev_b32 v24, 16, v182
    v_and_b32 v25, 0xffff0000, v182
    v_lshlrev_b32 v26, 16, v183
    v_and_b32 v27, 0xffff0000, v183
    ds_read_b64_tr_b16 v[96:97], v9 offset:57344
    ds_read_b64_tr_b16 v[98:99], v9 offset:58368
    v_mfma_f32_32x32x16_bf16 a[96:111], v[12:15], v[68:71], a[96:111]
    v_mul_f32_dpp v20, v34, v20 row_newbcast:8 row_mask:0xf bank_mask:0xf
    v_mul_f32_dpp v21, v34, v21 row_newbcast:9 row_mask:0xf bank_mask:0xf
    v_mul_f32_dpp v22, v34, v22 row_newbcast:10 row_mask:0xf bank_mask:0xf
    v_mul_f32_dpp v23, v34, v23 row_newbcast:11 row_mask:0xf bank_mask:0xf
    ds_read_b64_tr_b16 v[100:101], v10 offset:57344
    v_mfma_f32_32x32x16_bf16 a[112:127], v[12:15], v[72:75], a[112:127]
    v_mul_f32_dpp v24, v34, v24 row_newbcast:12 row_mask:0xf bank_mask:0xf
    v_mul_f32_dpp v25, v34, v25 row_newbcast:13 row_mask:0xf bank_mask:0xf
    v_mul_f32_dpp v26, v34, v26 row_newbcast:14 row_mask:0xf bank_mask:0xf
    v_mul_f32_dpp v27, v34, v27 row_newbcast:15 row_mask:0xf bank_mask:0xf
    ds_read_b64_tr_b16 v[102:103], v10 offset:58368
    v_mfma_f32_32x32x16_bf16 v[44:59], v[60:63], a[176:179], v[44:59]
    v_cvt_pk_bf16_f32 v16, v20, v21
    v_cvt_pk_bf16_f32 v17, v22, v23
    v_cvt_pk_bf16_f32 v18, v24, v25
    v_cvt_pk_bf16_f32 v19, v26, v27
    ds_read_b64_tr_b16 v[104:105], v11 offset:57344
    ds_read_b64_tr_b16 v[106:107], v11 offset:58368
    s_waitcnt lgkmcnt(8)
    v_mfma_f32_32x32x16_bf16 a[64:79], v[16:19], v[76:79], a[64:79]
    v_lshlrev_b32 v20, 16, v184
    v_and_b32 v21, 0xffff0000, v184
    v_lshlrev_b32 v22, 16, v185
    v_and_b32 v23, 0xffff0000, v185
    ds_read_b64_tr_b16 v[60:61], v8 offset:61440
    ds_read_b64_tr_b16 v[62:63], v8 offset:62464
    v_mfma_f32_32x32x16_bf16 a[80:95], v[16:19], v[80:83], a[80:95]
    v_lshlrev_b32 v24, 16, v186
    v_and_b32 v25, 0xffff0000, v186
    v_lshlrev_b32 v26, 16, v187
    v_and_b32 v27, 0xffff0000, v187
    ds_read_b64_tr_b16 v[64:65], v9 offset:61440
    ds_read_b64_tr_b16 v[66:67], v9 offset:62464
    v_mfma_f32_32x32x16_bf16 a[96:111], v[16:19], v[84:87], a[96:111]
    v_mul_f32_dpp v20, v35, v20 row_newbcast:0 row_mask:0xf bank_mask:0xf
    v_mul_f32_dpp v21, v35, v21 row_newbcast:1 row_mask:0xf bank_mask:0xf
    v_mul_f32_dpp v22, v35, v22 row_newbcast:2 row_mask:0xf bank_mask:0xf
    v_mul_f32_dpp v23, v35, v23 row_newbcast:3 row_mask:0xf bank_mask:0xf
    ds_read_b64_tr_b16 v[68:69], v10 offset:61440
    v_mfma_f32_32x32x16_bf16 a[112:127], v[16:19], v[88:91], a[112:127]
    v_mul_f32_dpp v24, v35, v24 row_newbcast:4 row_mask:0xf bank_mask:0xf
    v_mul_f32_dpp v25, v35, v25 row_newbcast:5 row_mask:0xf bank_mask:0xf
    v_mul_f32_dpp v26, v35, v26 row_newbcast:6 row_mask:0xf bank_mask:0xf
    v_mul_f32_dpp v27, v35, v27 row_newbcast:7 row_mask:0xf bank_mask:0xf
    ds_read_b64_tr_b16 v[70:71], v10 offset:62464
    v_mfma_f32_32x32x16_bf16 v[44:59], v[76:79], a[180:183], v[44:59]
    v_cvt_pk_bf16_f32 v12, v20, v21
    v_cvt_pk_bf16_f32 v13, v22, v23
    v_cvt_pk_bf16_f32 v14, v24, v25
    v_cvt_pk_bf16_f32 v15, v26, v27
    ds_read_b64_tr_b16 v[72:73], v11 offset:61440
    ds_read_b64_tr_b16 v[74:75], v11 offset:62464
    s_waitcnt vmcnt(0)
    s_barrier
    s_waitcnt lgkmcnt(8)
    v_mfma_f32_32x32x16_bf16 a[64:79], v[12:15], v[92:95], a[64:79]
    v_lshlrev_b32 v20, 16, v188
    v_and_b32 v21, 0xffff0000, v188
    v_lshlrev_b32 v22, 16, v189
    v_and_b32 v23, 0xffff0000, v189
    v_add_u32 v8, 0x10000, v8
    ds_read_b64_tr_b16 v[76:77], v8 offset:0
    ds_read_b64_tr_b16 v[78:79], v8 offset:1024
    v_mfma_f32_32x32x16_bf16 a[80:95], v[12:15], v[96:99], a[80:95]
    v_lshlrev_b32 v24, 16, v190
    v_and_b32 v25, 0xffff0000, v190
    v_lshlrev_b32 v26, 16, v191
    v_and_b32 v27, 0xffff0000, v191
    v_add_u32 v9, 0x10000, v9
    ds_read_b64_tr_b16 v[80:81], v9 offset:0
    ds_read_b64_tr_b16 v[82:83], v9 offset:1024
    v_mfma_f32_32x32x16_bf16 a[96:111], v[12:15], v[100:103], a[96:111]
    v_mul_f32_dpp v20, v35, v20 row_newbcast:8 row_mask:0xf bank_mask:0xf
    v_mul_f32_dpp v21, v35, v21 row_newbcast:9 row_mask:0xf bank_mask:0xf
    v_mul_f32_dpp v22, v35, v22 row_newbcast:10 row_mask:0xf bank_mask:0xf
    v_mul_f32_dpp v23, v35, v23 row_newbcast:11 row_mask:0xf bank_mask:0xf
    v_add_u32 v10, 0x10000, v10
    ds_read_b64_tr_b16 v[84:85], v10 offset:0
    v_mfma_f32_32x32x16_bf16 a[112:127], v[12:15], v[104:107], a[112:127]
    v_mul_f32_dpp v24, v35, v24 row_newbcast:12 row_mask:0xf bank_mask:0xf
    v_mul_f32_dpp v25, v35, v25 row_newbcast:13 row_mask:0xf bank_mask:0xf
    v_mul_f32_dpp v26, v35, v26 row_newbcast:14 row_mask:0xf bank_mask:0xf
    v_mul_f32_dpp v27, v35, v27 row_newbcast:15 row_mask:0xf bank_mask:0xf
    ds_read_b64_tr_b16 v[86:87], v10 offset:1024
    v_mfma_f32_32x32x16_bf16 v[44:59], v[92:95], a[184:187], v[44:59]
    v_cvt_pk_bf16_f32 v16, v20, v21
    v_cvt_pk_bf16_f32 v17, v22, v23
    v_cvt_pk_bf16_f32 v18, v24, v25
    v_cvt_pk_bf16_f32 v19, v26, v27
    v_add_u32 v11, 0x10000, v11
    ds_read_b64_tr_b16 v[88:89], v11 offset:0
    ds_read_b64_tr_b16 v[90:91], v11 offset:1024
    s_waitcnt lgkmcnt(8)
    v_mfma_f32_32x32x16_bf16 a[64:79], v[16:19], v[60:63], a[64:79]
    v_lshlrev_b32 v20, 16, v192
    v_and_b32 v21, 0xffff0000, v192
    v_lshlrev_b32 v22, 16, v193
    v_and_b32 v23, 0xffff0000, v193
    ds_read_b64_tr_b16 v[92:93], v8 offset:4096
    ds_read_b64_tr_b16 v[94:95], v8 offset:5120
    v_mfma_f32_32x32x16_bf16 a[80:95], v[16:19], v[64:67], a[80:95]
    v_lshlrev_b32 v24, 16, v194
    v_and_b32 v25, 0xffff0000, v194
    v_lshlrev_b32 v26, 16, v195
    v_and_b32 v27, 0xffff0000, v195
    ds_read_b64_tr_b16 v[96:97], v9 offset:4096
    ds_read_b64_tr_b16 v[98:99], v9 offset:5120
    v_mfma_f32_32x32x16_bf16 a[96:111], v[16:19], v[68:71], a[96:111]
    v_mul_f32_dpp v20, v36, v20 row_newbcast:0 row_mask:0xf bank_mask:0xf
    v_mul_f32_dpp v21, v36, v21 row_newbcast:1 row_mask:0xf bank_mask:0xf
    v_mul_f32_dpp v22, v36, v22 row_newbcast:2 row_mask:0xf bank_mask:0xf
    v_mul_f32_dpp v23, v36, v23 row_newbcast:3 row_mask:0xf bank_mask:0xf
    ds_read_b64_tr_b16 v[100:101], v10 offset:4096
    v_mfma_f32_32x32x16_bf16 a[112:127], v[16:19], v[72:75], a[112:127]
    v_mul_f32_dpp v24, v36, v24 row_newbcast:4 row_mask:0xf bank_mask:0xf
    v_mul_f32_dpp v25, v36, v25 row_newbcast:5 row_mask:0xf bank_mask:0xf
    v_mul_f32_dpp v26, v36, v26 row_newbcast:6 row_mask:0xf bank_mask:0xf
    v_mul_f32_dpp v27, v36, v27 row_newbcast:7 row_mask:0xf bank_mask:0xf
    ds_read_b64_tr_b16 v[102:103], v10 offset:5120
    v_mfma_f32_32x32x16_bf16 v[44:59], v[60:63], a[188:191], v[44:59]
    v_cvt_pk_bf16_f32 v12, v20, v21
    v_cvt_pk_bf16_f32 v13, v22, v23
    v_cvt_pk_bf16_f32 v14, v24, v25
    v_cvt_pk_bf16_f32 v15, v26, v27
    ds_read_b64_tr_b16 v[104:105], v11 offset:4096
    ds_read_b64_tr_b16 v[106:107], v11 offset:5120
    s_waitcnt lgkmcnt(8)
    v_mfma_f32_32x32x16_bf16 a[64:79], v[12:15], v[76:79], a[64:79]
    v_lshlrev_b32 v20, 16, v196
    v_and_b32 v21, 0xffff0000, v196
    v_lshlrev_b32 v22, 16, v197
    v_and_b32 v23, 0xffff0000, v197
    ds_read_b64_tr_b16 v[60:61], v8 offset:8192
    ds_read_b64_tr_b16 v[62:63], v8 offset:9216
    v_mfma_f32_32x32x16_bf16 a[80:95], v[12:15], v[80:83], a[80:95]
    v_lshlrev_b32 v24, 16, v198
    v_and_b32 v25, 0xffff0000, v198
    v_lshlrev_b32 v26, 16, v199
    v_and_b32 v27, 0xffff0000, v199
    ds_read_b64_tr_b16 v[64:65], v9 offset:8192
    ds_read_b64_tr_b16 v[66:67], v9 offset:9216
    v_mfma_f32_32x32x16_bf16 a[96:111], v[12:15], v[84:87], a[96:111]
    v_mul_f32_dpp v20, v36, v20 row_newbcast:8 row_mask:0xf bank_mask:0xf
    v_mul_f32_dpp v21, v36, v21 row_newbcast:9 row_mask:0xf bank_mask:0xf
    v_mul_f32_dpp v22, v36, v22 row_newbcast:10 row_mask:0xf bank_mask:0xf
    v_mul_f32_dpp v23, v36, v23 row_newbcast:11 row_mask:0xf bank_mask:0xf
    ds_read_b64_tr_b16 v[68:69], v10 offset:8192
    v_mfma_f32_32x32x16_bf16 a[112:127], v[12:15], v[88:91], a[112:127]
    v_mul_f32_dpp v24, v36, v24 row_newbcast:12 row_mask:0xf bank_mask:0xf
    v_mul_f32_dpp v25, v36, v25 row_newbcast:13 row_mask:0xf bank_mask:0xf
    v_mul_f32_dpp v26, v36, v26 row_newbcast:14 row_mask:0xf bank_mask:0xf
    v_mul_f32_dpp v27, v36, v27 row_newbcast:15 row_mask:0xf bank_mask:0xf
    ds_read_b64_tr_b16 v[70:71], v10 offset:9216
    v_mfma_f32_32x32x16_bf16 v[44:59], v[76:79], a[192:195], v[44:59]
    v_cvt_pk_bf16_f32 v16, v20, v21
    v_cvt_pk_bf16_f32 v17, v22, v23
    v_cvt_pk_bf16_f32 v18, v24, v25
    v_cvt_pk_bf16_f32 v19, v26, v27
    ds_read_b64_tr_b16 v[72:73], v11 offset:8192
    ds_read_b64_tr_b16 v[74:75], v11 offset:9216
    s_waitcnt lgkmcnt(8)
    v_mfma_f32_32x32x16_bf16 a[64:79], v[16:19], v[92:95], a[64:79]
    v_lshlrev_b32 v20, 16, v200
    v_and_b32 v21, 0xffff0000, v200
    v_lshlrev_b32 v22, 16, v201
    v_and_b32 v23, 0xffff0000, v201
    ds_read_b64_tr_b16 v[76:77], v8 offset:12288
    ds_read_b64_tr_b16 v[78:79], v8 offset:13312
    v_mfma_f32_32x32x16_bf16 a[80:95], v[16:19], v[96:99], a[80:95]
    v_lshlrev_b32 v24, 16, v202
    v_and_b32 v25, 0xffff0000, v202
    v_lshlrev_b32 v26, 16, v203
    v_and_b32 v27, 0xffff0000, v203
    ds_read_b64_tr_b16 v[80:81], v9 offset:12288
    ds_read_b64_tr_b16 v[82:83], v9 offset:13312
    v_mfma_f32_32x32x16_bf16 a[96:111], v[16:19], v[100:103], a[96:111]
    v_mul_f32_dpp v20, v37, v20 row_newbcast:0 row_mask:0xf bank_mask:0xf
    v_mul_f32_dpp v21, v37, v21 row_newbcast:1 row_mask:0xf bank_mask:0xf
    v_mul_f32_dpp v22, v37, v22 row_newbcast:2 row_mask:0xf bank_mask:0xf
    v_mul_f32_dpp v23, v37, v23 row_newbcast:3 row_mask:0xf bank_mask:0xf
    ds_read_b64_tr_b16 v[84:85], v10 offset:12288
    v_mfma_f32_32x32x16_bf16 a[112:127], v[16:19], v[104:107], a[112:127]
    v_mul_f32_dpp v24, v37, v24 row_newbcast:4 row_mask:0xf bank_mask:0xf
    v_mul_f32_dpp v25, v37, v25 row_newbcast:5 row_mask:0xf bank_mask:0xf
    v_mul_f32_dpp v26, v37, v26 row_newbcast:6 row_mask:0xf bank_mask:0xf
    v_mul_f32_dpp v27, v37, v27 row_newbcast:7 row_mask:0xf bank_mask:0xf
    ds_read_b64_tr_b16 v[86:87], v10 offset:13312
    v_mfma_f32_32x32x16_bf16 v[44:59], v[92:95], a[196:199], v[44:59]
    v_cvt_pk_bf16_f32 v12, v20, v21
    v_cvt_pk_bf16_f32 v13, v22, v23
    v_cvt_pk_bf16_f32 v14, v24, v25
    v_cvt_pk_bf16_f32 v15, v26, v27
    ds_read_b64_tr_b16 v[88:89], v11 offset:12288
    ds_read_b64_tr_b16 v[90:91], v11 offset:13312
    s_waitcnt lgkmcnt(8)
    v_mfma_f32_32x32x16_bf16 a[64:79], v[12:15], v[60:63], a[64:79]
    v_lshlrev_b32 v20, 16, v204
    v_and_b32 v21, 0xffff0000, v204
    v_lshlrev_b32 v22, 16, v205
    v_and_b32 v23, 0xffff0000, v205
    ds_read_b64_tr_b16 v[92:93], v8 offset:16384
    ds_read_b64_tr_b16 v[94:95], v8 offset:17408
    v_mfma_f32_32x32x16_bf16 a[80:95], v[12:15], v[64:67], a[80:95]
    v_lshlrev_b32 v24, 16, v206
    v_and_b32 v25, 0xffff0000, v206
    v_lshlrev_b32 v26, 16, v207
    v_and_b32 v27, 0xffff0000, v207
    ds_read_b64_tr_b16 v[96:97], v9 offset:16384
    ds_read_b64_tr_b16 v[98:99], v9 offset:17408
    v_mfma_f32_32x32x16_bf16 a[96:111], v[12:15], v[68:71], a[96:111]
    v_mul_f32_dpp v20, v37, v20 row_newbcast:8 row_mask:0xf bank_mask:0xf
    v_mul_f32_dpp v21, v37, v21 row_newbcast:9 row_mask:0xf bank_mask:0xf
    v_mul_f32_dpp v22, v37, v22 row_newbcast:10 row_mask:0xf bank_mask:0xf
    v_mul_f32_dpp v23, v37, v23 row_newbcast:11 row_mask:0xf bank_mask:0xf
    ds_read_b64_tr_b16 v[100:101], v10 offset:16384
    v_mfma_f32_32x32x16_bf16 a[112:127], v[12:15], v[72:75], a[112:127]
    v_mul_f32_dpp v24, v37, v24 row_newbcast:12 row_mask:0xf bank_mask:0xf
    v_mul_f32_dpp v25, v37, v25 row_newbcast:13 row_mask:0xf bank_mask:0xf
    v_mul_f32_dpp v26, v37, v26 row_newbcast:14 row_mask:0xf bank_mask:0xf
    v_mul_f32_dpp v27, v37, v27 row_newbcast:15 row_mask:0xf bank_mask:0xf
    ds_read_b64_tr_b16 v[102:103], v10 offset:17408
    v_mfma_f32_32x32x16_bf16 v[44:59], v[60:63], a[200:203], v[44:59]
    v_cvt_pk_bf16_f32 v16, v20, v21
    v_cvt_pk_bf16_f32 v17, v22, v23
    v_cvt_pk_bf16_f32 v18, v24, v25
    v_cvt_pk_bf16_f32 v19, v26, v27
    ds_read_b64_tr_b16 v[104:105], v11 offset:16384
    ds_read_b64_tr_b16 v[106:107], v11 offset:17408
    s_waitcnt lgkmcnt(8)
    v_mfma_f32_32x32x16_bf16 a[64:79], v[16:19], v[76:79], a[64:79]
    v_lshlrev_b32 v20, 16, v208
    v_and_b32 v21, 0xffff0000, v208
    v_lshlrev_b32 v22, 16, v209
    v_and_b32 v23, 0xffff0000, v209
    ds_read_b64_tr_b16 v[60:61], v8 offset:20480
    ds_read_b64_tr_b16 v[62:63], v8 offset:21504
    v_mfma_f32_32x32x16_bf16 a[80:95], v[16:19], v[80:83], a[80:95]
    v_lshlrev_b32 v24, 16, v210
    v_and_b32 v25, 0xffff0000, v210
    v_lshlrev_b32 v26, 16, v211
    v_and_b32 v27, 0xffff0000, v211
    ds_read_b64_tr_b16 v[64:65], v9 offset:20480
    ds_read_b64_tr_b16 v[66:67], v9 offset:21504
    v_mfma_f32_32x32x16_bf16 a[96:111], v[16:19], v[84:87], a[96:111]
    v_mul_f32_dpp v20, v38, v20 row_newbcast:0 row_mask:0xf bank_mask:0xf
    v_mul_f32_dpp v21, v38, v21 row_newbcast:1 row_mask:0xf bank_mask:0xf
    v_mul_f32_dpp v22, v38, v22 row_newbcast:2 row_mask:0xf bank_mask:0xf
    v_mul_f32_dpp v23, v38, v23 row_newbcast:3 row_mask:0xf bank_mask:0xf
    ds_read_b64_tr_b16 v[68:69], v10 offset:20480
    v_mfma_f32_32x32x16_bf16 a[112:127], v[16:19], v[88:91], a[112:127]
    v_mul_f32_dpp v24, v38, v24 row_newbcast:4 row_mask:0xf bank_mask:0xf
    v_mul_f32_dpp v25, v38, v25 row_newbcast:5 row_mask:0xf bank_mask:0xf
    v_mul_f32_dpp v26, v38, v26 row_newbcast:6 row_mask:0xf bank_mask:0xf
    v_mul_f32_dpp v27, v38, v27 row_newbcast:7 row_mask:0xf bank_mask:0xf
    ds_read_b64_tr_b16 v[70:71], v10 offset:21504
    v_mfma_f32_32x32x16_bf16 v[44:59], v[76:79], a[204:207], v[44:59]
    v_cvt_pk_bf16_f32 v12, v20, v21
    v_cvt_pk_bf16_f32 v13, v22, v23
    v_cvt_pk_bf16_f32 v14, v24, v25
    v_cvt_pk_bf16_f32 v15, v26, v27
    ds_read_b64_tr_b16 v[72:73], v11 offset:20480
    ds_read_b64_tr_b16 v[74:75], v11 offset:21504
    s_waitcnt lgkmcnt(8)
    v_mfma_f32_32x32x16_bf16 a[64:79], v[12:15], v[92:95], a[64:79]
    v_lshlrev_b32 v20, 16, v212
    v_and_b32 v21, 0xffff0000, v212
    v_lshlrev_b32 v22, 16, v213
    v_and_b32 v23, 0xffff0000, v213
    ds_read_b64_tr_b16 v[76:77], v8 offset:24576
    ds_read_b64_tr_b16 v[78:79], v8 offset:25600
    v_mfma_f32_32x32x16_bf16 a[80:95], v[12:15], v[96:99], a[80:95]
    v_lshlrev_b32 v24, 16, v214
    v_and_b32 v25, 0xffff0000, v214
    v_lshlrev_b32 v26, 16, v215
    v_and_b32 v27, 0xffff0000, v215
    ds_read_b64_tr_b16 v[80:81], v9 offset:24576
    ds_read_b64_tr_b16 v[82:83], v9 offset:25600
    v_mfma_f32_32x32x16_bf16 a[96:111], v[12:15], v[100:103], a[96:111]
    v_mul_f32_dpp v20, v38, v20 row_newbcast:8 row_mask:0xf bank_mask:0xf
    v_mul_f32_dpp v21, v38, v21 row_newbcast:9 row_mask:0xf bank_mask:0xf
    v_mul_f32_dpp v22, v38, v22 row_newbcast:10 row_mask:0xf bank_mask:0xf
    v_mul_f32_dpp v23, v38, v23 row_newbcast:11 row_mask:0xf bank_mask:0xf
    ds_read_b64_tr_b16 v[84:85], v10 offset:24576
    v_mfma_f32_32x32x16_bf16 a[112:127], v[12:15], v[104:107], a[112:127]
    v_mul_f32_dpp v24, v38, v24 row_newbcast:12 row_mask:0xf bank_mask:0xf
    v_mul_f32_dpp v25, v38, v25 row_newbcast:13 row_mask:0xf bank_mask:0xf
    v_mul_f32_dpp v26, v38, v26 row_newbcast:14 row_mask:0xf bank_mask:0xf
    v_mul_f32_dpp v27, v38, v27 row_newbcast:15 row_mask:0xf bank_mask:0xf
    ds_read_b64_tr_b16 v[86:87], v10 offset:25600
    v_mfma_f32_32x32x16_bf16 v[44:59], v[92:95], a[208:211], v[44:59]
    v_cvt_pk_bf16_f32 v16, v20, v21
    v_cvt_pk_bf16_f32 v17, v22, v23
    v_cvt_pk_bf16_f32 v18, v24, v25
    v_cvt_pk_bf16_f32 v19, v26, v27
    ds_read_b64_tr_b16 v[88:89], v11 offset:24576
    ds_read_b64_tr_b16 v[90:91], v11 offset:25600
    s_waitcnt lgkmcnt(8)
    v_mfma_f32_32x32x16_bf16 a[64:79], v[16:19], v[60:63], a[64:79]
    v_lshlrev_b32 v20, 16, v216
    v_and_b32 v21, 0xffff0000, v216
    v_lshlrev_b32 v22, 16, v217
    v_and_b32 v23, 0xffff0000, v217
    ds_read_b64_tr_b16 v[92:93], v8 offset:28672
    ds_read_b64_tr_b16 v[94:95], v8 offset:29696
    v_mfma_f32_32x32x16_bf16 a[80:95], v[16:19], v[64:67], a[80:95]
    v_lshlrev_b32 v24, 16, v218
    v_and_b32 v25, 0xffff0000, v218
    v_lshlrev_b32 v26, 16, v219
    v_and_b32 v27, 0xffff0000, v219
    ds_read_b64_tr_b16 v[96:97], v9 offset:28672
    ds_read_b64_tr_b16 v[98:99], v9 offset:29696
    v_mfma_f32_32x32x16_bf16 a[96:111], v[16:19], v[68:71], a[96:111]
    v_mul_f32_dpp v20, v39, v20 row_newbcast:0 row_mask:0xf bank_mask:0xf
    v_mul_f32_dpp v21, v39, v21 row_newbcast:1 row_mask:0xf bank_mask:0xf
    v_mul_f32_dpp v22, v39, v22 row_newbcast:2 row_mask:0xf bank_mask:0xf
    v_mul_f32_dpp v23, v39, v23 row_newbcast:3 row_mask:0xf bank_mask:0xf
    ds_read_b64_tr_b16 v[100:101], v10 offset:28672
    v_mfma_f32_32x32x16_bf16 a[112:127], v[16:19], v[72:75], a[112:127]
    v_mul_f32_dpp v24, v39, v24 row_newbcast:4 row_mask:0xf bank_mask:0xf
    v_mul_f32_dpp v25, v39, v25 row_newbcast:5 row_mask:0xf bank_mask:0xf
    v_mul_f32_dpp v26, v39, v26 row_newbcast:6 row_mask:0xf bank_mask:0xf
    v_mul_f32_dpp v27, v39, v27 row_newbcast:7 row_mask:0xf bank_mask:0xf
    ds_read_b64_tr_b16 v[102:103], v10 offset:29696
    v_mfma_f32_32x32x16_bf16 v[44:59], v[60:63], a[212:215], v[44:59]
    v_cvt_pk_bf16_f32 v12, v20, v21
    v_cvt_pk_bf16_f32 v13, v22, v23
    v_cvt_pk_bf16_f32 v14, v24, v25
    v_cvt_pk_bf16_f32 v15, v26, v27
    ds_read_b64_tr_b16 v[104:105], v11 offset:28672
    ds_read_b64_tr_b16 v[106:107], v11 offset:29696
    s_waitcnt lgkmcnt(8)
    v_mfma_f32_32x32x16_bf16 a[64:79], v[12:15], v[76:79], a[64:79]
    v_lshlrev_b32 v20, 16, v220
    v_and_b32 v21, 0xffff0000, v220
    v_lshlrev_b32 v22, 16, v221
    v_and_b32 v23, 0xffff0000, v221
    ds_read_b64_tr_b16 v[60:61], v8 offset:32768
    ds_read_b64_tr_b16 v[62:63], v8 offset:33792
    v_mfma_f32_32x32x16_bf16 a[80:95], v[12:15], v[80:83], a[80:95]
    v_lshlrev_b32 v24, 16, v222
    v_and_b32 v25, 0xffff0000, v222
    v_lshlrev_b32 v26, 16, v223
    v_and_b32 v27, 0xffff0000, v223
    ds_read_b64_tr_b16 v[64:65], v9 offset:32768
    ds_read_b64_tr_b16 v[66:67], v9 offset:33792
    v_mfma_f32_32x32x16_bf16 a[96:111], v[12:15], v[84:87], a[96:111]
    v_mul_f32_dpp v20, v39, v20 row_newbcast:8 row_mask:0xf bank_mask:0xf
    v_mul_f32_dpp v21, v39, v21 row_newbcast:9 row_mask:0xf bank_mask:0xf
    v_mul_f32_dpp v22, v39, v22 row_newbcast:10 row_mask:0xf bank_mask:0xf
    v_mul_f32_dpp v23, v39, v23 row_newbcast:11 row_mask:0xf bank_mask:0xf
    ds_read_b64_tr_b16 v[68:69], v10 offset:32768
    v_mfma_f32_32x32x16_bf16 a[112:127], v[12:15], v[88:91], a[112:127]
    v_mul_f32_dpp v24, v39, v24 row_newbcast:12 row_mask:0xf bank_mask:0xf
    v_mul_f32_dpp v25, v39, v25 row_newbcast:13 row_mask:0xf bank_mask:0xf
    v_mul_f32_dpp v26, v39, v26 row_newbcast:14 row_mask:0xf bank_mask:0xf
    v_mul_f32_dpp v27, v39, v27 row_newbcast:15 row_mask:0xf bank_mask:0xf
    ds_read_b64_tr_b16 v[70:71], v10 offset:33792
    v_mfma_f32_32x32x16_bf16 v[44:59], v[76:79], a[216:219], v[44:59]
    v_cvt_pk_bf16_f32 v16, v20, v21
    v_cvt_pk_bf16_f32 v17, v22, v23
    v_cvt_pk_bf16_f32 v18, v24, v25
    v_cvt_pk_bf16_f32 v19, v26, v27
    ds_read_b64_tr_b16 v[72:73], v11 offset:32768
    ds_read_b64_tr_b16 v[74:75], v11 offset:33792
    s_waitcnt lgkmcnt(8)
    v_mfma_f32_32x32x16_bf16 a[64:79], v[16:19], v[92:95], a[64:79]
    v_lshlrev_b32 v20, 16, v224
    v_and_b32 v21, 0xffff0000, v224
    v_lshlrev_b32 v22, 16, v225
    v_and_b32 v23, 0xffff0000, v225
    ds_read_b64_tr_b16 v[76:77], v8 offset:36864
    ds_read_b64_tr_b16 v[78:79], v8 offset:37888
    v_mfma_f32_32x32x16_bf16 a[80:95], v[16:19], v[96:99], a[80:95]
    v_lshlrev_b32 v24, 16, v226
    v_and_b32 v25, 0xffff0000, v226
    v_lshlrev_b32 v26, 16, v227
    v_and_b32 v27, 0xffff0000, v227
    ds_read_b64_tr_b16 v[80:81], v9 offset:36864
    ds_read_b64_tr_b16 v[82:83], v9 offset:37888
    v_mfma_f32_32x32x16_bf16 a[96:111], v[16:19], v[100:103], a[96:111]
    v_mul_f32_dpp v20, v40, v20 row_newbcast:0 row_mask:0xf bank_mask:0xf
    v_mul_f32_dpp v21, v40, v21 row_newbcast:1 row_mask:0xf bank_mask:0xf
    v_mul_f32_dpp v22, v40, v22 row_newbcast:2 row_mask:0xf bank_mask:0xf
    v_mul_f32_dpp v23, v40, v23 row_newbcast:3 row_mask:0xf bank_mask:0xf
    ds_read_b64_tr_b16 v[84:85], v10 offset:36864
    v_mfma_f32_32x32x16_bf16 a[112:127], v[16:19], v[104:107], a[112:127]
    v_mul_f32_dpp v24, v40, v24 row_newbcast:4 row_mask:0xf bank_mask:0xf
    v_mul_f32_dpp v25, v40, v25 row_newbcast:5 row_mask:0xf bank_mask:0xf
    v_mul_f32_dpp v26, v40, v26 row_newbcast:6 row_mask:0xf bank_mask:0xf
    v_mul_f32_dpp v27, v40, v27 row_newbcast:7 row_mask:0xf bank_mask:0xf
    ds_read_b64_tr_b16 v[86:87], v10 offset:37888
    v_mfma_f32_32x32x16_bf16 v[44:59], v[92:95], a[220:223], v[44:59]
    v_cvt_pk_bf16_f32 v12, v20, v21
    v_cvt_pk_bf16_f32 v13, v22, v23
    v_cvt_pk_bf16_f32 v14, v24, v25
    v_cvt_pk_bf16_f32 v15, v26, v27
    ds_read_b64_tr_b16 v[88:89], v11 offset:36864
    ds_read_b64_tr_b16 v[90:91], v11 offset:37888
    s_waitcnt lgkmcnt(8)
    v_mfma_f32_32x32x16_bf16 a[64:79], v[12:15], v[60:63], a[64:79]
    v_lshlrev_b32 v20, 16, v228
    v_and_b32 v21, 0xffff0000, v228
    v_lshlrev_b32 v22, 16, v229
    v_and_b32 v23, 0xffff0000, v229
    ds_read_b64_tr_b16 v[92:93], v8 offset:40960
    ds_read_b64_tr_b16 v[94:95], v8 offset:41984
    v_mfma_f32_32x32x16_bf16 a[80:95], v[12:15], v[64:67], a[80:95]
    v_lshlrev_b32 v24, 16, v230
    v_and_b32 v25, 0xffff0000, v230
    v_lshlrev_b32 v26, 16, v231
    v_and_b32 v27, 0xffff0000, v231
    ds_read_b64_tr_b16 v[96:97], v9 offset:40960
    ds_read_b64_tr_b16 v[98:99], v9 offset:41984
    v_mfma_f32_32x32x16_bf16 a[96:111], v[12:15], v[68:71], a[96:111]
    v_mul_f32_dpp v20, v40, v20 row_newbcast:8 row_mask:0xf bank_mask:0xf
    v_mul_f32_dpp v21, v40, v21 row_newbcast:9 row_mask:0xf bank_mask:0xf
    v_mul_f32_dpp v22, v40, v22 row_newbcast:10 row_mask:0xf bank_mask:0xf
    v_mul_f32_dpp v23, v40, v23 row_newbcast:11 row_mask:0xf bank_mask:0xf
    ds_read_b64_tr_b16 v[100:101], v10 offset:40960
    v_mfma_f32_32x32x16_bf16 a[112:127], v[12:15], v[72:75], a[112:127]
    v_mul_f32_dpp v24, v40, v24 row_newbcast:12 row_mask:0xf bank_mask:0xf
    v_mul_f32_dpp v25, v40, v25 row_newbcast:13 row_mask:0xf bank_mask:0xf
    v_mul_f32_dpp v26, v40, v26 row_newbcast:14 row_mask:0xf bank_mask:0xf
    v_mul_f32_dpp v27, v40, v27 row_newbcast:15 row_mask:0xf bank_mask:0xf
    ds_read_b64_tr_b16 v[102:103], v10 offset:41984
    v_mfma_f32_32x32x16_bf16 v[44:59], v[60:63], a[224:227], v[44:59]
    v_cvt_pk_bf16_f32 v16, v20, v21
    v_cvt_pk_bf16_f32 v17, v22, v23
    v_cvt_pk_bf16_f32 v18, v24, v25
    v_cvt_pk_bf16_f32 v19, v26, v27
    ds_read_b64_tr_b16 v[104:105], v11 offset:40960
    ds_read_b64_tr_b16 v[106:107], v11 offset:41984
    s_waitcnt lgkmcnt(8)
    v_mfma_f32_32x32x16_bf16 a[64:79], v[16:19], v[76:79], a[64:79]
    v_lshlrev_b32 v20, 16, v232
    v_and_b32 v21, 0xffff0000, v232
    v_lshlrev_b32 v22, 16, v233
    v_and_b32 v23, 0xffff0000, v233
    ds_read_b64_tr_b16 v[60:61], v8 offset:45056
    ds_read_b64_tr_b16 v[62:63], v8 offset:46080
    v_mfma_f32_32x32x16_bf16 a[80:95], v[16:19], v[80:83], a[80:95]
    v_lshlrev_b32 v24, 16, v234
    v_and_b32 v25, 0xffff0000, v234
    v_lshlrev_b32 v26, 16, v235
    v_and_b32 v27, 0xffff0000, v235
    ds_read_b64_tr_b16 v[64:65], v9 offset:45056
    ds_read_b64_tr_b16 v[66:67], v9 offset:46080
    v_mfma_f32_32x32x16_bf16 a[96:111], v[16:19], v[84:87], a[96:111]
    v_mul_f32_dpp v20, v41, v20 row_newbcast:0 row_mask:0xf bank_mask:0xf
    v_mul_f32_dpp v21, v41, v21 row_newbcast:1 row_mask:0xf bank_mask:0xf
    v_mul_f32_dpp v22, v41, v22 row_newbcast:2 row_mask:0xf bank_mask:0xf
    v_mul_f32_dpp v23, v41, v23 row_newbcast:3 row_mask:0xf bank_mask:0xf
    ds_read_b64_tr_b16 v[68:69], v10 offset:45056
    v_mfma_f32_32x32x16_bf16 a[112:127], v[16:19], v[88:91], a[112:127]
    v_mul_f32_dpp v24, v41, v24 row_newbcast:4 row_mask:0xf bank_mask:0xf
    v_mul_f32_dpp v25, v41, v25 row_newbcast:5 row_mask:0xf bank_mask:0xf
    v_mul_f32_dpp v26, v41, v26 row_newbcast:6 row_mask:0xf bank_mask:0xf
    v_mul_f32_dpp v27, v41, v27 row_newbcast:7 row_mask:0xf bank_mask:0xf
    ds_read_b64_tr_b16 v[70:71], v10 offset:46080
    v_mfma_f32_32x32x16_bf16 v[44:59], v[76:79], a[228:231], v[44:59]
    v_cvt_pk_bf16_f32 v12, v20, v21
    v_cvt_pk_bf16_f32 v13, v22, v23
    v_cvt_pk_bf16_f32 v14, v24, v25
    v_cvt_pk_bf16_f32 v15, v26, v27
    ds_read_b64_tr_b16 v[72:73], v11 offset:45056
    ds_read_b64_tr_b16 v[74:75], v11 offset:46080
    s_waitcnt lgkmcnt(8)
    v_mfma_f32_32x32x16_bf16 a[64:79], v[12:15], v[92:95], a[64:79]
    v_lshlrev_b32 v20, 16, v236
    v_and_b32 v21, 0xffff0000, v236
    v_lshlrev_b32 v22, 16, v237
    v_and_b32 v23, 0xffff0000, v237
    ds_read_b64_tr_b16 v[76:77], v8 offset:49152
    ds_read_b64_tr_b16 v[78:79], v8 offset:50176
    v_mfma_f32_32x32x16_bf16 a[80:95], v[12:15], v[96:99], a[80:95]
    v_lshlrev_b32 v24, 16, v238
    v_and_b32 v25, 0xffff0000, v238
    v_lshlrev_b32 v26, 16, v239
    v_and_b32 v27, 0xffff0000, v239
    ds_read_b64_tr_b16 v[80:81], v9 offset:49152
    ds_read_b64_tr_b16 v[82:83], v9 offset:50176
    v_mfma_f32_32x32x16_bf16 a[96:111], v[12:15], v[100:103], a[96:111]
    v_mul_f32_dpp v20, v41, v20 row_newbcast:8 row_mask:0xf bank_mask:0xf
    v_mul_f32_dpp v21, v41, v21 row_newbcast:9 row_mask:0xf bank_mask:0xf
    v_mul_f32_dpp v22, v41, v22 row_newbcast:10 row_mask:0xf bank_mask:0xf
    v_mul_f32_dpp v23, v41, v23 row_newbcast:11 row_mask:0xf bank_mask:0xf
    ds_read_b64_tr_b16 v[84:85], v10 offset:49152
    v_mfma_f32_32x32x16_bf16 a[112:127], v[12:15], v[104:107], a[112:127]
    v_mul_f32_dpp v24, v41, v24 row_newbcast:12 row_mask:0xf bank_mask:0xf
    v_mul_f32_dpp v25, v41, v25 row_newbcast:13 row_mask:0xf bank_mask:0xf
    v_mul_f32_dpp v26, v41, v26 row_newbcast:14 row_mask:0xf bank_mask:0xf
    v_mul_f32_dpp v27, v41, v27 row_newbcast:15 row_mask:0xf bank_mask:0xf
    ds_read_b64_tr_b16 v[86:87], v10 offset:50176
    v_mfma_f32_32x32x16_bf16 v[44:59], v[92:95], a[232:235], v[44:59]
    v_cvt_pk_bf16_f32 v16, v20, v21
    v_cvt_pk_bf16_f32 v17, v22, v23
    v_cvt_pk_bf16_f32 v18, v24, v25
    v_cvt_pk_bf16_f32 v19, v26, v27
    ds_read_b64_tr_b16 v[88:89], v11 offset:49152
    ds_read_b64_tr_b16 v[90:91], v11 offset:50176
    s_waitcnt lgkmcnt(8)
    v_mfma_f32_32x32x16_bf16 a[64:79], v[16:19], v[60:63], a[64:79]
    v_lshlrev_b32 v20, 16, v240
    v_and_b32 v21, 0xffff0000, v240
    v_lshlrev_b32 v22, 16, v241
    v_and_b32 v23, 0xffff0000, v241
    ds_read_b64_tr_b16 v[92:93], v8 offset:53248
    ds_read_b64_tr_b16 v[94:95], v8 offset:54272
    v_mfma_f32_32x32x16_bf16 a[80:95], v[16:19], v[64:67], a[80:95]
    v_lshlrev_b32 v24, 16, v242
    v_and_b32 v25, 0xffff0000, v242
    v_lshlrev_b32 v26, 16, v243
    v_and_b32 v27, 0xffff0000, v243
    ds_read_b64_tr_b16 v[96:97], v9 offset:53248
    ds_read_b64_tr_b16 v[98:99], v9 offset:54272
    v_mfma_f32_32x32x16_bf16 a[96:111], v[16:19], v[68:71], a[96:111]
    v_mul_f32_dpp v20, v42, v20 row_newbcast:0 row_mask:0xf bank_mask:0xf
    v_mul_f32_dpp v21, v42, v21 row_newbcast:1 row_mask:0xf bank_mask:0xf
    v_mul_f32_dpp v22, v42, v22 row_newbcast:2 row_mask:0xf bank_mask:0xf
    v_mul_f32_dpp v23, v42, v23 row_newbcast:3 row_mask:0xf bank_mask:0xf
    ds_read_b64_tr_b16 v[100:101], v10 offset:53248
    v_mfma_f32_32x32x16_bf16 a[112:127], v[16:19], v[72:75], a[112:127]
    v_mul_f32_dpp v24, v42, v24 row_newbcast:4 row_mask:0xf bank_mask:0xf
    v_mul_f32_dpp v25, v42, v25 row_newbcast:5 row_mask:0xf bank_mask:0xf
    v_mul_f32_dpp v26, v42, v26 row_newbcast:6 row_mask:0xf bank_mask:0xf
    v_mul_f32_dpp v27, v42, v27 row_newbcast:7 row_mask:0xf bank_mask:0xf
    ds_read_b64_tr_b16 v[102:103], v10 offset:54272
    v_mfma_f32_32x32x16_bf16 v[44:59], v[60:63], a[236:239], v[44:59]
    v_cvt_pk_bf16_f32 v12, v20, v21
    v_cvt_pk_bf16_f32 v13, v22, v23
    v_cvt_pk_bf16_f32 v14, v24, v25
    v_cvt_pk_bf16_f32 v15, v26, v27
    ds_read_b64_tr_b16 v[104:105], v11 offset:53248
    ds_read_b64_tr_b16 v[106:107], v11 offset:54272
    s_waitcnt lgkmcnt(8)
    v_mfma_f32_32x32x16_bf16 a[64:79], v[12:15], v[76:79], a[64:79]
    v_lshlrev_b32 v20, 16, v244
    v_and_b32 v21, 0xffff0000, v244
    v_lshlrev_b32 v22, 16, v245
    v_and_b32 v23, 0xffff0000, v245
    ds_read_b64_tr_b16 v[60:61], v8 offset:57344
    ds_read_b64_tr_b16 v[62:63], v8 offset:58368
    v_mfma_f32_32x32x16_bf16 a[80:95], v[12:15], v[80:83], a[80:95]
    v_lshlrev_b32 v24, 16, v246
    v_and_b32 v25, 0xffff0000, v246
    v_lshlrev_b32 v26, 16, v247
    v_and_b32 v27, 0xffff0000, v247
    ds_read_b64_tr_b16 v[64:65], v9 offset:57344
    ds_read_b64_tr_b16 v[66:67], v9 offset:58368
    v_mfma_f32_32x32x16_bf16 a[96:111], v[12:15], v[84:87], a[96:111]
    v_mul_f32_dpp v20, v42, v20 row_newbcast:8 row_mask:0xf bank_mask:0xf
    v_mul_f32_dpp v21, v42, v21 row_newbcast:9 row_mask:0xf bank_mask:0xf
    v_mul_f32_dpp v22, v42, v22 row_newbcast:10 row_mask:0xf bank_mask:0xf
    v_mul_f32_dpp v23, v42, v23 row_newbcast:11 row_mask:0xf bank_mask:0xf
    ds_read_b64_tr_b16 v[68:69], v10 offset:57344
    v_mfma_f32_32x32x16_bf16 a[112:127], v[12:15], v[88:91], a[112:127]
    v_mul_f32_dpp v24, v42, v24 row_newbcast:12 row_mask:0xf bank_mask:0xf
    v_mul_f32_dpp v25, v42, v25 row_newbcast:13 row_mask:0xf bank_mask:0xf
    v_mul_f32_dpp v26, v42, v26 row_newbcast:14 row_mask:0xf bank_mask:0xf
    v_mul_f32_dpp v27, v42, v27 row_newbcast:15 row_mask:0xf bank_mask:0xf
    ds_read_b64_tr_b16 v[70:71], v10 offset:58368
    v_mfma_f32_32x32x16_bf16 v[44:59], v[76:79], a[240:243], v[44:59]
    v_cvt_pk_bf16_f32 v16, v20, v21
    v_cvt_pk_bf16_f32 v17, v22, v23
    v_cvt_pk_bf16_f32 v18, v24, v25
    v_cvt_pk_bf16_f32 v19, v26, v27
    ds_read_b64_tr_b16 v[72:73], v11 offset:57344
    ds_read_b64_tr_b16 v[74:75], v11 offset:58368
    s_waitcnt lgkmcnt(8)
    v_mfma_f32_32x32x16_bf16 a[64:79], v[16:19], v[92:95], a[64:79]
    v_lshlrev_b32 v20, 16, v248
    v_and_b32 v21, 0xffff0000, v248
    v_lshlrev_b32 v22, 16, v249
    v_and_b32 v23, 0xffff0000, v249
    ds_read_b64_tr_b16 v[76:77], v8 offset:61440
    ds_read_b64_tr_b16 v[78:79], v8 offset:62464
    v_mfma_f32_32x32x16_bf16 a[80:95], v[16:19], v[96:99], a[80:95]
    v_lshlrev_b32 v24, 16, v250
    v_and_b32 v25, 0xffff0000, v250
    v_lshlrev_b32 v26, 16, v251
    v_and_b32 v27, 0xffff0000, v251
    ds_read_b64_tr_b16 v[80:81], v9 offset:61440
    ds_read_b64_tr_b16 v[82:83], v9 offset:62464
    v_mfma_f32_32x32x16_bf16 a[96:111], v[16:19], v[100:103], a[96:111]
    v_mul_f32_dpp v20, v43, v20 row_newbcast:0 row_mask:0xf bank_mask:0xf
    v_mul_f32_dpp v21, v43, v21 row_newbcast:1 row_mask:0xf bank_mask:0xf
    v_mul_f32_dpp v22, v43, v22 row_newbcast:2 row_mask:0xf bank_mask:0xf
    v_mul_f32_dpp v23, v43, v23 row_newbcast:3 row_mask:0xf bank_mask:0xf
    ds_read_b64_tr_b16 v[84:85], v10 offset:61440
    v_mfma_f32_32x32x16_bf16 a[112:127], v[16:19], v[104:107], a[112:127]
    v_mul_f32_dpp v24, v43, v24 row_newbcast:4 row_mask:0xf bank_mask:0xf
    v_mul_f32_dpp v25, v43, v25 row_newbcast:5 row_mask:0xf bank_mask:0xf
    v_mul_f32_dpp v26, v43, v26 row_newbcast:6 row_mask:0xf bank_mask:0xf
    v_mul_f32_dpp v27, v43, v27 row_newbcast:7 row_mask:0xf bank_mask:0xf
    ds_read_b64_tr_b16 v[86:87], v10 offset:62464
    v_mfma_f32_32x32x16_bf16 v[44:59], v[92:95], a[244:247], v[44:59]
    v_cvt_pk_bf16_f32 v12, v20, v21
    v_cvt_pk_bf16_f32 v13, v22, v23
    v_cvt_pk_bf16_f32 v14, v24, v25
    v_cvt_pk_bf16_f32 v15, v26, v27
    ds_read_b64_tr_b16 v[88:89], v11 offset:61440
    ds_read_b64_tr_b16 v[90:91], v11 offset:62464
    s_waitcnt lgkmcnt(8)
    v_mfma_f32_32x32x16_bf16 a[64:79], v[12:15], v[60:63], a[64:79]
    v_lshlrev_b32 v20, 16, v252
    v_and_b32 v21, 0xffff0000, v252
    v_lshlrev_b32 v22, 16, v253
    v_and_b32 v23, 0xffff0000, v253
    v_mfma_f32_32x32x16_bf16 a[80:95], v[12:15], v[64:67], a[80:95]
    v_lshlrev_b32 v24, 16, v254
    v_and_b32 v25, 0xffff0000, v254
    v_lshlrev_b32 v26, 16, v255
    v_and_b32 v27, 0xffff0000, v255
    v_mfma_f32_32x32x16_bf16 a[96:111], v[12:15], v[68:71], a[96:111]
    v_mul_f32_dpp v20, v43, v20 row_newbcast:8 row_mask:0xf bank_mask:0xf
    v_mul_f32_dpp v21, v43, v21 row_newbcast:9 row_mask:0xf bank_mask:0xf
    v_mul_f32_dpp v22, v43, v22 row_newbcast:10 row_mask:0xf bank_mask:0xf
    v_mul_f32_dpp v23, v43, v23 row_newbcast:11 row_mask:0xf bank_mask:0xf
    v_mfma_f32_32x32x16_bf16 a[112:127], v[12:15], v[72:75], a[112:127]
    v_mul_f32_dpp v24, v43, v24 row_newbcast:12 row_mask:0xf bank_mask:0xf
    v_mul_f32_dpp v25, v43, v25 row_newbcast:13 row_mask:0xf bank_mask:0xf
    v_mul_f32_dpp v26, v43, v26 row_newbcast:14 row_mask:0xf bank_mask:0xf
    v_mul_f32_dpp v27, v43, v27 row_newbcast:15 row_mask:0xf bank_mask:0xf
    v_mfma_f32_32x32x16_bf16 v[44:59], v[60:63], a[248:251], v[44:59]
    v_cvt_pk_bf16_f32 v16, v20, v21
    v_cvt_pk_bf16_f32 v17, v22, v23
    v_cvt_pk_bf16_f32 v18, v24, v25
    v_cvt_pk_bf16_f32 v19, v26, v27
    s_waitcnt lgkmcnt(0)
    s_nop 0
    v_mfma_f32_32x32x16_bf16 a[64:79], v[16:19], v[76:79], a[64:79]
    v_mfma_f32_32x32x16_bf16 a[80:95], v[16:19], v[80:83], a[80:95]
    v_mfma_f32_32x32x16_bf16 a[96:111], v[16:19], v[84:87], a[96:111]
    v_mfma_f32_32x32x16_bf16 a[112:127], v[16:19], v[88:91], a[112:127]
    v_mfma_f32_32x32x16_bf16 v[44:59], v[76:79], a[252:255], v[44:59]
    v_and_b32 v14, 1, v1
    v_lshlrev_b32 v14, 9, v14
    v_lshl_add_u32 v14, v3, 4, v14
    s_lshl_b32 s3, s6, 7
    s_add_u32 s3, s3, 139264
    v_add_u32 v14, s3, v14
    s_mov_b32 exec_lo, 3
    s_mov_b32 exec_hi, 3
    s_nop 7
    ds_write_b128 v14, v[44:47] offset:0
    ds_write_b128 v14, v[48:51] offset:32
    ds_write_b128 v14, v[52:55] offset:64
    ds_write_b128 v14, v[56:59] offset:96
    s_mov_b64 exec, -1
    v_accvgpr_read_b32 v60, a64
    v_accvgpr_read_b32 v61, a65
    v_accvgpr_read_b32 v62, a66
    v_accvgpr_read_b32 v63, a67
    v_accvgpr_read_b32 v64, a68
    v_accvgpr_read_b32 v65, a69
    v_accvgpr_read_b32 v66, a70
    v_accvgpr_read_b32 v67, a71
    v_accvgpr_read_b32 v68, a72
    v_accvgpr_read_b32 v69, a73
    v_accvgpr_read_b32 v70, a74
    v_accvgpr_read_b32 v71, a75
    v_accvgpr_read_b32 v72, a76
    v_accvgpr_read_b32 v73, a77
    v_accvgpr_read_b32 v74, a78
    v_accvgpr_read_b32 v75, a79
    v_accvgpr_read_b32 v76, a80
    v_accvgpr_read_b32 v77, a81
    v_accvgpr_read_b32 v78, a82
    v_accvgpr_read_b32 v79, a83
    v_accvgpr_read_b32 v80, a84
    v_accvgpr_read_b32 v81, a85
    v_accvgpr_read_b32 v82, a86
    v_accvgpr_read_b32 v83, a87
    v_accvgpr_read_b32 v84, a88
    v_accvgpr_read_b32 v85, a89
    v_accvgpr_read_b32 v86, a90
    v_accvgpr_read_b32 v87, a91
    v_accvgpr_read_b32 v88, a92
    v_accvgpr_read_b32 v89, a93
    v_accvgpr_read_b32 v90, a94
    v_accvgpr_read_b32 v91, a95
    v_accvgpr_read_b32 v92, a96
    v_accvgpr_read_b32 v93, a97
    v_accvgpr_read_b32 v94, a98
    v_accvgpr_read_b32 v95, a99
    v_accvgpr_read_b32 v96, a100
    v_accvgpr_read_b32 v97, a101
    v_accvgpr_read_b32 v98, a102
    v_accvgpr_read_b32 v99, a103
    v_accvgpr_read_b32 v100, a104
    v_accvgpr_read_b32 v101, a105
    v_accvgpr_read_b32 v102, a106
    v_accvgpr_read_b32 v103, a107
    v_accvgpr_read_b32 v104, a108
    v_accvgpr_read_b32 v105, a109
    v_accvgpr_read_b32 v106, a110
    v_accvgpr_read_b32 v107, a111
    v_accvgpr_read_b32 v108, a112
    v_accvgpr_read_b32 v109, a113
    v_accvgpr_read_b32 v110, a114
    v_accvgpr_read_b32 v111, a115
    v_accvgpr_read_b32 v112, a116
    v_accvgpr_read_b32 v113, a117
    v_accvgpr_read_b32 v114, a118
    v_accvgpr_read_b32 v115, a119
    v_accvgpr_read_b32 v116, a120
    v_accvgpr_read_b32 v117, a121
    v_accvgpr_read_b32 v118, a122
    v_accvgpr_read_b32 v119, a123
    v_accvgpr_read_b32 v120, a124
    v_accvgpr_read_b32 v121, a125
    v_accvgpr_read_b32 v122, a126
    v_accvgpr_read_b32 v123, a127
    s_lshl_b32 s3, s6, 8
    s_add_u32 s3, s3, 141312
    v_lshlrev_b32 v14, 2, v2
    v_add_u32 v14, s3, v14
    ds_write_b32 v14, v4
    ds_write_b32 v14, v5 offset:128
    v_lshlrev_b32 v15, 4, v3
    v_add_u32 v15, s3, v15
    s_waitcnt lgkmcnt(0)
    s_barrier
    ds_read_b128 v[128:131], v15 offset:0
    ds_read_b128 v[144:147], v15 offset:128
    ds_read_b128 v[132:135], v15 offset:32
    ds_read_b128 v[148:151], v15 offset:160
    ds_read_b128 v[136:139], v15 offset:64
    ds_read_b128 v[152:155], v15 offset:192
    ds_read_b128 v[140:143], v15 offset:96
    ds_read_b128 v[156:159], v15 offset:224
    s_lshl_b32 s3, s62, 7
    s_add_u32 s3, s3, 139264
    v_lshlrev_b32 v14, 2, v2
    v_add_u32 v14, s3, v14
    ds_read_b32 v160, v14
    ds_read_b32 v161, v14 offset:512
    s_lshl_b32 s3, s63, 7
    s_add_u32 s3, s3, 139264
    v_lshlrev_b32 v14, 2, v2
    v_add_u32 v14, s3, v14
    ds_read_b32 v162, v14
    ds_read_b32 v163, v14 offset:512
    s_lshl_b32 s3, s64, 7
    s_add_u32 s3, s3, 139264
    v_lshlrev_b32 v14, 2, v2
    v_add_u32 v14, s3, v14
    ds_read_b32 v164, v14
    ds_read_b32 v165, v14 offset:512
    s_lshl_b32 s3, s65, 7
    s_add_u32 s3, s3, 139264
    v_lshlrev_b32 v14, 2, v2
    v_add_u32 v14, s3, v14
    ds_read_b32 v166, v14
    ds_read_b32 v167, v14 offset:512
    s_waitcnt lgkmcnt(0)
    v_pk_fma_f32 v[168:169], v[144:145], v[160:161], v[160:161] op_sel:[0,0,1] op_sel_hi:[1,0,1]
    v_pk_fma_f32 v[170:171], v[146:147], v[160:161], v[160:161] op_sel:[0,0,1] op_sel_hi:[1,0,1]
    v_pk_fma_f32 v[172:173], v[148:149], v[160:161], v[160:161] op_sel:[0,0,1] op_sel_hi:[1,0,1]
    v_pk_fma_f32 v[174:175], v[150:151], v[160:161], v[160:161] op_sel:[0,0,1] op_sel_hi:[1,0,1]
    v_pk_fma_f32 v[176:177], v[152:153], v[160:161], v[160:161] op_sel:[0,0,1] op_sel_hi:[1,0,1]
    v_pk_fma_f32 v[178:179], v[154:155], v[160:161], v[160:161] op_sel:[0,0,1] op_sel_hi:[1,0,1]
    v_pk_fma_f32 v[180:181], v[156:157], v[160:161], v[160:161] op_sel:[0,0,1] op_sel_hi:[1,0,1]
    v_pk_fma_f32 v[182:183], v[158:159], v[160:161], v[160:161] op_sel:[0,0,1] op_sel_hi:[1,0,1]
    v_pk_fma_f32 v[60:61], v[60:61], v[128:129], v[168:169]
    v_pk_fma_f32 v[62:63], v[62:63], v[130:131], v[170:171]
    v_pk_fma_f32 v[64:65], v[64:65], v[132:133], v[172:173]
    v_pk_fma_f32 v[66:67], v[66:67], v[134:135], v[174:175]
    v_pk_fma_f32 v[68:69], v[68:69], v[136:137], v[176:177]
    v_pk_fma_f32 v[70:71], v[70:71], v[138:139], v[178:179]
    v_pk_fma_f32 v[72:73], v[72:73], v[140:141], v[180:181]
    v_pk_fma_f32 v[74:75], v[74:75], v[142:143], v[182:183]
    v_pk_fma_f32 v[168:169], v[144:145], v[162:163], v[162:163] op_sel:[0,0,1] op_sel_hi:[1,0,1]
    v_pk_fma_f32 v[170:171], v[146:147], v[162:163], v[162:163] op_sel:[0,0,1] op_sel_hi:[1,0,1]
    v_pk_fma_f32 v[172:173], v[148:149], v[162:163], v[162:163] op_sel:[0,0,1] op_sel_hi:[1,0,1]
    v_pk_fma_f32 v[174:175], v[150:151], v[162:163], v[162:163] op_sel:[0,0,1] op_sel_hi:[1,0,1]
    v_pk_fma_f32 v[176:177], v[152:153], v[162:163], v[162:163] op_sel:[0,0,1] op_sel_hi:[1,0,1]
    v_pk_fma_f32 v[178:179], v[154:155], v[162:163], v[162:163] op_sel:[0,0,1] op_sel_hi:[1,0,1]
    v_pk_fma_f32 v[180:181], v[156:157], v[162:163], v[162:163] op_sel:[0,0,1] op_sel_hi:[1,0,1]
    v_pk_fma_f32 v[182:183], v[158:159], v[162:163], v[162:163] op_sel:[0,0,1] op_sel_hi:[1,0,1]
    v_pk_fma_f32 v[76:77], v[76:77], v[128:129], v[168:169]
    v_pk_fma_f32 v[78:79], v[78:79], v[130:131], v[170:171]
    v_pk_fma_f32 v[80:81], v[80:81], v[132:133], v[172:173]
    v_pk_fma_f32 v[82:83], v[82:83], v[134:135], v[174:175]
    v_pk_fma_f32 v[84:85], v[84:85], v[136:137], v[176:177]
    v_pk_fma_f32 v[86:87], v[86:87], v[138:139], v[178:179]
    v_pk_fma_f32 v[88:89], v[88:89], v[140:141], v[180:181]
    v_pk_fma_f32 v[90:91], v[90:91], v[142:143], v[182:183]
    v_pk_fma_f32 v[168:169], v[144:145], v[164:165], v[164:165] op_sel:[0,0,1] op_sel_hi:[1,0,1]
    v_pk_fma_f32 v[170:171], v[146:147], v[164:165], v[164:165] op_sel:[0,0,1] op_sel_hi:[1,0,1]
    v_pk_fma_f32 v[172:173], v[148:149], v[164:165], v[164:165] op_sel:[0,0,1] op_sel_hi:[1,0,1]
    v_pk_fma_f32 v[174:175], v[150:151], v[164:165], v[164:165] op_sel:[0,0,1] op_sel_hi:[1,0,1]
    v_pk_fma_f32 v[176:177], v[152:153], v[164:165], v[164:165] op_sel:[0,0,1] op_sel_hi:[1,0,1]
    v_pk_fma_f32 v[178:179], v[154:155], v[164:165], v[164:165] op_sel:[0,0,1] op_sel_hi:[1,0,1]
    v_pk_fma_f32 v[180:181], v[156:157], v[164:165], v[164:165] op_sel:[0,0,1] op_sel_hi:[1,0,1]
    v_pk_fma_f32 v[182:183], v[158:159], v[164:165], v[164:165] op_sel:[0,0,1] op_sel_hi:[1,0,1]
    v_pk_fma_f32 v[92:93], v[92:93], v[128:129], v[168:169]
    v_pk_fma_f32 v[94:95], v[94:95], v[130:131], v[170:171]
    v_pk_fma_f32 v[96:97], v[96:97], v[132:133], v[172:173]
    v_pk_fma_f32 v[98:99], v[98:99], v[134:135], v[174:175]
    v_pk_fma_f32 v[100:101], v[100:101], v[136:137], v[176:177]
    v_pk_fma_f32 v[102:103], v[102:103], v[138:139], v[178:179]
    v_pk_fma_f32 v[104:105], v[104:105], v[140:141], v[180:181]
    v_pk_fma_f32 v[106:107], v[106:107], v[142:143], v[182:183]
    v_pk_fma_f32 v[168:169], v[144:145], v[166:167], v[166:167] op_sel:[0,0,1] op_sel_hi:[1,0,1]
    v_pk_fma_f32 v[170:171], v[146:147], v[166:167], v[166:167] op_sel:[0,0,1] op_sel_hi:[1,0,1]
    v_pk_fma_f32 v[172:173], v[148:149], v[166:167], v[166:167] op_sel:[0,0,1] op_sel_hi:[1,0,1]
    v_pk_fma_f32 v[174:175], v[150:151], v[166:167], v[166:167] op_sel:[0,0,1] op_sel_hi:[1,0,1]
    v_pk_fma_f32 v[176:177], v[152:153], v[166:167], v[166:167] op_sel:[0,0,1] op_sel_hi:[1,0,1]
    v_pk_fma_f32 v[178:179], v[154:155], v[166:167], v[166:167] op_sel:[0,0,1] op_sel_hi:[1,0,1]
    v_pk_fma_f32 v[180:181], v[156:157], v[166:167], v[166:167] op_sel:[0,0,1] op_sel_hi:[1,0,1]
    v_pk_fma_f32 v[182:183], v[158:159], v[166:167], v[166:167] op_sel:[0,0,1] op_sel_hi:[1,0,1]
    v_pk_fma_f32 v[108:109], v[108:109], v[128:129], v[168:169]
    v_pk_fma_f32 v[110:111], v[110:111], v[130:131], v[170:171]
    v_pk_fma_f32 v[112:113], v[112:113], v[132:133], v[172:173]
    v_pk_fma_f32 v[114:115], v[114:115], v[134:135], v[174:175]
    v_pk_fma_f32 v[116:117], v[116:117], v[136:137], v[176:177]
    v_pk_fma_f32 v[118:119], v[118:119], v[138:139], v[178:179]
    v_pk_fma_f32 v[120:121], v[120:121], v[140:141], v[180:181]
    v_pk_fma_f32 v[122:123], v[122:123], v[142:143], v[182:183]
    s_lshl_b32 s55, s53, 2
    s_add_u32 s55, s55, s6
    s_lshr_b32 s3, s54, 2
    s_lshl_b32 s56, s3, 21
    s_add_u32 s56, s56, 2097152
    s_and_b32 s59, s54, 3
    s_lshl_b32 s57, s59, 19
    s_add_u32 s56, s56, s57
    s_lshl_b32 s57, s55, 10
    s_add_u32 s56, s56, s57
    v_bfe_u32 v9, v1, 4, 1
    v_lshlrev_b32 v9, 16, v9
    v_and_b32 v10, 15, v1
    v_lshlrev_b32 v10, 4, v10
    v_lshlrev_b32 v11, 8, v3
    v_add3_u32 v9, v9, v10, v11
    v_cvt_pk_bf16_f32 v128, v60, v61
    v_cvt_pk_bf16_f32 v129, v62, v63
    v_cvt_pk_bf16_f32 v130, v64, v65
    v_cvt_pk_bf16_f32 v131, v66, v67
    s_nop 0
    v_permlane32_swap_b32 v128, v130
    v_permlane32_swap_b32 v129, v131
    s_lshl_b32 s57, s62, 17
    s_add_u32 s57, s57, s56
    buffer_store_dwordx4 v[128:131], v9, s[48:51], s57 offen offset:0 sc1
    v_cvt_pk_bf16_f32 v132, v68, v69
    v_cvt_pk_bf16_f32 v133, v70, v71
    v_cvt_pk_bf16_f32 v134, v72, v73
    v_cvt_pk_bf16_f32 v135, v74, v75
    s_nop 0
    v_permlane32_swap_b32 v132, v134
    v_permlane32_swap_b32 v133, v135
    s_lshl_b32 s57, s62, 17
    s_add_u32 s57, s57, s56
    buffer_store_dwordx4 v[132:135], v9, s[48:51], s57 offen offset:512 sc1
    v_cvt_pk_bf16_f32 v136, v76, v77
    v_cvt_pk_bf16_f32 v137, v78, v79
    v_cvt_pk_bf16_f32 v138, v80, v81
    v_cvt_pk_bf16_f32 v139, v82, v83
    s_nop 0
    v_permlane32_swap_b32 v136, v138
    v_permlane32_swap_b32 v137, v139
    s_lshl_b32 s57, s63, 17
    s_add_u32 s57, s57, s56
    buffer_store_dwordx4 v[136:139], v9, s[48:51], s57 offen offset:0 sc1
    v_cvt_pk_bf16_f32 v140, v84, v85
    v_cvt_pk_bf16_f32 v141, v86, v87
    v_cvt_pk_bf16_f32 v142, v88, v89
    v_cvt_pk_bf16_f32 v143, v90, v91
    s_nop 0
    v_permlane32_swap_b32 v140, v142
    v_permlane32_swap_b32 v141, v143
    s_lshl_b32 s57, s63, 17
    s_add_u32 s57, s57, s56
    buffer_store_dwordx4 v[140:143], v9, s[48:51], s57 offen offset:512 sc1
    v_cvt_pk_bf16_f32 v144, v92, v93
    v_cvt_pk_bf16_f32 v145, v94, v95
    v_cvt_pk_bf16_f32 v146, v96, v97
    v_cvt_pk_bf16_f32 v147, v98, v99
    s_nop 0
    v_permlane32_swap_b32 v144, v146
    v_permlane32_swap_b32 v145, v147
    s_lshl_b32 s57, s64, 17
    s_add_u32 s57, s57, s56
    buffer_store_dwordx4 v[144:147], v9, s[48:51], s57 offen offset:0 sc1
    v_cvt_pk_bf16_f32 v148, v100, v101
    v_cvt_pk_bf16_f32 v149, v102, v103
    v_cvt_pk_bf16_f32 v150, v104, v105
    v_cvt_pk_bf16_f32 v151, v106, v107
    s_nop 0
    v_permlane32_swap_b32 v148, v150
    v_permlane32_swap_b32 v149, v151
    s_lshl_b32 s57, s64, 17
    s_add_u32 s57, s57, s56
    buffer_store_dwordx4 v[148:151], v9, s[48:51], s57 offen offset:512 sc1
    v_cvt_pk_bf16_f32 v152, v108, v109
    v_cvt_pk_bf16_f32 v153, v110, v111
    v_cvt_pk_bf16_f32 v154, v112, v113
    v_cvt_pk_bf16_f32 v155, v114, v115
    s_nop 0
    v_permlane32_swap_b32 v152, v154
    v_permlane32_swap_b32 v153, v155
    s_lshl_b32 s57, s65, 17
    s_add_u32 s57, s57, s56
    buffer_store_dwordx4 v[152:155], v9, s[48:51], s57 offen offset:0 sc1
    v_cvt_pk_bf16_f32 v156, v116, v117
    v_cvt_pk_bf16_f32 v157, v118, v119
    v_cvt_pk_bf16_f32 v158, v120, v121
    v_cvt_pk_bf16_f32 v159, v122, v123
    s_nop 0
    v_permlane32_swap_b32 v156, v158
    v_permlane32_swap_b32 v157, v159
    s_lshl_b32 s57, s65, 17
    s_add_u32 s57, s57, s56
    buffer_store_dwordx4 v[156:159], v9, s[48:51], s57 offen offset:512 sc1
P1SIG:
    s_waitcnt vmcnt(0)
    s_barrier
    s_cmp_lg_u32 s6, 0
    s_cbranch_scc1 SG_12
    s_and_b32 s3, s54, 3
    s_lshl_b32 s3, s3, 1
    v_lshrrev_b32 v5, 5, v1
    v_add_u32 v5, s3, v5
    v_bfe_u32 v4, v1, 3, 2
    v_lshl_add_u32 v5, v4, 6, v5
    v_and_b32 v4, 7, v1
    v_lshl_add_u32 v5, v4, 3, v5
    s_lshr_b32 s3, s54, 2
    s_lshl_b32 s3, s3, 4
    s_add_u32 s3, s3, s53
    s_lshl_b32 s3, s3, 2
    v_lshl_add_u32 v5, v5, 8, s3
    s_mov_b32 s3, 393216
    v_mov_b32 v4, s7
    s_mov_b32 exec_lo, 0xffffffff
    s_mov_b32 exec_hi, 0xffffffff
    buffer_store_dword v4, v5, s[48:51], s3 offen sc0 sc1
    s_mov_b64 exec, -1
SG_12:
P1END:
    s_lshl_b32 s60, s4, 2
    s_lshr_b32 s3, s5, 3
    s_add_u32 s60, s60, s3
    s_and_b32 s61, s5, 7
    v_mov_b32 v12, 0x3f803f80
    v_mov_b32 v13, v12
    v_mov_b32 v14, v12
    v_mov_b32 v15, v12
    v_lshlrev_b32 v9, 4, v0
    v_add_u32 v9, 131072, v9
    ds_write_b128 v9, v[12:15]
    ds_write_b128 v9, v[12:15] offset:4096
    s_cmp_lg_u32 s6, 0
    s_cbranch_scc1 WT_14
    s_lshl_b32 s3, s2, 8
    v_lshrrev_b32 v5, 4, v1
    v_min_u32 v5, 2, v5
    v_and_b32 v4, 15, v1
    v_lshl_add_u32 v4, v5, 4, v4
    v_lshl_add_u32 v4, v4, 2, s3
    s_mov_b32 s3, 393216
    s_mov_b32 s52, 262144
WL_15:
    buffer_load_dword v5, v4, s[48:51], s3 offen sc0 sc1
    s_waitcnt vmcnt(0)
    v_cmp_ne_u32 vcc, s7, v5
    s_cbranch_vccz WE_13
    s_sub_u32 s52, s52, 1
    s_cmp_lg_u32 s52, 0
    s_cbranch_scc1 WL_15
    s_branch WE_13
WT_14:
WE_13:
    s_waitcnt vmcnt(0) lgkmcnt(0)
    s_barrier
    s_lshl_b32 s64, s60, 16
    s_lshl_b32 s3, s61, 3
    s_lshl_b32 s65, s6, 1
    s_add_u32 s3, s3, s65
    s_lshl_b32 s66, s3, 10
    s_add_u32 s66, s66, s64
    s_add_u32 s66, s66, 2097152
    v_lshlrev_b32 v14, 4, v1
    buffer_load_dwordx4 v[4:7], v14, s[48:51], s66 offen sc1
    buffer_load_dwordx4 v[8:11], v14, s[48:51], s66 offen offset:1024 sc1
    s_lshl_b32 s3, s60, 8
    s_add_u32 s3, s3, 294912
    v_lshlrev_b32 v13, 2, v1
    buffer_load_dword v80, v13, s[48:51], s3 offen sc1
    s_add_u32 s3, s3, 8192
    buffer_load_dword v81, v13, s[48:51], s3 offen sc1
    s_lshl_b32 s65, s6, 12
    s_add_u32 s64, s64, s65
    v_lshlrev_b32 v144, 4, v1
    s_add_u32 m0, s65, 0
    s_add_u32 s3, s64, 4194304
    buffer_load_dwordx4 v14, s[48:51], s3 offen sc1 lds
    s_add_u32 m0, s65, 65536
    s_add_u32 s3, s64, 6291456
    buffer_load_dwordx4 v14, s[48:51], s3 offen sc1 lds
    s_add_u32 m0, s65, 1024
    s_add_u32 s3, s64, 4195328
    buffer_load_dwordx4 v14, s[48:51], s3 offen sc1 lds
    s_add_u32 m0, s65, 66560
    s_add_u32 s3, s64, 6292480
    buffer_load_dwordx4 v14, s[48:51], s3 offen sc1 lds
    s_add_u32 m0, s65, 2048
    s_add_u32 s3, s64, 4196352
    buffer_load_dwordx4 v14, s[48:51], s3 offen sc1 lds
    s_add_u32 m0, s65, 67584
    s_add_u32 s3, s64, 6293504
    buffer_load_dwordx4 v14, s[48:51], s3 offen sc1 lds
    s_add_u32 m0, s65, 3072
    s_add_u32 s3, s64, 4197376
    buffer_load_dwordx4 v14, s[48:51], s3 offen sc1 lds
    s_add_u32 m0, s65, 68608
    s_add_u32 s3, s64, 6294528
    buffer_load_dwordx4 v14, s[48:51], s3 offen sc1 lds
    s_add_u32 m0, s65, 16384
    s_add_u32 s3, s64, 4210688
    buffer_load_dwordx4 v14, s[48:51], s3 offen sc1 lds
    s_add_u32 m0, s65, 81920
    s_add_u32 s3, s64, 6307840
    buffer_load_dwordx4 v14, s[48:51], s3 offen sc1 lds
    s_add_u32 s68, s65, 17408
    s_add_u32 s69, s64, 4211712
    s_lshl_b32 s3, s5, 2
    s_add_u32 s3, s3, s6
    s_mul_i32 s90, s3, 14336
    s_lshr_b32 s52, s4, 2
    s_mul_i32 s52, s52, 896
    s_add_u32 s90, s90, s52
    s_lshl_b32 s91, s3, 12
    s_mul_i32 s92, s3, 7168
    s_min_u32 s92, s92, 908288
    v_min_u32 v145, 55, v1
    v_lshlrev_b32 v145, 4, v145
    s_waitcnt vmcnt(10)
    v_max_f32_dpp v80, v80, v80 row_ror:1 row_mask:0xf bank_mask:0xf
    s_nop 1
    v_max_f32_dpp v80, v80, v80 row_ror:2 row_mask:0xf bank_mask:0xf
    s_nop 1
    v_max_f32_dpp v80, v80, v80 row_ror:4 row_mask:0xf bank_mask:0xf
    s_nop 1
    v_max_f32_dpp v80, v80, v80 row_ror:8 row_mask:0xf bank_mask:0xf
    v_mov_b32 v82, v80
    s_nop 1
    v_permlane16_swap_b32 v80, v82
    v_max_f32 v80, v80, v82
    v_mov_b32 v82, v80
    s_nop 1
    v_permlane32_swap_b32 v80, v82
    v_max_f32 v80, v80, v82
    v_max_f32_dpp v81, v81, v81 row_ror:1 row_mask:0xf bank_mask:0xf
    s_nop 1
    v_max_f32_dpp v81, v81, v81 row_ror:2 row_mask:0xf bank_mask:0xf
    s_nop 1
    v_max_f32_dpp v81, v81, v81 row_ror:4 row_mask:0xf bank_mask:0xf
    s_nop 1
    v_max_f32_dpp v81, v81, v81 row_ror:8 row_mask:0xf bank_mask:0xf
    v_mov_b32 v82, v81
    s_nop 1
    v_permlane16_swap_b32 v81, v82
    v_max_f32 v81, v81, v82
    v_mov_b32 v82, v81
    s_nop 1
    v_permlane32_swap_b32 v81, v82
    v_max_f32 v81, v81, v82
    v_mul_f32 v80, v80, v81
    v_mov_b32 v81, 0x45c80000
    v_cmp_le_f32 vcc, v80, v81
    v_mov_b32 v12, 0xdddd
    v_lshlrev_b32 v40, 4, v1
    v_and_b32 v41, 15, v1
    v_lshlrev_b32 v41, 4, v41
    v_lshl_add_u32 v41, v3, 8, v41
    v_bfe_u32 v43, v1, 4, 1
    v_cmp_eq_u32 s[66:67], 0, v43
    v_mov_b32 v44, 131072
    v_mov_b32 v45, 65536
    v_mov_b32 v46, 4096
    v_mov_b32 v47, 0
    v_cndmask_b32 v44, v44, v45, s[66:67]
    v_add_u32 v13, v41, v44
    v_cndmask_b32 v15, v47, v46, s[66:67]
    v_mov_b32 v14, v40
    v_mov_b32 v16, 0
    v_mov_b32 v17, 0
    v_mov_b32 v18, 0
    v_mov_b32 v19, 0
    v_mov_b32 v20, 0
    v_mov_b32 v21, 0
    v_mov_b32 v22, 0
    v_mov_b32 v23, 0
    v_mov_b32 v24, 0
    v_mov_b32 v25, 0
    v_mov_b32 v26, 0
    v_mov_b32 v27, 0
    v_mov_b32 v28, 0
    v_mov_b32 v29, 0
    v_mov_b32 v30, 0
    v_mov_b32 v31, 0
    v_mov_b32 v32, 0
    v_mov_b32 v33, 0
    v_mov_b32 v34, 0
    v_mov_b32 v35, 0
    v_mov_b32 v36, 0
    v_mov_b32 v37, 0
    v_mov_b32 v38, 0
    v_mov_b32 v39, 0
    v_mov_b32 v40, 0
    v_mov_b32 v41, 0
    v_mov_b32 v42, 0
    v_mov_b32 v43, 0
    v_mov_b32 v44, 0
    v_mov_b32 v45, 0
    v_mov_b32 v46, 0
    v_mov_b32 v47, 0
    s_cbranch_vccnz FAST_16
    s_add_u32 m0, s65, 16384
    s_add_u32 s3, s64, 4210688
    buffer_load_dwordx4 v14, s[48:51], s3 offen sc1 lds
    s_add_u32 m0, s65, 17408
    s_add_u32 s3, s64, 4211712
    buffer_load_dwordx4 v14, s[48:51], s3 offen sc1 lds
    s_add_u32 m0, s65, 18432
    s_add_u32 s3, s64, 4212736
    buffer_load_dwordx4 v14, s[48:51], s3 offen sc1 lds
    s_add_u32 m0, s65, 19456
    s_add_u32 s3, s64, 4213760
    buffer_load_dwordx4 v14, s[48:51], s3 offen sc1 lds
    s_add_u32 m0, s65, 32768
    s_add_u32 s3, s64, 4227072
    buffer_load_dwordx4 v14, s[48:51], s3 offen sc1 lds
    s_add_u32 m0, s65, 33792
    s_add_u32 s3, s64, 4228096
    buffer_load_dwordx4 v14, s[48:51], s3 offen sc1 lds
    s_add_u32 m0, s65, 34816
    s_add_u32 s3, s64, 4229120
    buffer_load_dwordx4 v14, s[48:51], s3 offen sc1 lds
    s_add_u32 m0, s65, 35840
    s_add_u32 s3, s64, 4230144
    buffer_load_dwordx4 v14, s[48:51], s3 offen sc1 lds
    s_add_u32 m0, s65, 49152
    s_add_u32 s3, s64, 4243456
    buffer_load_dwordx4 v14, s[48:51], s3 offen sc1 lds
    s_add_u32 m0, s65, 50176
    s_add_u32 s3, s64, 4244480
    buffer_load_dwordx4 v14, s[48:51], s3 offen sc1 lds
    s_add_u32 m0, s65, 51200
    s_add_u32 s3, s64, 4245504
    buffer_load_dwordx4 v14, s[48:51], s3 offen sc1 lds
    s_add_u32 m0, s65, 52224
    s_add_u32 s3, s64, 4246528
    buffer_load_dwordx4 v14, s[48:51], s3 offen sc1 lds
    s_waitcnt vmcnt(0)
    s_barrier
    v_mov_b32 v140, 0xff800000
    v_mov_b32 v141, 0xff800000
    v_mov_b32 v142, v14
    s_mov_b32 s66, 64
SLOW_17:
    ds_read_b128 v[112:115], v142
    v_add_u32 v142, 1024, v142
    s_waitcnt lgkmcnt(0)
    v_mfma_f32_32x32x16_bf16 v[80:95], v[112:115], v[4:7], 0
    v_mfma_f32_32x32x16_bf16 v[96:111], v[112:115], v[8:11], 0
    s_nop 10
    v_max3_f32 v140, v80, v81, v140
    v_max3_f32 v140, v82, v83, v140
    v_max3_f32 v140, v84, v85, v140
    v_max3_f32 v140, v86, v87, v140
    v_max3_f32 v140, v88, v89, v140
    v_max3_f32 v140, v90, v91, v140
    v_max3_f32 v140, v92, v93, v140
    v_max3_f32 v140, v94, v95, v140
    v_max3_f32 v141, v96, v97, v141
    v_max3_f32 v141, v98, v99, v141
    v_max3_f32 v141, v100, v101, v141
    v_max3_f32 v141, v102, v103, v141
    v_max3_f32 v141, v104, v105, v141
    v_max3_f32 v141, v106, v107, v141
    v_max3_f32 v141, v108, v109, v141
    v_max3_f32 v141, v110, v111, v141
    s_sub_u32 s66, s66, 1
    s_cmp_lg_u32 s66, 0
    s_cbranch_scc1 SLOW_17
    v_mov_b32 v142, v140
    s_nop 1
    v_permlane32_swap_b32 v140, v142
    v_max_f32 v142, v140, v142
    v_sub_f32 v142, 0, v142
    v_mov_b32 v16, v142
    v_mov_b32 v17, v142
    v_mov_b32 v18, v142
    v_mov_b32 v19, v142
    v_mov_b32 v20, v142
    v_mov_b32 v21, v142
    v_mov_b32 v22, v142
    v_mov_b32 v23, v142
    v_mov_b32 v24, v142
    v_mov_b32 v25, v142
    v_mov_b32 v26, v142
    v_mov_b32 v27, v142
    v_mov_b32 v28, v142
    v_mov_b32 v29, v142
    v_mov_b32 v30, v142
    v_mov_b32 v31, v142
    v_mov_b32 v142, v141
    s_nop 1
    v_permlane32_swap_b32 v141, v142
    v_max_f32 v142, v141, v142
    v_sub_f32 v142, 0, v142
    v_mov_b32 v32, v142
    v_mov_b32 v33, v142
    v_mov_b32 v34, v142
    v_mov_b32 v35, v142
    v_mov_b32 v36, v142
    v_mov_b32 v37, v142
    v_mov_b32 v38, v142
    v_mov_b32 v39, v142
    v_mov_b32 v40, v142
    v_mov_b32 v41, v142
    v_mov_b32 v42, v142
    v_mov_b32 v43, v142
    v_mov_b32 v44, v142
    v_mov_b32 v45, v142
    v_mov_b32 v46, v142
    v_mov_b32 v47, v142
FAST_16:
    v_mov_b32 v48, 0
    v_mov_b32 v49, 0
    v_mov_b32 v50, 0
    v_mov_b32 v51, 0
    v_mov_b32 v52, 0
    v_mov_b32 v53, 0
    v_mov_b32 v54, 0
    v_mov_b32 v55, 0
    v_mov_b32 v56, 0
    v_mov_b32 v57, 0
    v_mov_b32 v58, 0
    v_mov_b32 v59, 0
    v_mov_b32 v60, 0
    v_mov_b32 v61, 0
    v_mov_b32 v62, 0
    v_mov_b32 v63, 0
    v_mov_b32 v64, 0
    v_mov_b32 v65, 0
    v_mov_b32 v66, 0
    v_mov_b32 v67, 0
    v_mov_b32 v68, 0
    v_mov_b32 v69, 0
    v_mov_b32 v70, 0
    v_mov_b32 v71, 0
    v_mov_b32 v72, 0
    v_mov_b32 v73, 0
    v_mov_b32 v74, 0
    v_mov_b32 v75, 0
    v_mov_b32 v76, 0
    v_mov_b32 v77, 0
    v_mov_b32 v78, 0
    v_mov_b32 v79, 0
    v_mov_b32 v104, 0
    v_mov_b32 v105, 0
    v_mov_b32 v106, 0
    v_mov_b32 v107, 0
    v_mov_b32 v108, 0
    v_mov_b32 v109, 0
    v_mov_b32 v110, 0
    v_mov_b32 v111, 0
    v_mov_b32 v128, 0
    v_mov_b32 v129, 0
    v_mov_b32 v130, 0
    v_mov_b32 v131, 0
    v_mov_b32 v132, 0
    v_mov_b32 v133, 0
    v_mov_b32 v134, 0
    v_mov_b32 v135, 0
    s_waitcnt vmcnt(2)
    s_barrier
    ds_read_b128 v[112:115], v14
    ds_read_b128 v[120:123], v13
    ds_read_b128 v[124:127], v13 offset:512
    s_waitcnt lgkmcnt(0)
    v_mfma_f32_32x32x16_bf16 v[80:95], v[112:115], v[4:7], v[16:31]
    s_mov_b32 s66, 3
AT_18:
    ds_read_b128 v[116:119], v14 offset:1024
    s_nop 9
    v_exp_f32 v80, v80
    v_exp_f32 v81, v81
    v_smfmac_f32_32x32x32_bf16 v[64:79], v[132:135], v[104:111], v12
    ds_read_b128 v[128:131], v13 offset:1024
    ds_read_b128 v[132:135], v13 offset:1536
    v_exp_f32 v82, v82
    v_exp_f32 v83, v83
    v_exp_f32 v84, v84
    v_mfma_f32_32x32x16_bf16 v[96:111], v[112:115], v[8:11], v[32:47]
    v_exp_f32 v85, v85
    v_exp_f32 v86, v86
    v_exp_f32 v87, v87
    v_exp_f32 v88, v88
    v_exp_f32 v89, v89
    s_waitcnt lgkmcnt(3)
    v_smfmac_f32_32x32x32_bf16 v[48:63], v[120:123], v[80:87], v12
    v_exp_f32 v90, v90
    v_exp_f32 v91, v91
    v_exp_f32 v92, v92
    v_exp_f32 v93, v93
    v_exp_f32 v94, v94
    v_exp_f32 v95, v95
    s_mov_b32 m0, s68
    s_nop 0
    buffer_load_dwordx4 v144, s[48:51], s69 offen sc1 lds
    v_exp_f32 v96, v96
    v_exp_f32 v97, v97
    v_smfmac_f32_32x32x32_bf16 v[48:63], v[124:127], v[88:95], v12
    v_exp_f32 v98, v98
    v_exp_f32 v99, v99
    v_exp_f32 v100, v100
    s_waitcnt lgkmcnt(2)
    v_mfma_f32_32x32x16_bf16 v[80:95], v[116:119], v[4:7], v[16:31]
    v_exp_f32 v101, v101
    v_exp_f32 v102, v102
    v_exp_f32 v103, v103
    v_exp_f32 v104, v104
    v_exp_f32 v105, v105
    v_smfmac_f32_32x32x32_bf16 v[64:79], v[120:123], v[96:103], v12
    v_exp_f32 v106, v106
    v_exp_f32 v107, v107
    v_exp_f32 v108, v108
    v_exp_f32 v109, v109
    v_exp_f32 v110, v110
    v_exp_f32 v111, v111
    ds_read_b128 v[112:115], v14 offset:2048
    v_exp_f32 v80, v80
    v_exp_f32 v81, v81
    v_smfmac_f32_32x32x32_bf16 v[64:79], v[124:127], v[104:111], v12
    ds_read_b128 v[120:123], v13 offset:2048
    ds_read_b128 v[124:127], v13 offset:2560
    v_exp_f32 v82, v82
    v_exp_f32 v83, v83
    v_exp_f32 v84, v84
    v_mfma_f32_32x32x16_bf16 v[96:111], v[116:119], v[8:11], v[32:47]
    v_exp_f32 v85, v85
    v_exp_f32 v86, v86
    v_exp_f32 v87, v87
    v_exp_f32 v88, v88
    v_exp_f32 v89, v89
    s_waitcnt lgkmcnt(3)
    v_smfmac_f32_32x32x32_bf16 v[48:63], v[128:131], v[80:87], v12
    v_exp_f32 v90, v90
    v_exp_f32 v91, v91
    v_exp_f32 v92, v92
    v_exp_f32 v93, v93
    v_exp_f32 v94, v94
    v_exp_f32 v95, v95
    s_add_u32 m0, s68, 65536
    s_add_u32 s3, s69, 2097152
    buffer_load_dwordx4 v144, s[48:51], s3 offen sc1 lds
    s_add_u32 s68, s68, 1024
    s_add_u32 s69, s69, 1024
    v_exp_f32 v96, v96
    v_exp_f32 v97, v97
    v_smfmac_f32_32x32x32_bf16 v[48:63], v[132:135], v[88:95], v12
    v_exp_f32 v98, v98
    v_exp_f32 v99, v99
    v_exp_f32 v100, v100
    s_waitcnt lgkmcnt(2)
    v_mfma_f32_32x32x16_bf16 v[80:95], v[112:115], v[4:7], v[16:31]
    v_exp_f32 v101, v101
    v_exp_f32 v102, v102
    v_exp_f32 v103, v103
    v_exp_f32 v104, v104
    v_exp_f32 v105, v105
    v_smfmac_f32_32x32x32_bf16 v[64:79], v[128:131], v[96:103], v12
    v_exp_f32 v106, v106
    v_exp_f32 v107, v107
    v_exp_f32 v108, v108
    v_exp_f32 v109, v109
    v_exp_f32 v110, v110
    v_exp_f32 v111, v111
    ds_read_b128 v[116:119], v14 offset:3072
    v_exp_f32 v80, v80
    v_exp_f32 v81, v81
    v_smfmac_f32_32x32x32_bf16 v[64:79], v[132:135], v[104:111], v12
    ds_read_b128 v[128:131], v13 offset:3072
    ds_read_b128 v[132:135], v13 offset:3584
    v_exp_f32 v82, v82
    v_exp_f32 v83, v83
    v_exp_f32 v84, v84
    v_mfma_f32_32x32x16_bf16 v[96:111], v[112:115], v[8:11], v[32:47]
    v_exp_f32 v85, v85
    v_exp_f32 v86, v86
    v_exp_f32 v87, v87
    v_exp_f32 v88, v88
    v_exp_f32 v89, v89
    s_waitcnt lgkmcnt(3)
    v_smfmac_f32_32x32x32_bf16 v[48:63], v[120:123], v[80:87], v12
    v_exp_f32 v90, v90
    v_exp_f32 v91, v91
    v_exp_f32 v92, v92
    v_exp_f32 v93, v93
    v_exp_f32 v94, v94
    v_exp_f32 v95, v95
    v_exp_f32 v96, v96
    v_exp_f32 v97, v97
    v_smfmac_f32_32x32x32_bf16 v[48:63], v[124:127], v[88:95], v12
    v_exp_f32 v98, v98
    v_exp_f32 v99, v99
    v_exp_f32 v100, v100
    s_waitcnt lgkmcnt(2)
    v_mfma_f32_32x32x16_bf16 v[80:95], v[116:119], v[4:7], v[16:31]
    v_exp_f32 v101, v101
    v_exp_f32 v102, v102
    v_exp_f32 v103, v103
    v_exp_f32 v104, v104
    v_exp_f32 v105, v105
    v_smfmac_f32_32x32x32_bf16 v[64:79], v[120:123], v[96:103], v12
    v_exp_f32 v106, v106
    v_exp_f32 v107, v107
    v_exp_f32 v108, v108
    v_exp_f32 v109, v109
    v_exp_f32 v110, v110
    v_exp_f32 v111, v111
    ds_read_b128 v[112:115], v14 offset:4096
    v_exp_f32 v80, v80
    v_exp_f32 v81, v81
    v_smfmac_f32_32x32x32_bf16 v[64:79], v[124:127], v[104:111], v12
    ds_read_b128 v[120:123], v13 offset:4096
    ds_read_b128 v[124:127], v13 offset:4608
    v_exp_f32 v82, v82
    v_exp_f32 v83, v83
    v_exp_f32 v84, v84
    v_mfma_f32_32x32x16_bf16 v[96:111], v[116:119], v[8:11], v[32:47]
    v_exp_f32 v85, v85
    v_exp_f32 v86, v86
    v_exp_f32 v87, v87
    v_exp_f32 v88, v88
    v_exp_f32 v89, v89
    s_waitcnt lgkmcnt(3)
    v_smfmac_f32_32x32x32_bf16 v[48:63], v[128:131], v[80:87], v12
    v_exp_f32 v90, v90
    v_exp_f32 v91, v91
    v_exp_f32 v92, v92
    v_exp_f32 v93, v93
    v_exp_f32 v94, v94
    v_exp_f32 v95, v95
    v_exp_f32 v96, v96
    v_exp_f32 v97, v97
    v_smfmac_f32_32x32x32_bf16 v[48:63], v[132:135], v[88:95], v12
    v_exp_f32 v98, v98
    v_exp_f32 v99, v99
    v_exp_f32 v100, v100
    s_waitcnt lgkmcnt(2)
    v_mfma_f32_32x32x16_bf16 v[80:95], v[112:115], v[4:7], v[16:31]
    v_exp_f32 v101, v101
    v_exp_f32 v102, v102
    v_exp_f32 v103, v103
    v_exp_f32 v104, v104
    v_exp_f32 v105, v105
    v_smfmac_f32_32x32x32_bf16 v[64:79], v[128:131], v[96:103], v12
    v_exp_f32 v106, v106
    v_exp_f32 v107, v107
    v_exp_f32 v108, v108
    v_exp_f32 v109, v109
    v_exp_f32 v110, v110
    v_exp_f32 v111, v111
    v_add_u32 v14, 4096, v14
    v_add_u32 v13, v13, v15
    s_sub_u32 s66, s66, 1
    s_cmp_lg_u32 s66, 0
    s_cbranch_scc1 AT_18
    s_waitcnt vmcnt(0)
    s_barrier
    s_add_u32 s68, s68, 12288
    s_add_u32 s69, s69, 12288
    s_mov_b32 s66, 4
AT_19:
    ds_read_b128 v[116:119], v14 offset:1024
    v_exp_f32 v80, v80
    v_exp_f32 v81, v81
    v_smfmac_f32_32x32x32_bf16 v[64:79], v[132:135], v[104:111], v12
    ds_read_b128 v[128:131], v13 offset:1024
    ds_read_b128 v[132:135], v13 offset:1536
    v_exp_f32 v82, v82
    v_exp_f32 v83, v83
    v_exp_f32 v84, v84
    v_mfma_f32_32x32x16_bf16 v[96:111], v[112:115], v[8:11], v[32:47]
    v_exp_f32 v85, v85
    v_exp_f32 v86, v86
    v_exp_f32 v87, v87
    v_exp_f32 v88, v88
    v_exp_f32 v89, v89
    s_waitcnt lgkmcnt(3)
    v_smfmac_f32_32x32x32_bf16 v[48:63], v[120:123], v[80:87], v12
    v_exp_f32 v90, v90
    v_exp_f32 v91, v91
    v_exp_f32 v92, v92
    v_exp_f32 v93, v93
    v_exp_f32 v94, v94
    v_exp_f32 v95, v95
    s_mov_b32 m0, s68
    s_nop 0
    buffer_load_dwordx4 v144, s[48:51], s69 offen sc1 lds
    v_exp_f32 v96, v96
    v_exp_f32 v97, v97
    v_smfmac_f32_32x32x32_bf16 v[48:63], v[124:127], v[88:95], v12
    v_exp_f32 v98, v98
    v_exp_f32 v99, v99
    v_exp_f32 v100, v100
    s_waitcnt lgkmcnt(2)
    v_mfma_f32_32x32x16_bf16 v[80:95], v[116:119], v[4:7], v[16:31]
    v_exp_f32 v101, v101
    v_exp_f32 v102, v102
    v_exp_f32 v103, v103
    v_exp_f32 v104, v104
    v_exp_f32 v105, v105
    v_smfmac_f32_32x32x32_bf16 v[64:79], v[120:123], v[96:103], v12
    v_exp_f32 v106, v106
    v_exp_f32 v107, v107
    v_exp_f32 v108, v108
    v_exp_f32 v109, v109
    v_exp_f32 v110, v110
    v_exp_f32 v111, v111
    ds_read_b128 v[112:115], v14 offset:2048
    v_exp_f32 v80, v80
    v_exp_f32 v81, v81
    v_smfmac_f32_32x32x32_bf16 v[64:79], v[124:127], v[104:111], v12
    ds_read_b128 v[120:123], v13 offset:2048
    ds_read_b128 v[124:127], v13 offset:2560
    v_exp_f32 v82, v82
    v_exp_f32 v83, v83
    v_exp_f32 v84, v84
    v_mfma_f32_32x32x16_bf16 v[96:111], v[116:119], v[8:11], v[32:47]
    v_exp_f32 v85, v85
    v_exp_f32 v86, v86
    v_exp_f32 v87, v87
    v_exp_f32 v88, v88
    v_exp_f32 v89, v89
    s_waitcnt lgkmcnt(3)
    v_smfmac_f32_32x32x32_bf16 v[48:63], v[128:131], v[80:87], v12
    v_exp_f32 v90, v90
    v_exp_f32 v91, v91
    v_exp_f32 v92, v92
    v_exp_f32 v93, v93
    v_exp_f32 v94, v94
    v_exp_f32 v95, v95
    s_add_u32 m0, s68, 65536
    s_add_u32 s3, s69, 2097152
    buffer_load_dwordx4 v144, s[48:51], s3 offen sc1 lds
    s_add_u32 s68, s68, 1024
    s_add_u32 s69, s69, 1024
    v_exp_f32 v96, v96
    v_exp_f32 v97, v97
    v_smfmac_f32_32x32x32_bf16 v[48:63], v[132:135], v[88:95], v12
    v_exp_f32 v98, v98
    v_exp_f32 v99, v99
    v_exp_f32 v100, v100
    s_waitcnt lgkmcnt(2)
    v_mfma_f32_32x32x16_bf16 v[80:95], v[112:115], v[4:7], v[16:31]
    v_exp_f32 v101, v101
    v_exp_f32 v102, v102
    v_exp_f32 v103, v103
    v_exp_f32 v104, v104
    v_exp_f32 v105, v105
    v_smfmac_f32_32x32x32_bf16 v[64:79], v[128:131], v[96:103], v12
    v_exp_f32 v106, v106
    v_exp_f32 v107, v107
    v_exp_f32 v108, v108
    v_exp_f32 v109, v109
    v_exp_f32 v110, v110
    v_exp_f32 v111, v111
    ds_read_b128 v[116:119], v14 offset:3072
    v_exp_f32 v80, v80
    v_exp_f32 v81, v81
    v_smfmac_f32_32x32x32_bf16 v[64:79], v[132:135], v[104:111], v12
    ds_read_b128 v[128:131], v13 offset:3072
    ds_read_b128 v[132:135], v13 offset:3584
    v_exp_f32 v82, v82
    v_exp_f32 v83, v83
    v_exp_f32 v84, v84
    v_mfma_f32_32x32x16_bf16 v[96:111], v[112:115], v[8:11], v[32:47]
    v_exp_f32 v85, v85
    v_exp_f32 v86, v86
    v_exp_f32 v87, v87
    v_exp_f32 v88, v88
    v_exp_f32 v89, v89
    s_waitcnt lgkmcnt(3)
    v_smfmac_f32_32x32x32_bf16 v[48:63], v[120:123], v[80:87], v12
    v_exp_f32 v90, v90
    v_exp_f32 v91, v91
    v_exp_f32 v92, v92
    v_exp_f32 v93, v93
    v_exp_f32 v94, v94
    v_exp_f32 v95, v95
    buffer_load_dwordx4 v[136:139], v145, s[20:23], s90 offen
    buffer_load_dwordx4 v[136:139], v145, s[20:23], s90 offen offset:1792
    s_add_u32 s90, s90, 3584
    v_exp_f32 v96, v96
    v_exp_f32 v97, v97
    v_smfmac_f32_32x32x32_bf16 v[48:63], v[124:127], v[88:95], v12
    v_exp_f32 v98, v98
    v_exp_f32 v99, v99
    v_exp_f32 v100, v100
    s_waitcnt lgkmcnt(2)
    v_mfma_f32_32x32x16_bf16 v[80:95], v[116:119], v[4:7], v[16:31]
    v_exp_f32 v101, v101
    v_exp_f32 v102, v102
    v_exp_f32 v103, v103
    v_exp_f32 v104, v104
    v_exp_f32 v105, v105
    v_smfmac_f32_32x32x32_bf16 v[64:79], v[120:123], v[96:103], v12
    v_exp_f32 v106, v106
    v_exp_f32 v107, v107
    v_exp_f32 v108, v108
    v_exp_f32 v109, v109
    v_exp_f32 v110, v110
    v_exp_f32 v111, v111
    ds_read_b128 v[112:115], v14 offset:4096
    v_exp_f32 v80, v80
    v_exp_f32 v81, v81
    v_smfmac_f32_32x32x32_bf16 v[64:79], v[124:127], v[104:111], v12
    ds_read_b128 v[120:123], v13 offset:4096
    ds_read_b128 v[124:127], v13 offset:4608
    v_exp_f32 v82, v82
    v_exp_f32 v83, v83
    v_exp_f32 v84, v84
    v_mfma_f32_32x32x16_bf16 v[96:111], v[116:119], v[8:11], v[32:47]
    v_exp_f32 v85, v85
    v_exp_f32 v86, v86
    v_exp_f32 v87, v87
    v_exp_f32 v88, v88
    v_exp_f32 v89, v89
    s_waitcnt lgkmcnt(3)
    v_smfmac_f32_32x32x32_bf16 v[48:63], v[128:131], v[80:87], v12
    v_exp_f32 v90, v90
    v_exp_f32 v91, v91
    v_exp_f32 v92, v92
    v_exp_f32 v93, v93
    v_exp_f32 v94, v94
    v_exp_f32 v95, v95
    v_exp_f32 v96, v96
    v_exp_f32 v97, v97
    v_smfmac_f32_32x32x32_bf16 v[48:63], v[132:135], v[88:95], v12
    v_exp_f32 v98, v98
    v_exp_f32 v99, v99
    v_exp_f32 v100, v100
    s_waitcnt lgkmcnt(2)
    v_mfma_f32_32x32x16_bf16 v[80:95], v[112:115], v[4:7], v[16:31]
    v_exp_f32 v101, v101
    v_exp_f32 v102, v102
    v_exp_f32 v103, v103
    v_exp_f32 v104, v104
    v_exp_f32 v105, v105
    v_smfmac_f32_32x32x32_bf16 v[64:79], v[128:131], v[96:103], v12
    v_exp_f32 v106, v106
    v_exp_f32 v107, v107
    v_exp_f32 v108, v108
    v_exp_f32 v109, v109
    v_exp_f32 v110, v110
    v_exp_f32 v111, v111
    v_add_u32 v14, 4096, v14
    v_add_u32 v13, v13, v15
    s_sub_u32 s66, s66, 1
    s_cmp_lg_u32 s66, 0
    s_cbranch_scc1 AT_19
    s_waitcnt vmcnt(2)
    s_barrier
    s_add_u32 s68, s68, 12288
    s_add_u32 s69, s69, 12288
    s_mov_b32 s66, 4
AT_20:
    ds_read_b128 v[116:119], v14 offset:1024
    v_exp_f32 v80, v80
    v_exp_f32 v81, v81
    v_smfmac_f32_32x32x32_bf16 v[64:79], v[132:135], v[104:111], v12
    ds_read_b128 v[128:131], v13 offset:1024
    ds_read_b128 v[132:135], v13 offset:1536
    v_exp_f32 v82, v82
    v_exp_f32 v83, v83
    v_exp_f32 v84, v84
    v_mfma_f32_32x32x16_bf16 v[96:111], v[112:115], v[8:11], v[32:47]
    v_exp_f32 v85, v85
    v_exp_f32 v86, v86
    v_exp_f32 v87, v87
    v_exp_f32 v88, v88
    v_exp_f32 v89, v89
    s_waitcnt lgkmcnt(3)
    v_smfmac_f32_32x32x32_bf16 v[48:63], v[120:123], v[80:87], v12
    v_exp_f32 v90, v90
    v_exp_f32 v91, v91
    v_exp_f32 v92, v92
    v_exp_f32 v93, v93
    v_exp_f32 v94, v94
    v_exp_f32 v95, v95
    s_mov_b32 m0, s68
    s_nop 0
    buffer_load_dwordx4 v144, s[48:51], s69 offen sc1 lds
    v_exp_f32 v96, v96
    v_exp_f32 v97, v97
    v_smfmac_f32_32x32x32_bf16 v[48:63], v[124:127], v[88:95], v12
    v_exp_f32 v98, v98
    v_exp_f32 v99, v99
    v_exp_f32 v100, v100
    s_waitcnt lgkmcnt(2)
    v_mfma_f32_32x32x16_bf16 v[80:95], v[116:119], v[4:7], v[16:31]
    v_exp_f32 v101, v101
    v_exp_f32 v102, v102
    v_exp_f32 v103, v103
    v_exp_f32 v104, v104
    v_exp_f32 v105, v105
    v_smfmac_f32_32x32x32_bf16 v[64:79], v[120:123], v[96:103], v12
    v_exp_f32 v106, v106
    v_exp_f32 v107, v107
    v_exp_f32 v108, v108
    v_exp_f32 v109, v109
    v_exp_f32 v110, v110
    v_exp_f32 v111, v111
    ds_read_b128 v[112:115], v14 offset:2048
    v_exp_f32 v80, v80
    v_exp_f32 v81, v81
    v_smfmac_f32_32x32x32_bf16 v[64:79], v[124:127], v[104:111], v12
    ds_read_b128 v[120:123], v13 offset:2048
    ds_read_b128 v[124:127], v13 offset:2560
    v_exp_f32 v82, v82
    v_exp_f32 v83, v83
    v_exp_f32 v84, v84
    v_mfma_f32_32x32x16_bf16 v[96:111], v[116:119], v[8:11], v[32:47]
    v_exp_f32 v85, v85
    v_exp_f32 v86, v86
    v_exp_f32 v87, v87
    v_exp_f32 v88, v88
    v_exp_f32 v89, v89
    s_waitcnt lgkmcnt(3)
    v_smfmac_f32_32x32x32_bf16 v[48:63], v[128:131], v[80:87], v12
    v_exp_f32 v90, v90
    v_exp_f32 v91, v91
    v_exp_f32 v92, v92
    v_exp_f32 v93, v93
    v_exp_f32 v94, v94
    v_exp_f32 v95, v95
    s_add_u32 m0, s68, 65536
    s_add_u32 s3, s69, 2097152
    buffer_load_dwordx4 v144, s[48:51], s3 offen sc1 lds
    s_add_u32 s68, s68, 1024
    s_add_u32 s69, s69, 1024
    v_exp_f32 v96, v96
    v_exp_f32 v97, v97
    v_smfmac_f32_32x32x32_bf16 v[48:63], v[132:135], v[88:95], v12
    v_exp_f32 v98, v98
    v_exp_f32 v99, v99
    v_exp_f32 v100, v100
    s_waitcnt lgkmcnt(2)
    v_mfma_f32_32x32x16_bf16 v[80:95], v[112:115], v[4:7], v[16:31]
    v_exp_f32 v101, v101
    v_exp_f32 v102, v102
    v_exp_f32 v103, v103
    v_exp_f32 v104, v104
    v_exp_f32 v105, v105
    v_smfmac_f32_32x32x32_bf16 v[64:79], v[128:131], v[96:103], v12
    v_exp_f32 v106, v106
    v_exp_f32 v107, v107
    v_exp_f32 v108, v108
    v_exp_f32 v109, v109
    v_exp_f32 v110, v110
    v_exp_f32 v111, v111
    ds_read_b128 v[116:119], v14 offset:3072
    v_exp_f32 v80, v80
    v_exp_f32 v81, v81
    v_smfmac_f32_32x32x32_bf16 v[64:79], v[132:135], v[104:111], v12
    ds_read_b128 v[128:131], v13 offset:3072
    ds_read_b128 v[132:135], v13 offset:3584
    v_exp_f32 v82, v82
    v_exp_f32 v83, v83
    v_exp_f32 v84, v84
    v_mfma_f32_32x32x16_bf16 v[96:111], v[112:115], v[8:11], v[32:47]
    v_exp_f32 v85, v85
    v_exp_f32 v86, v86
    v_exp_f32 v87, v87
    v_exp_f32 v88, v88
    v_exp_f32 v89, v89
    s_waitcnt lgkmcnt(3)
    v_smfmac_f32_32x32x32_bf16 v[48:63], v[120:123], v[80:87], v12
    v_exp_f32 v90, v90
    v_exp_f32 v91, v91
    v_exp_f32 v92, v92
    v_exp_f32 v93, v93
    v_exp_f32 v94, v94
    v_exp_f32 v95, v95
    buffer_load_dwordx4 v[136:139], v144, s[16:19], s91 offen
    s_add_u32 s91, s91, 1024
    v_exp_f32 v96, v96
    v_exp_f32 v97, v97
    v_smfmac_f32_32x32x32_bf16 v[48:63], v[124:127], v[88:95], v12
    v_exp_f32 v98, v98
    v_exp_f32 v99, v99
    v_exp_f32 v100, v100
    s_waitcnt lgkmcnt(2)
    v_mfma_f32_32x32x16_bf16 v[80:95], v[116:119], v[4:7], v[16:31]
    v_exp_f32 v101, v101
    v_exp_f32 v102, v102
    v_exp_f32 v103, v103
    v_exp_f32 v104, v104
    v_exp_f32 v105, v105
    v_smfmac_f32_32x32x32_bf16 v[64:79], v[120:123], v[96:103], v12
    v_exp_f32 v106, v106
    v_exp_f32 v107, v107
    v_exp_f32 v108, v108
    v_exp_f32 v109, v109
    v_exp_f32 v110, v110
    v_exp_f32 v111, v111
    ds_read_b128 v[112:115], v14 offset:4096
    v_exp_f32 v80, v80
    v_exp_f32 v81, v81
    v_smfmac_f32_32x32x32_bf16 v[64:79], v[124:127], v[104:111], v12
    ds_read_b128 v[120:123], v13 offset:4096
    ds_read_b128 v[124:127], v13 offset:4608
    v_exp_f32 v82, v82
    v_exp_f32 v83, v83
    v_exp_f32 v84, v84
    v_mfma_f32_32x32x16_bf16 v[96:111], v[116:119], v[8:11], v[32:47]
    v_exp_f32 v85, v85
    v_exp_f32 v86, v86
    v_exp_f32 v87, v87
    v_exp_f32 v88, v88
    v_exp_f32 v89, v89
    s_waitcnt lgkmcnt(3)
    v_smfmac_f32_32x32x32_bf16 v[48:63], v[128:131], v[80:87], v12
    v_exp_f32 v90, v90
    v_exp_f32 v91, v91
    v_exp_f32 v92, v92
    v_exp_f32 v93, v93
    v_exp_f32 v94, v94
    v_exp_f32 v95, v95
    buffer_load_dwordx4 v[136:139], v144, s[32:35], s92 offen
    s_add_u32 s92, s92, 1024
    v_exp_f32 v96, v96
    v_exp_f32 v97, v97
    v_smfmac_f32_32x32x32_bf16 v[48:63], v[132:135], v[88:95], v12
    v_exp_f32 v98, v98
    v_exp_f32 v99, v99
    v_exp_f32 v100, v100
    s_waitcnt lgkmcnt(2)
    v_mfma_f32_32x32x16_bf16 v[80:95], v[112:115], v[4:7], v[16:31]
    v_exp_f32 v101, v101
    v_exp_f32 v102, v102
    v_exp_f32 v103, v103
    v_exp_f32 v104, v104
    v_exp_f32 v105, v105
    v_smfmac_f32_32x32x32_bf16 v[64:79], v[128:131], v[96:103], v12
    v_exp_f32 v106, v106
    v_exp_f32 v107, v107
    v_exp_f32 v108, v108
    v_exp_f32 v109, v109
    v_exp_f32 v110, v110
    v_exp_f32 v111, v111
    v_add_u32 v14, 4096, v14
    v_add_u32 v13, v13, v15
    s_sub_u32 s66, s66, 1
    s_cmp_lg_u32 s66, 0
    s_cbranch_scc1 AT_20
    s_waitcnt vmcnt(2)
    s_barrier
    v_lshlrev_b32 v200, 7, v1
    s_mov_b32 s93, 65536
    s_cmp_lg_u32 s6, 1
    s_cbranch_scc1 HF_21
    buffer_load_dword v201, v200, s[48:51], s93 offen sc0 sc1
HF_21:
    s_mov_b32 s66, 5
AT_22:
    ds_read_b128 v[116:119], v14 offset:1024
    v_exp_f32 v80, v80
    v_exp_f32 v81, v81
    v_smfmac_f32_32x32x32_bf16 v[64:79], v[132:135], v[104:111], v12
    ds_read_b128 v[128:131], v13 offset:1024
    ds_read_b128 v[132:135], v13 offset:1536
    v_exp_f32 v82, v82
    v_exp_f32 v83, v83
    v_exp_f32 v84, v84
    v_mfma_f32_32x32x16_bf16 v[96:111], v[112:115], v[8:11], v[32:47]
    v_exp_f32 v85, v85
    v_exp_f32 v86, v86
    v_exp_f32 v87, v87
    v_exp_f32 v88, v88
    v_exp_f32 v89, v89
    s_waitcnt lgkmcnt(3)
    v_smfmac_f32_32x32x32_bf16 v[48:63], v[120:123], v[80:87], v12
    v_exp_f32 v90, v90
    v_exp_f32 v91, v91
    v_exp_f32 v92, v92
    v_exp_f32 v93, v93
    v_exp_f32 v94, v94
    v_exp_f32 v95, v95
    v_exp_f32 v96, v96
    v_exp_f32 v97, v97
    v_smfmac_f32_32x32x32_bf16 v[48:63], v[124:127], v[88:95], v12
    v_exp_f32 v98, v98
    v_exp_f32 v99, v99
    v_exp_f32 v100, v100
    s_waitcnt lgkmcnt(2)
    v_mfma_f32_32x32x16_bf16 v[80:95], v[116:119], v[4:7], v[16:31]
    v_exp_f32 v101, v101
    v_exp_f32 v102, v102
    v_exp_f32 v103, v103
    v_exp_f32 v104, v104
    v_exp_f32 v105, v105
    v_smfmac_f32_32x32x32_bf16 v[64:79], v[120:123], v[96:103], v12
    v_exp_f32 v106, v106
    v_exp_f32 v107, v107
    v_exp_f32 v108, v108
    v_exp_f32 v109, v109
    v_exp_f32 v110, v110
    v_exp_f32 v111, v111
    ds_read_b128 v[112:115], v14 offset:2048
    v_exp_f32 v80, v80
    v_exp_f32 v81, v81
    v_smfmac_f32_32x32x32_bf16 v[64:79], v[124:127], v[104:111], v12
    ds_read_b128 v[120:123], v13 offset:2048
    ds_read_b128 v[124:127], v13 offset:2560
    v_exp_f32 v82, v82
    v_exp_f32 v83, v83
    v_exp_f32 v84, v84
    v_mfma_f32_32x32x16_bf16 v[96:111], v[116:119], v[8:11], v[32:47]
    v_exp_f32 v85, v85
    v_exp_f32 v86, v86
    v_exp_f32 v87, v87
    v_exp_f32 v88, v88
    v_exp_f32 v89, v89
    s_waitcnt lgkmcnt(3)
    v_smfmac_f32_32x32x32_bf16 v[48:63], v[128:131], v[80:87], v12
    v_exp_f32 v90, v90
    v_exp_f32 v91, v91
    v_exp_f32 v92, v92
    v_exp_f32 v93, v93
    v_exp_f32 v94, v94
    v_exp_f32 v95, v95
    v_exp_f32 v96, v96
    v_exp_f32 v97, v97
    v_smfmac_f32_32x32x32_bf16 v[48:63], v[132:135], v[88:95], v12
    v_exp_f32 v98, v98
    v_exp_f32 v99, v99
    v_exp_f32 v100, v100
    s_waitcnt lgkmcnt(2)
    v_mfma_f32_32x32x16_bf16 v[80:95], v[112:115], v[4:7], v[16:31]
    v_exp_f32 v101, v101
    v_exp_f32 v102, v102
    v_exp_f32 v103, v103
    v_exp_f32 v104, v104
    v_exp_f32 v105, v105
    v_smfmac_f32_32x32x32_bf16 v[64:79], v[128:131], v[96:103], v12
    v_exp_f32 v106, v106
    v_exp_f32 v107, v107
    v_exp_f32 v108, v108
    v_exp_f32 v109, v109
    v_exp_f32 v110, v110
    v_exp_f32 v111, v111
    ds_read_b128 v[116:119], v14 offset:3072
    v_exp_f32 v80, v80
    v_exp_f32 v81, v81
    v_smfmac_f32_32x32x32_bf16 v[64:79], v[132:135], v[104:111], v12
    ds_read_b128 v[128:131], v13 offset:3072
    ds_read_b128 v[132:135], v13 offset:3584
    v_exp_f32 v82, v82
    v_exp_f32 v83, v83
    v_exp_f32 v84, v84
    v_mfma_f32_32x32x16_bf16 v[96:111], v[112:115], v[8:11], v[32:47]
    v_exp_f32 v85, v85
    v_exp_f32 v86, v86
    v_exp_f32 v87, v87
    v_exp_f32 v88, v88
    v_exp_f32 v89, v89
    s_waitcnt lgkmcnt(3)
    v_smfmac_f32_32x32x32_bf16 v[48:63], v[120:123], v[80:87], v12
    v_exp_f32 v90, v90
    v_exp_f32 v91, v91
    v_exp_f32 v92, v92
    v_exp_f32 v93, v93
    v_exp_f32 v94, v94
    v_exp_f32 v95, v95
    buffer_load_dwordx4 v[136:139], v144, s[32:35], s92 offen
    s_add_u32 s92, s92, 1024
    v_exp_f32 v96, v96
    v_exp_f32 v97, v97
    v_smfmac_f32_32x32x32_bf16 v[48:63], v[124:127], v[88:95], v12
    v_exp_f32 v98, v98
    v_exp_f32 v99, v99
    v_exp_f32 v100, v100
    s_waitcnt lgkmcnt(2)
    v_mfma_f32_32x32x16_bf16 v[80:95], v[116:119], v[4:7], v[16:31]
    v_exp_f32 v101, v101
    v_exp_f32 v102, v102
    v_exp_f32 v103, v103
    v_exp_f32 v104, v104
    v_exp_f32 v105, v105
    v_smfmac_f32_32x32x32_bf16 v[64:79], v[120:123], v[96:103], v12
    v_exp_f32 v106, v106
    v_exp_f32 v107, v107
    v_exp_f32 v108, v108
    v_exp_f32 v109, v109
    v_exp_f32 v110, v110
    v_exp_f32 v111, v111
    ds_read_b128 v[112:115], v14 offset:4096
    v_exp_f32 v80, v80
    v_exp_f32 v81, v81
    v_smfmac_f32_32x32x32_bf16 v[64:79], v[124:127], v[104:111], v12
    ds_read_b128 v[120:123], v13 offset:4096
    ds_read_b128 v[124:127], v13 offset:4608
    v_exp_f32 v82, v82
    v_exp_f32 v83, v83
    v_exp_f32 v84, v84
    v_mfma_f32_32x32x16_bf16 v[96:111], v[116:119], v[8:11], v[32:47]
    v_exp_f32 v85, v85
    v_exp_f32 v86, v86
    v_exp_f32 v87, v87
    v_exp_f32 v88, v88
    v_exp_f32 v89, v89
    s_waitcnt lgkmcnt(3)
    v_smfmac_f32_32x32x32_bf16 v[48:63], v[128:131], v[80:87], v12
    v_exp_f32 v90, v90
    v_exp_f32 v91, v91
    v_exp_f32 v92, v92
    v_exp_f32 v93, v93
    v_exp_f32 v94, v94
    v_exp_f32 v95, v95
    v_exp_f32 v96, v96
    v_exp_f32 v97, v97
    v_smfmac_f32_32x32x32_bf16 v[48:63], v[132:135], v[88:95], v12
    v_exp_f32 v98, v98
    v_exp_f32 v99, v99
    v_exp_f32 v100, v100
    s_waitcnt lgkmcnt(2)
    v_mfma_f32_32x32x16_bf16 v[80:95], v[112:115], v[4:7], v[16:31]
    v_exp_f32 v101, v101
    v_exp_f32 v102, v102
    v_exp_f32 v103, v103
    v_exp_f32 v104, v104
    v_exp_f32 v105, v105
    v_smfmac_f32_32x32x32_bf16 v[64:79], v[128:131], v[96:103], v12
    v_exp_f32 v106, v106
    v_exp_f32 v107, v107
    v_exp_f32 v108, v108
    v_exp_f32 v109, v109
    v_exp_f32 v110, v110
    v_exp_f32 v111, v111
    v_add_u32 v14, 4096, v14
    v_add_u32 v13, v13, v15
    s_sub_u32 s66, s66, 1
    s_cmp_lg_u32 s66, 0
    s_cbranch_scc1 AT_22
    s_nop 1
    v_smfmac_f32_32x32x32_bf16 v[64:79], v[132:135], v[104:111], v12
    s_waitcnt lgkmcnt(0)
    s_lshl_b32 s3, s61, 3
    s_lshl_b32 s64, s6, 1
    s_add_u32 s3, s3, s64
    s_lshl_b32 s3, s3, 5
    s_add_u32 s3, s3, s60
    s_lshl_b32 s3, s3, 10
    s_add_u32 s64, s3, 8388608
    v_lshlrev_b32 v14, 4, v1
    s_nop 15
    v_rcp_f32 v80, v56
    s_nop 0
    v_mul_f32 v48, v48, v80
    v_mul_f32 v49, v49, v80
    v_mul_f32 v50, v50, v80
    v_mul_f32 v51, v51, v80
    v_mul_f32 v52, v52, v80
    v_mul_f32 v53, v53, v80
    v_mul_f32 v54, v54, v80
    v_mul_f32 v55, v55, v80
    v_cvt_pk_bf16_f32 v84, v48, v49
    v_cvt_pk_bf16_f32 v85, v50, v51
    v_cvt_pk_bf16_f32 v86, v52, v53
    v_cvt_pk_bf16_f32 v87, v54, v55
    s_nop 0
    v_permlane32_swap_b32 v84, v86
    v_permlane32_swap_b32 v85, v87
    s_add_u32 s3, s64, 0
    buffer_store_dwordx4 v[84:87], v14, s[48:51], s3 offen sc1
    v_rcp_f32 v80, v72
    s_nop 0
    v_mul_f32 v64, v64, v80
    v_mul_f32 v65, v65, v80
    v_mul_f32 v66, v66, v80
    v_mul_f32 v67, v67, v80
    v_mul_f32 v68, v68, v80
    v_mul_f32 v69, v69, v80
    v_mul_f32 v70, v70, v80
    v_mul_f32 v71, v71, v80
    v_cvt_pk_bf16_f32 v88, v64, v65
    v_cvt_pk_bf16_f32 v89, v66, v67
    v_cvt_pk_bf16_f32 v90, v68, v69
    v_cvt_pk_bf16_f32 v91, v70, v71
    s_nop 0
    v_permlane32_swap_b32 v88, v90
    v_permlane32_swap_b32 v89, v91
    s_add_u32 s3, s64, 32768
    buffer_store_dwordx4 v[88:91], v14, s[48:51], s3 offen sc1
    s_cmp_lg_u32 s6, 1
    s_cbranch_scc1 HK_24
    s_mov_b32 s52, 262144
    s_waitcnt vmcnt(0)
HK_23:
    v_cmp_ne_u32 vcc, s7, v201
    s_cbranch_vccz HK_24
    buffer_load_dword v201, v200, s[48:51], s93 offen sc0 sc1
    s_waitcnt vmcnt(0)
    s_sub_u32 s52, s52, 1
    s_cmp_lg_u32 s52, 0
    s_cbranch_scc1 HK_23
HK_24:
    s_waitcnt vmcnt(0)
    s_barrier
    s_cmp_lg_u32 s6, 0
    s_cbranch_scc1 SG_25
    v_lshlrev_b32 v5, 3, v1
    v_add_u32 v5, s61, v5
    s_lshl_b32 s3, s60, 2
    v_lshl_add_u32 v5, v5, 7, s3
    s_mov_b32 s3, 131072
    v_mov_b32 v4, s7
    s_mov_b32 exec_lo, 0xffffffff
    s_mov_b32 exec_hi, 0x0
    buffer_store_dword v4, v5, s[48:51], s3 offen sc0 sc1
    s_mov_b64 exec, -1
SG_25:
    s_lshl_b32 s70, s4, 2
    s_lshr_b32 s3, s5, 3
    s_add_u32 s70, s70, s3
    s_and_b32 s71, s5, 7
    s_and_b32 s72, s6, 1
    s_lshr_b32 s73, s6, 1
    s_lshl_b32 s74, s70, 1
    s_add_u32 s74, s74, s72
    s_lshl_b32 s75, s71, 6
    s_lshl_b32 s3, s73, 5
    s_add_u32 s75, s75, s3
    s_lshl_b32 s76, s71, 7
    v_lshrrev_b32 v11, 3, v1
    v_bfe_u32 v12, v1, 2, 1
    v_bfe_u32 v10, v1, 4, 1
    v_xor_b32 v12, v12, v10
    v_lshlrev_b32 v12, 6, v12
    v_and_b32 v10, 3, v1
    v_lshl_add_u32 v10, v10, 4, v12
    v_mul_u32_u24 v11, 1024, v11
    v_add_u32 v10, v10, v11
    s_mul_i32 s68, s6, 131072
    s_add_u32 s68, s68, s76
    s_mul_i32 s69, s6, 16384
    s_add_u32 m0, s69, 0
    s_add_u32 s3, s68, 0
    buffer_load_dwordx4 v10, s[16:19], s3 offen lds
    s_add_u32 m0, s69, 1024
    s_add_u32 s3, s68, 8192
    buffer_load_dwordx4 v10, s[16:19], s3 offen lds
    s_add_u32 m0, s69, 2048
    s_add_u32 s3, s68, 16384
    buffer_load_dwordx4 v10, s[16:19], s3 offen lds
    s_add_u32 m0, s69, 3072
    s_add_u32 s3, s68, 24576
    buffer_load_dwordx4 v10, s[16:19], s3 offen lds
    s_add_u32 m0, s69, 4096
    s_add_u32 s3, s68, 32768
    buffer_load_dwordx4 v10, s[16:19], s3 offen lds
    s_add_u32 m0, s69, 5120
    s_add_u32 s3, s68, 40960
    buffer_load_dwordx4 v10, s[16:19], s3 offen lds
    s_add_u32 m0, s69, 6144
    s_add_u32 s3, s68, 49152
    buffer_load_dwordx4 v10, s[16:19], s3 offen lds
    s_add_u32 m0, s69, 7168
    s_add_u32 s3, s68, 57344
    buffer_load_dwordx4 v10, s[16:19], s3 offen lds
    s_add_u32 m0, s69, 8192
    s_add_u32 s3, s68, 65536
    buffer_load_dwordx4 v10, s[16:19], s3 offen lds
    s_add_u32 m0, s69, 9216
    s_add_u32 s3, s68, 73728
    buffer_load_dwordx4 v10, s[16:19], s3 offen lds
    s_add_u32 m0, s69, 10240
    s_add_u32 s3, s68, 81920
    buffer_load_dwordx4 v10, s[16:19], s3 offen lds
    s_add_u32 m0, s69, 11264
    s_add_u32 s3, s68, 90112
    buffer_load_dwordx4 v10, s[16:19], s3 offen lds
    s_add_u32 m0, s69, 12288
    s_add_u32 s3, s68, 98304
    buffer_load_dwordx4 v10, s[16:19], s3 offen lds
    s_add_u32 m0, s69, 13312
    s_add_u32 s3, s68, 106496
    buffer_load_dwordx4 v10, s[16:19], s3 offen lds
    s_add_u32 m0, s69, 14336
    s_add_u32 s3, s68, 114688
    buffer_load_dwordx4 v10, s[16:19], s3 offen lds
    s_add_u32 m0, s69, 15360
    s_add_u32 s3, s68, 122880
    buffer_load_dwordx4 v10, s[16:19], s3 offen lds
    s_lshl_b32 s76, s74, 15
    s_lshl_b32 s3, s75, 1
    s_add_u32 s76, s76, s3
    v_lshlrev_b32 v13, 10, v2
    v_lshl_add_u32 v13, v3, 3, v13
    v_lshlrev_b32 v14, 4, v3
    s_lshl_b32 s77, s75, 2
    buffer_load_dwordx2 v[128:129], v13, s[8:11], s76 offen offset:0
    buffer_load_dwordx2 v[130:131], v13, s[8:11], s76 offen offset:16
    buffer_load_dwordx2 v[132:133], v13, s[8:11], s76 offen offset:32
    buffer_load_dwordx2 v[134:135], v13, s[8:11], s76 offen offset:48
    s_add_u32 s3, s77, 282624
    buffer_load_dwordx4 v[136:139], v14, s[48:51], s3 offen sc1
    s_add_u32 s3, s77, 282656
    buffer_load_dwordx4 v[140:143], v14, s[48:51], s3 offen sc1
    s_add_u32 s3, s77, 282688
    buffer_load_dwordx4 v[144:147], v14, s[48:51], s3 offen sc1
    s_add_u32 s3, s77, 282720
    buffer_load_dwordx4 v[148:151], v14, s[48:51], s3 offen sc1
    s_add_u32 s3, s77, 286720
    buffer_load_dwordx4 v[152:155], v14, s[48:51], s3 offen sc1
    s_add_u32 s3, s77, 286752
    buffer_load_dwordx4 v[156:159], v14, s[48:51], s3 offen sc1
    s_add_u32 s3, s77, 286784
    buffer_load_dwordx4 v[160:163], v14, s[48:51], s3 offen sc1
    s_add_u32 s3, s77, 286816
    buffer_load_dwordx4 v[164:167], v14, s[48:51], s3 offen sc1
    s_and_b32 s80, s4, 3
    s_lshl_b32 s80, s80, 2
    s_and_b32 s3, s5, 3
    s_add_u32 s80, s80, s3
    s_lshr_b32 s81, s4, 2
    s_mul_i32 s81, s81, 7
    s_lshr_b32 s3, s5, 2
    s_add_u32 s81, s81, s3
    s_min_u32 s81, s81, 13
    s_cmp_ge_u32 s5, 28
    s_cbranch_scc1 P3W_26
    v_lshlrev_b32 v11, 3, v0
    s_mov_b32 s3, 286720
    buffer_load_dwordx2 v[16:17], v11, s[48:51], s3 offen sc1
    s_mov_b32 s3, 284672
    buffer_load_dwordx2 v[18:19], v11, s[48:51], s3 offen sc1
    s_waitcnt vmcnt(0)
    v_add_f32 v16, 1.0, v16
    v_add_f32 v17, 1.0, v17
    v_cvt_pk_bf16_f32 v16, v16, v17
    v_cvt_pk_bf16_f32 v18, v18, v19
    v_lshlrev_b32 v11, 2, v0
    v_add_u32 v11, 131072, v11
    ds_write_b32 v11, v16
    ds_write_b32 v11, v18 offset:1024
P3W_26:
    s_lshl_b32 s76, s73, 15
    v_bfe_u32 v10, v1, 2, 2
    v_lshl_add_u32 v11, v3, 3, v10
    v_lshlrev_b32 v11, 7, v11
    v_bfe_u32 v12, v1, 4, 1
    v_lshl_add_u32 v11, v12, 5, v11
    v_and_b32 v12, 3, v1
    v_lshl_add_u32 v11, v12, 3, v11
    v_add_u32 v11, s76, v11
    v_lshrrev_b32 v10, 1, v10
    v_lshl_add_u32 v8, v10, 6, v11
    v_xor_b32 v10, 1, v10
    v_lshl_add_u32 v9, v10, 6, v11
    s_cmp_lg_u32 s6, 0
    s_cbranch_scc1 WT_28
    s_lshl_b32 s3, s2, 7
    v_lshl_add_u32 v4, v2, 2, s3
    s_mov_b32 s3, 131072
    s_mov_b32 s52, 262144
WL_29:
    buffer_load_dword v5, v4, s[48:51], s3 offen sc0 sc1
    s_waitcnt vmcnt(0)
    v_cmp_ne_u32 vcc, s7, v5
    s_cbranch_vccz WE_27
    s_sub_u32 s52, s52, 1
    s_cmp_lg_u32 s52, 0
    s_cbranch_scc1 WL_29
    s_branch WE_27
WT_28:
WE_27:
    s_waitcnt vmcnt(0) lgkmcnt(0)
    s_barrier
    s_lshl_b32 s76, s74, 5
    s_lshl_b32 s3, s73, 4
    s_add_u32 s76, s76, s3
    s_lshl_b32 s76, s76, 10
    s_add_u32 s76, s76, 8388608
    v_lshlrev_b32 v13, 4, v1
    s_add_u32 s3, s76, 0
    buffer_load_dwordx4 v[64:67], v13, s[48:51], s3 offen offset:0 sc1
    s_add_u32 s3, s76, 0
    buffer_load_dwordx4 v[68:71], v13, s[48:51], s3 offen offset:1024 sc1
    s_add_u32 s3, s76, 0
    buffer_load_dwordx4 v[72:75], v13, s[48:51], s3 offen offset:2048 sc1
    s_add_u32 s3, s76, 0
    buffer_load_dwordx4 v[76:79], v13, s[48:51], s3 offen offset:3072 sc1
    s_add_u32 s3, s76, 4096
    buffer_load_dwordx4 v[80:83], v13, s[48:51], s3 offen offset:0 sc1
    s_add_u32 s3, s76, 4096
    buffer_load_dwordx4 v[84:87], v13, s[48:51], s3 offen offset:1024 sc1
    s_add_u32 s3, s76, 4096
    buffer_load_dwordx4 v[88:91], v13, s[48:51], s3 offen offset:2048 sc1
    s_add_u32 s3, s76, 4096
    buffer_load_dwordx4 v[92:95], v13, s[48:51], s3 offen offset:3072 sc1
    s_add_u32 s3, s76, 8192
    buffer_load_dwordx4 v[96:99], v13, s[48:51], s3 offen offset:0 sc1
    s_add_u32 s3, s76, 8192
    buffer_load_dwordx4 v[100:103], v13, s[48:51], s3 offen offset:1024 sc1
    s_add_u32 s3, s76, 8192
    buffer_load_dwordx4 v[104:107], v13, s[48:51], s3 offen offset:2048 sc1
    s_add_u32 s3, s76, 8192
    buffer_load_dwordx4 v[108:111], v13, s[48:51], s3 offen offset:3072 sc1
    s_add_u32 s3, s76, 12288
    buffer_load_dwordx4 v[112:115], v13, s[48:51], s3 offen offset:0 sc1
    s_add_u32 s3, s76, 12288
    buffer_load_dwordx4 v[116:119], v13, s[48:51], s3 offen offset:1024 sc1
    s_add_u32 s3, s76, 12288
    buffer_load_dwordx4 v[120:123], v13, s[48:51], s3 offen offset:2048 sc1
    s_add_u32 s3, s76, 12288
    buffer_load_dwordx4 v[124:127], v13, s[48:51], s3 offen offset:3072 sc1
    v_lshrrev_b32 v14, 4, v1
    v_bfe_u32 v12, v1, 2, 2
    v_xor_b32 v12, v12, v14
    v_and_b32 v13, 1, v12
    v_lshlrev_b32 v13, 6, v13
    v_lshrrev_b32 v12, 1, v12
    v_xor_b32 v12, 1, v12
    v_mul_u32_u24 v12, 1792, v12
    v_mul_u32_u24 v14, 3584, v14
    v_add3_u32 v14, v14, v12, v13
    v_and_b32 v12, 3, v1
    v_lshl_add_u32 v14, v12, 4, v14
    s_mul_i32 s68, s6, 229376
    s_lshl_b32 s3, s81, 7
    s_add_u32 s68, s68, s3
    s_add_u32 s68, s68, 917504
    s_lshl_b32 s69, s6, 14
    s_add_u32 s69, s69, 65536
    ds_read_b64_tr_b16 v[168:169], v8 offset:0
    ds_read_b64_tr_b16 v[170:171], v8 offset:512
    ds_read_b64_tr_b16 v[172:173], v9 offset:0
    ds_read_b64_tr_b16 v[174:175], v9 offset:512
    ds_read_b64_tr_b16 v[176:177], v8 offset:2048
    ds_read_b64_tr_b16 v[178:179], v8 offset:2560
    ds_read_b64_tr_b16 v[180:181], v9 offset:2048
    ds_read_b64_tr_b16 v[182:183], v9 offset:2560
    ds_read_b64_tr_b16 v[184:185], v8 offset:4096
    ds_read_b64_tr_b16 v[186:187], v8 offset:4608
    ds_read_b64_tr_b16 v[188:189], v9 offset:4096
    ds_read_b64_tr_b16 v[190:191], v9 offset:4608
    ds_read_b64_tr_b16 v[192:193], v8 offset:6144
    ds_read_b64_tr_b16 v[194:195], v8 offset:6656
    ds_read_b64_tr_b16 v[196:197], v9 offset:6144
    ds_read_b64_tr_b16 v[198:199], v9 offset:6656
    s_waitcnt vmcnt(15)
    s_waitcnt lgkmcnt(12)
    v_mfma_f32_32x32x16_bf16 v[16:31], v[168:171], v[64:67], 0
    v_mfma_f32_32x32x16_bf16 v[32:47], v[172:175], v[64:67], 0
    s_add_u32 m0, s69, 0
    s_add_u32 s3, s68, 0
    buffer_load_dwordx4 v14, s[20:23], s3 offen lds
    ds_read_b64_tr_b16 v[168:169], v8 offset:8192
    ds_read_b64_tr_b16 v[170:171], v8 offset:8704
    ds_read_b64_tr_b16 v[172:173], v9 offset:8192
    ds_read_b64_tr_b16 v[174:175], v9 offset:8704
    s_waitcnt vmcnt(15)
    s_waitcnt lgkmcnt(12)
    v_mfma_f32_32x32x16_bf16 v[16:31], v[176:179], v[68:71], v[16:31]
    v_mfma_f32_32x32x16_bf16 v[32:47], v[180:183], v[68:71], v[32:47]
    s_add_u32 m0, s69, 1024
    s_add_u32 s3, s68, 14336
    buffer_load_dwordx4 v14, s[20:23], s3 offen lds
    ds_read_b64_tr_b16 v[176:177], v8 offset:10240
    ds_read_b64_tr_b16 v[178:179], v8 offset:10752
    ds_read_b64_tr_b16 v[180:181], v9 offset:10240
    ds_read_b64_tr_b16 v[182:183], v9 offset:10752
    s_waitcnt vmcnt(15)
    s_waitcnt lgkmcnt(12)
    v_mfma_f32_32x32x16_bf16 v[16:31], v[184:187], v[72:75], v[16:31]
    v_mfma_f32_32x32x16_bf16 v[32:47], v[188:191], v[72:75], v[32:47]
    s_add_u32 m0, s69, 2048
    s_add_u32 s3, s68, 28672
    buffer_load_dwordx4 v14, s[20:23], s3 offen lds
    ds_read_b64_tr_b16 v[184:185], v8 offset:12288
    ds_read_b64_tr_b16 v[186:187], v8 offset:12800
    ds_read_b64_tr_b16 v[188:189], v9 offset:12288
    ds_read_b64_tr_b16 v[190:191], v9 offset:12800
    s_waitcnt vmcnt(15)
    s_waitcnt lgkmcnt(12)
    v_mfma_f32_32x32x16_bf16 v[16:31], v[192:195], v[76:79], v[16:31]
    v_mfma_f32_32x32x16_bf16 v[32:47], v[196:199], v[76:79], v[32:47]
    s_add_u32 m0, s69, 3072
    s_add_u32 s3, s68, 43008
    buffer_load_dwordx4 v14, s[20:23], s3 offen lds
    ds_read_b64_tr_b16 v[192:193], v8 offset:14336
    ds_read_b64_tr_b16 v[194:195], v8 offset:14848
    ds_read_b64_tr_b16 v[196:197], v9 offset:14336
    ds_read_b64_tr_b16 v[198:199], v9 offset:14848
    s_waitcnt vmcnt(15)
    s_waitcnt lgkmcnt(12)
    v_mfma_f32_32x32x16_bf16 v[16:31], v[168:171], v[80:83], v[16:31]
    v_mfma_f32_32x32x16_bf16 v[32:47], v[172:175], v[80:83], v[32:47]
    s_add_u32 m0, s69, 4096
    s_add_u32 s3, s68, 57344
    buffer_load_dwordx4 v14, s[20:23], s3 offen lds
    ds_read_b64_tr_b16 v[168:169], v8 offset:16384
    ds_read_b64_tr_b16 v[170:171], v8 offset:16896
    ds_read_b64_tr_b16 v[172:173], v9 offset:16384
    ds_read_b64_tr_b16 v[174:175], v9 offset:16896
    s_waitcnt vmcnt(15)
    s_waitcnt lgkmcnt(12)
    v_mfma_f32_32x32x16_bf16 v[16:31], v[176:179], v[84:87], v[16:31]
    v_mfma_f32_32x32x16_bf16 v[32:47], v[180:183], v[84:87], v[32:47]
    s_add_u32 m0, s69, 5120
    s_add_u32 s3, s68, 71680
    buffer_load_dwordx4 v14, s[20:23], s3 offen lds
    ds_read_b64_tr_b16 v[176:177], v8 offset:18432
    ds_read_b64_tr_b16 v[178:179], v8 offset:18944
    ds_read_b64_tr_b16 v[180:181], v9 offset:18432
    ds_read_b64_tr_b16 v[182:183], v9 offset:18944
    s_waitcnt vmcnt(15)
    s_waitcnt lgkmcnt(12)
    v_mfma_f32_32x32x16_bf16 v[16:31], v[184:187], v[88:91], v[16:31]
    v_mfma_f32_32x32x16_bf16 v[32:47], v[188:191], v[88:91], v[32:47]
    s_add_u32 m0, s69, 6144
    s_add_u32 s3, s68, 86016
    buffer_load_dwordx4 v14, s[20:23], s3 offen lds
    ds_read_b64_tr_b16 v[184:185], v8 offset:20480
    ds_read_b64_tr_b16 v[186:187], v8 offset:20992
    ds_read_b64_tr_b16 v[188:189], v9 offset:20480
    ds_read_b64_tr_b16 v[190:191], v9 offset:20992
    s_waitcnt vmcnt(15)
    s_waitcnt lgkmcnt(12)
    v_mfma_f32_32x32x16_bf16 v[16:31], v[192:195], v[92:95], v[16:31]
    v_mfma_f32_32x32x16_bf16 v[32:47], v[196:199], v[92:95], v[32:47]
    s_add_u32 m0, s69, 7168
    s_add_u32 s3, s68, 100352
    buffer_load_dwordx4 v14, s[20:23], s3 offen lds
    ds_read_b64_tr_b16 v[192:193], v8 offset:22528
    ds_read_b64_tr_b16 v[194:195], v8 offset:23040
    ds_read_b64_tr_b16 v[196:197], v9 offset:22528
    ds_read_b64_tr_b16 v[198:199], v9 offset:23040
    s_waitcnt vmcnt(15)
    s_waitcnt lgkmcnt(12)
    v_mfma_f32_32x32x16_bf16 v[16:31], v[168:171], v[96:99], v[16:31]
    v_mfma_f32_32x32x16_bf16 v[32:47], v[172:175], v[96:99], v[32:47]
    s_add_u32 m0, s69, 8192
    s_add_u32 s3, s68, 114688
    buffer_load_dwordx4 v14, s[20:23], s3 offen lds
    ds_read_b64_tr_b16 v[168:169], v8 offset:24576
    ds_read_b64_tr_b16 v[170:171], v8 offset:25088
    ds_read_b64_tr_b16 v[172:173], v9 offset:24576
    ds_read_b64_tr_b16 v[174:175], v9 offset:25088
    s_waitcnt vmcnt(15)
    s_waitcnt lgkmcnt(12)
    v_mfma_f32_32x32x16_bf16 v[16:31], v[176:179], v[100:103], v[16:31]
    v_mfma_f32_32x32x16_bf16 v[32:47], v[180:183], v[100:103], v[32:47]
    s_add_u32 m0, s69, 9216
    s_add_u32 s3, s68, 129024
    buffer_load_dwordx4 v14, s[20:23], s3 offen lds
    ds_read_b64_tr_b16 v[176:177], v8 offset:26624
    ds_read_b64_tr_b16 v[178:179], v8 offset:27136
    ds_read_b64_tr_b16 v[180:181], v9 offset:26624
    ds_read_b64_tr_b16 v[182:183], v9 offset:27136
    s_waitcnt vmcnt(15)
    s_waitcnt lgkmcnt(12)
    v_mfma_f32_32x32x16_bf16 v[16:31], v[184:187], v[104:107], v[16:31]
    v_mfma_f32_32x32x16_bf16 v[32:47], v[188:191], v[104:107], v[32:47]
    s_add_u32 m0, s69, 10240
    s_add_u32 s3, s68, 143360
    buffer_load_dwordx4 v14, s[20:23], s3 offen lds
    ds_read_b64_tr_b16 v[184:185], v8 offset:28672
    ds_read_b64_tr_b16 v[186:187], v8 offset:29184
    ds_read_b64_tr_b16 v[188:189], v9 offset:28672
    ds_read_b64_tr_b16 v[190:191], v9 offset:29184
    s_waitcnt vmcnt(15)
    s_waitcnt lgkmcnt(12)
    v_mfma_f32_32x32x16_bf16 v[16:31], v[192:195], v[108:111], v[16:31]
    v_mfma_f32_32x32x16_bf16 v[32:47], v[196:199], v[108:111], v[32:47]
    s_add_u32 m0, s69, 11264
    s_add_u32 s3, s68, 157696
    buffer_load_dwordx4 v14, s[20:23], s3 offen lds
    ds_read_b64_tr_b16 v[192:193], v8 offset:30720
    ds_read_b64_tr_b16 v[194:195], v8 offset:31232
    ds_read_b64_tr_b16 v[196:197], v9 offset:30720
    ds_read_b64_tr_b16 v[198:199], v9 offset:31232
    s_waitcnt vmcnt(15)
    s_waitcnt lgkmcnt(12)
    v_mfma_f32_32x32x16_bf16 v[16:31], v[168:171], v[112:115], v[16:31]
    v_mfma_f32_32x32x16_bf16 v[32:47], v[172:175], v[112:115], v[32:47]
    s_add_u32 m0, s69, 12288
    s_add_u32 s3, s68, 172032
    buffer_load_dwordx4 v14, s[20:23], s3 offen lds
    s_waitcnt vmcnt(15)
    s_waitcnt lgkmcnt(8)
    v_mfma_f32_32x32x16_bf16 v[16:31], v[176:179], v[116:119], v[16:31]
    v_mfma_f32_32x32x16_bf16 v[32:47], v[180:183], v[116:119], v[32:47]
    s_add_u32 m0, s69, 13312
    s_add_u32 s3, s68, 186368
    buffer_load_dwordx4 v14, s[20:23], s3 offen lds
    s_waitcnt vmcnt(15)
    s_waitcnt lgkmcnt(4)
    v_mfma_f32_32x32x16_bf16 v[16:31], v[184:187], v[120:123], v[16:31]
    v_mfma_f32_32x32x16_bf16 v[32:47], v[188:191], v[120:123], v[32:47]
    s_add_u32 m0, s69, 14336
    s_add_u32 s3, s68, 200704
    buffer_load_dwordx4 v14, s[20:23], s3 offen lds
    s_waitcnt vmcnt(15)
    s_waitcnt lgkmcnt(0)
    v_mfma_f32_32x32x16_bf16 v[16:31], v[192:195], v[124:127], v[16:31]
    v_mfma_f32_32x32x16_bf16 v[32:47], v[196:199], v[124:127], v[32:47]
    s_add_u32 m0, s69, 15360
    s_add_u32 s3, s68, 215040
    buffer_load_dwordx4 v14, s[20:23], s3 offen lds
    v_lshlrev_b32 v10, 4, v1
    s_lshl_b32 s3, s6, 12
    s_add_u32 s3, s3, 147456
    v_add_u32 v11, s3, v10
    s_xor_b32 s3, s3, 8192
    v_add_u32 v12, s3, v10
    s_nop 7
    s_cmp_ge_u32 s6, 2
    s_cbranch_scc1 XC_30
    ds_write_b128 v11, v[32:35] offset:0
    ds_write_b128 v11, v[36:39] offset:1024
    ds_write_b128 v11, v[40:43] offset:2048
    ds_write_b128 v11, v[44:47] offset:3072
    v_mov_b32 v48, v16
    v_mov_b32 v49, v17
    v_mov_b32 v50, v18
    v_mov_b32 v51, v19
    v_mov_b32 v52, v20
    v_mov_b32 v53, v21
    v_mov_b32 v54, v22
    v_mov_b32 v55, v23
    v_mov_b32 v56, v24
    v_mov_b32 v57, v25
    v_mov_b32 v58, v26
    v_mov_b32 v59, v27
    v_mov_b32 v60, v28
    v_mov_b32 v61, v29
    v_mov_b32 v62, v30
    v_mov_b32 v63, v31
    s_branch XC_31
XC_30:
    ds_write_b128 v11, v[16:19] offset:0
    ds_write_b128 v11, v[20:23] offset:1024
    ds_write_b128 v11, v[24:27] offset:2048
    ds_write_b128 v11, v[28:31] offset:3072
    v_mov_b32 v48, v32
    v_mov_b32 v49, v33
    v_mov_b32 v50, v34
    v_mov_b32 v51, v35
    v_mov_b32 v52, v36
    v_mov_b32 v53, v37
    v_mov_b32 v54, v38
    v_mov_b32 v55, v39
    v_mov_b32 v56, v40
    v_mov_b32 v57, v41
    v_mov_b32 v58, v42
    v_mov_b32 v59, v43
    v_mov_b32 v60, v44
    v_mov_b32 v61, v45
    v_mov_b32 v62, v46
    v_mov_b32 v63, v47
XC_31:
    s_waitcnt lgkmcnt(0)
    s_barrier
    ds_read_b128 v[16:19], v12 offset:0
    ds_read_b128 v[20:23], v12 offset:1024
    ds_read_b128 v[24:27], v12 offset:2048
    ds_read_b128 v[28:31], v12 offset:3072
    s_waitcnt lgkmcnt(0)
    v_add_f32 v48, v48, v16
    v_add_f32 v49, v49, v17
    v_add_f32 v50, v50, v18
    v_add_f32 v51, v51, v19
    v_add_f32 v52, v52, v20
    v_add_f32 v53, v53, v21
    v_add_f32 v54, v54, v22
    v_add_f32 v55, v55, v23
    v_add_f32 v56, v56, v24
    v_add_f32 v57, v57, v25
    v_add_f32 v58, v58, v26
    v_add_f32 v59, v59, v27
    v_add_f32 v60, v60, v28
    v_add_f32 v61, v61, v29
    v_add_f32 v62, v62, v30
    v_add_f32 v63, v63, v31
    v_lshlrev_b32 v10, 16, v128
    v_and_b32 v11, 0xffff0000, v128
    v_fma_f32 v48, v48, v136, v10
    v_fma_f32 v49, v49, v137, v11
    v_lshlrev_b32 v10, 16, v129
    v_and_b32 v11, 0xffff0000, v129
    v_fma_f32 v50, v50, v138, v10
    v_fma_f32 v51, v51, v139, v11
    v_lshlrev_b32 v10, 16, v130
    v_and_b32 v11, 0xffff0000, v130
    v_fma_f32 v52, v52, v140, v10
    v_fma_f32 v53, v53, v141, v11
    v_lshlrev_b32 v10, 16, v131
    v_and_b32 v11, 0xffff0000, v131
    v_fma_f32 v54, v54, v142, v10
    v_fma_f32 v55, v55, v143, v11
    v_lshlrev_b32 v10, 16, v132
    v_and_b32 v11, 0xffff0000, v132
    v_fma_f32 v56, v56, v144, v10
    v_fma_f32 v57, v57, v145, v11
    v_lshlrev_b32 v10, 16, v133
    v_and_b32 v11, 0xffff0000, v133
    v_fma_f32 v58, v58, v146, v10
    v_fma_f32 v59, v59, v147, v11
    v_lshlrev_b32 v10, 16, v134
    v_and_b32 v11, 0xffff0000, v134
    v_fma_f32 v60, v60, v148, v10
    v_fma_f32 v61, v61, v149, v11
    v_lshlrev_b32 v10, 16, v135
    v_and_b32 v11, 0xffff0000, v135
    v_fma_f32 v62, v62, v150, v10
    v_fma_f32 v63, v63, v151, v11
    v_cvt_pk_bf16_f32 v16, v48, v49
    v_cvt_pk_bf16_f32 v17, v50, v51
    v_cvt_pk_bf16_f32 v18, v52, v53
    v_cvt_pk_bf16_f32 v19, v54, v55
    v_cvt_pk_bf16_f32 v20, v56, v57
    v_cvt_pk_bf16_f32 v21, v58, v59
    v_cvt_pk_bf16_f32 v22, v60, v61
    v_cvt_pk_bf16_f32 v23, v62, v63
    v_lshlrev_b32 v10, 4, v0
    v_add_u32 v10, 139264, v10
    ds_write_b128 v10, v[16:19]
    ds_write_b128 v10, v[20:23] offset:4096
    v_lshlrev_b32 v48, 16, v16
    v_and_b32 v49, 0xffff0000, v16
    v_lshlrev_b32 v50, 16, v17
    v_and_b32 v51, 0xffff0000, v17
    v_lshlrev_b32 v52, 16, v18
    v_and_b32 v53, 0xffff0000, v18
    v_lshlrev_b32 v54, 16, v19
    v_and_b32 v55, 0xffff0000, v19
    v_lshlrev_b32 v56, 16, v20
    v_and_b32 v57, 0xffff0000, v20
    v_lshlrev_b32 v58, 16, v21
    v_and_b32 v59, 0xffff0000, v21
    v_lshlrev_b32 v60, 16, v22
    v_and_b32 v61, 0xffff0000, v22
    v_lshlrev_b32 v62, 16, v23
    v_and_b32 v63, 0xffff0000, v23
    v_add_f32 v24, v48, v49
    v_mul_f32 v25, v48, v48
    v_fma_f32 v25, v49, v49, v25
    v_add_f32 v24, v24, v50
    v_fma_f32 v25, v50, v50, v25
    v_add_f32 v24, v24, v51
    v_fma_f32 v25, v51, v51, v25
    v_add_f32 v24, v24, v52
    v_fma_f32 v25, v52, v52, v25
    v_add_f32 v24, v24, v53
    v_fma_f32 v25, v53, v53, v25
    v_add_f32 v24, v24, v54
    v_fma_f32 v25, v54, v54, v25
    v_add_f32 v24, v24, v55
    v_fma_f32 v25, v55, v55, v25
    v_add_f32 v24, v24, v56
    v_fma_f32 v25, v56, v56, v25
    v_add_f32 v24, v24, v57
    v_fma_f32 v25, v57, v57, v25
    v_add_f32 v24, v24, v58
    v_fma_f32 v25, v58, v58, v25
    v_add_f32 v24, v24, v59
    v_fma_f32 v25, v59, v59, v25
    v_add_f32 v24, v24, v60
    v_fma_f32 v25, v60, v60, v25
    v_add_f32 v24, v24, v61
    v_fma_f32 v25, v61, v61, v25
    v_add_f32 v24, v24, v62
    v_fma_f32 v25, v62, v62, v25
    v_add_f32 v24, v24, v63
    v_fma_f32 v25, v63, v63, v25
    v_mov_b32 v26, v24
    v_mov_b32 v27, v25
    s_nop 1
    v_permlane32_swap_b32 v24, v26
    v_permlane32_swap_b32 v25, v27
    v_add_f32 v24, v24, v26
    v_add_f32 v25, v25, v27
    s_lshl_b32 s76, s74, 12
    s_lshl_b32 s3, s71, 4
    s_add_u32 s76, s76, s3
    s_lshl_b32 s3, s73, 3
    s_add_u32 s76, s76, s3
    s_add_u32 s76, s76, 524288
    v_lshlrev_b32 v13, 7, v2
    s_mov_b32 exec_hi, 0
    buffer_store_dwordx2 v[24:25], v13, s[48:51], s76 offen sc1
    s_mov_b32 exec_hi, -1
    v_fma_f32 v48, v48, v152, v48
    v_fma_f32 v49, v49, v153, v49
    v_fma_f32 v50, v50, v154, v50
    v_fma_f32 v51, v51, v155, v51
    v_fma_f32 v52, v52, v156, v52
    v_fma_f32 v53, v53, v157, v53
    v_fma_f32 v54, v54, v158, v54
    v_fma_f32 v55, v55, v159, v55
    v_fma_f32 v56, v56, v160, v56
    v_fma_f32 v57, v57, v161, v57
    v_fma_f32 v58, v58, v162, v58
    v_fma_f32 v59, v59, v163, v59
    v_fma_f32 v60, v60, v164, v60
    v_fma_f32 v61, v61, v165, v61
    v_fma_f32 v62, v62, v166, v62
    v_fma_f32 v63, v63, v167, v63
    s_lshl_b32 s76, s74, 5
    s_lshr_b32 s3, s75, 4
    s_add_u32 s76, s76, s3
    s_lshl_b32 s76, s76, 10
    s_add_u32 s76, s76, 10485760
    v_lshlrev_b32 v13, 4, v1
    v_cvt_pk_bf16_f32 v28, v48, v49
    v_cvt_pk_bf16_f32 v29, v50, v51
    v_cvt_pk_bf16_f32 v30, v52, v53
    v_cvt_pk_bf16_f32 v31, v54, v55
    s_nop 0
    v_permlane32_swap_b32 v28, v30
    v_permlane32_swap_b32 v29, v31
    buffer_store_dwordx4 v[28:31], v13, s[48:51], s76 offen offset:0 sc1
    v_cvt_pk_bf16_f32 v32, v56, v57
    v_cvt_pk_bf16_f32 v33, v58, v59
    v_cvt_pk_bf16_f32 v34, v60, v61
    v_cvt_pk_bf16_f32 v35, v62, v63
    s_nop 0
    v_permlane32_swap_b32 v32, v34
    v_permlane32_swap_b32 v33, v35
    buffer_store_dwordx4 v[32:35], v13, s[48:51], s76 offen offset:1024 sc1
    s_cmp_ge_u32 s5, 28
    s_cbranch_scc1 P3T_32
    v_lshrrev_b32 v20, 4, v1
    v_bfe_u32 v21, v1, 2, 2
    v_xor_b32 v21, v21, v20
    v_and_b32 v22, 1, v21
    v_lshlrev_b32 v22, 6, v22
    v_lshrrev_b32 v21, 1, v21
    v_xor_b32 v21, 1, v21
    v_mul_u32_u24 v21, 1792, v21
    v_mul_u32_u24 v20, 3584, v20
    v_add3_u32 v20, v20, v21, v22
    v_and_b32 v21, 3, v1
    v_lshl_add_u32 v20, v21, 4, v20
    s_mul_i32 s68, s6, 229376
    s_lshl_b32 s3, s81, 7
    s_add_u32 s68, s68, s3
    s_lshl_b32 s69, s6, 14
    s_add_u32 m0, s69, 0
    s_add_u32 s3, s68, 0
    buffer_load_dwordx4 v20, s[20:23], s3 offen lds
    s_add_u32 m0, s69, 1024
    s_add_u32 s3, s68, 14336
    buffer_load_dwordx4 v20, s[20:23], s3 offen lds
    s_add_u32 m0, s69, 2048
    s_add_u32 s3, s68, 28672
    buffer_load_dwordx4 v20, s[20:23], s3 offen lds
    s_add_u32 m0, s69, 3072
    s_add_u32 s3, s68, 43008
    buffer_load_dwordx4 v20, s[20:23], s3 offen lds
    s_add_u32 m0, s69, 4096
    s_add_u32 s3, s68, 57344
    buffer_load_dwordx4 v20, s[20:23], s3 offen lds
    s_add_u32 m0, s69, 5120
    s_add_u32 s3, s68, 71680
    buffer_load_dwordx4 v20, s[20:23], s3 offen lds
    s_add_u32 m0, s69, 6144
    s_add_u32 s3, s68, 86016
    buffer_load_dwordx4 v20, s[20:23], s3 offen lds
    s_add_u32 m0, s69, 7168
    s_add_u32 s3, s68, 100352
    buffer_load_dwordx4 v20, s[20:23], s3 offen lds
    s_add_u32 m0, s69, 8192
    s_add_u32 s3, s68, 114688
    buffer_load_dwordx4 v20, s[20:23], s3 offen lds
    s_add_u32 m0, s69, 9216
    s_add_u32 s3, s68, 129024
    buffer_load_dwordx4 v20, s[20:23], s3 offen lds
    s_add_u32 m0, s69, 10240
    s_add_u32 s3, s68, 143360
    buffer_load_dwordx4 v20, s[20:23], s3 offen lds
    s_add_u32 m0, s69, 11264
    s_add_u32 s3, s68, 157696
    buffer_load_dwordx4 v20, s[20:23], s3 offen lds
    s_add_u32 m0, s69, 12288
    s_add_u32 s3, s68, 172032
    buffer_load_dwordx4 v20, s[20:23], s3 offen lds
    s_add_u32 m0, s69, 13312
    s_add_u32 s3, s68, 186368
    buffer_load_dwordx4 v20, s[20:23], s3 offen lds
    s_add_u32 m0, s69, 14336
    s_add_u32 s3, s68, 200704
    buffer_load_dwordx4 v20, s[20:23], s3 offen lds
    s_add_u32 m0, s69, 15360
    s_add_u32 s3, s68, 215040
    buffer_load_dwordx4 v20, s[20:23], s3 offen lds
    s_waitcnt vmcnt(16)
    s_branch P3T_32b
P3T_32:
    s_waitcnt vmcnt(0)
P3T_32b:
    s_barrier
    s_cmp_lg_u32 s6, 0
    s_cbranch_scc1 SG_33
    v_cmp_le_u32 vcc, 7, v1
    v_mov_b32 v4, 0
    v_mov_b32 v5, -220
    v_cndmask_b32 v4, v4, v5, vcc
    v_lshl_add_u32 v4, v1, 5, v4
    s_lshr_b32 s3, s70, 3
    s_bfe_u32 s52, s70, 0x20001
    s_lshl_b32 s52, s52, 3
    s_add_u32 s3, s3, s52
    v_add_u32 v4, s3, v4
    s_and_b32 s3, s70, 1
    s_lshl_b32 s3, s3, 3
    s_add_u32 s3, s3, s71
    s_lshl_b32 s3, s3, 2
    v_lshl_add_u32 v5, v4, 7, s3
    s_mov_b32 s3, 163840
    v_mov_b32 v4, s7
    s_mov_b32 exec_lo, 0x3fff
    s_mov_b32 exec_hi, 0x0
    buffer_store_dword v4, v5, s[48:51], s3 offen sc0 sc1
    s_mov_b64 exec, -1
SG_33:
    s_cmp_ge_u32 s5, 28
    s_cbranch_scc1 P6START
    v_bfe_u32 v12, v1, 2, 2
    v_lshl_add_u32 v13, v3, 3, v12
    v_lshlrev_b32 v13, 8, v13
    v_bfe_u32 v14, v1, 4, 1
    v_lshl_add_u32 v13, v14, 5, v13
    v_and_b32 v14, 3, v1
    v_lshl_add_u32 v13, v14, 3, v13
    v_xor_b32 v14, 0, v12
    v_lshl_add_u32 v120, v14, 6, v13
    v_add_u32 v124, 0x10000, v120
    v_xor_b32 v14, 1, v12
    v_lshl_add_u32 v121, v14, 6, v13
    v_add_u32 v125, 0x10000, v121
    v_xor_b32 v14, 2, v12
    v_lshl_add_u32 v122, v14, 6, v13
    v_add_u32 v126, 0x10000, v122
    v_xor_b32 v14, 3, v12
    v_lshl_add_u32 v123, v14, 6, v13
    v_add_u32 v127, 0x10000, v123
    v_xor_b32 v14, s6, v12
    v_lshl_add_u32 v8, v14, 6, v13
    v_add_u32 v9, 0x10000, v8
    v_and_b32 v14, 1, v1
    v_lshlrev_b32 v14, 10, v14
    v_lshl_add_u32 v14, v3, 4, v14
    v_add_u32 v14, 131072, v14
    s_waitcnt vmcnt(0)
    s_barrier
    ds_read_b64_tr_b16 v[80:81], v8 offset:0
    ds_read_b64_tr_b16 v[82:83], v8 offset:1024
    ds_read_b128 v[84:87], v14 offset:0
    ds_read_b64_tr_b16 v[88:89], v8 offset:4096
    ds_read_b64_tr_b16 v[90:91], v8 offset:5120
    ds_read_b128 v[92:95], v14 offset:32
    ds_read_b64_tr_b16 v[96:97], v8 offset:8192
    ds_read_b64_tr_b16 v[98:99], v8 offset:9216
    ds_read_b128 v[100:103], v14 offset:64
    ds_read_b64_tr_b16 v[104:105], v8 offset:12288
    ds_read_b64_tr_b16 v[106:107], v8 offset:13312
    ds_read_b128 v[108:111], v14 offset:96
    s_waitcnt lgkmcnt(9)
    v_mfma_f32_32x32x16_bf16 v[16:31], v[80:83], v[84:87], 0
    ds_read_b64_tr_b16 v[80:81], v8 offset:16384
    ds_read_b64_tr_b16 v[82:83], v8 offset:17408
    ds_read_b128 v[84:87], v14 offset:128
    s_waitcnt lgkmcnt(9)
    v_mfma_f32_32x32x16_bf16 v[16:31], v[88:91], v[92:95], v[16:31]
    ds_read_b64_tr_b16 v[88:89], v8 offset:20480
    ds_read_b64_tr_b16 v[90:91], v8 offset:21504
    ds_read_b128 v[92:95], v14 offset:160
    s_waitcnt lgkmcnt(9)
    v_mfma_f32_32x32x16_bf16 v[16:31], v[96:99], v[100:103], v[16:31]
    ds_read_b64_tr_b16 v[96:97], v8 offset:24576
    ds_read_b64_tr_b16 v[98:99], v8 offset:25600
    ds_read_b128 v[100:103], v14 offset:192
    s_waitcnt lgkmcnt(9)
    v_mfma_f32_32x32x16_bf16 v[16:31], v[104:107], v[108:111], v[16:31]
    ds_read_b64_tr_b16 v[104:105], v8 offset:28672
    ds_read_b64_tr_b16 v[106:107], v8 offset:29696
    ds_read_b128 v[108:111], v14 offset:224
    s_waitcnt lgkmcnt(9)
    v_mfma_f32_32x32x16_bf16 v[16:31], v[80:83], v[84:87], v[16:31]
    ds_read_b64_tr_b16 v[80:81], v8 offset:32768
    ds_read_b64_tr_b16 v[82:83], v8 offset:33792
    ds_read_b128 v[84:87], v14 offset:256
    s_waitcnt lgkmcnt(9)
    v_mfma_f32_32x32x16_bf16 v[16:31], v[88:91], v[92:95], v[16:31]
    ds_read_b64_tr_b16 v[88:89], v8 offset:36864
    ds_read_b64_tr_b16 v[90:91], v8 offset:37888
    ds_read_b128 v[92:95], v14 offset:288
    s_waitcnt lgkmcnt(9)
    v_mfma_f32_32x32x16_bf16 v[16:31], v[96:99], v[100:103], v[16:31]
    ds_read_b64_tr_b16 v[96:97], v8 offset:40960
    ds_read_b64_tr_b16 v[98:99], v8 offset:41984
    ds_read_b128 v[100:103], v14 offset:320
    s_waitcnt lgkmcnt(9)
    v_mfma_f32_32x32x16_bf16 v[16:31], v[104:107], v[108:111], v[16:31]
    ds_read_b64_tr_b16 v[104:105], v8 offset:45056
    ds_read_b64_tr_b16 v[106:107], v8 offset:46080
    ds_read_b128 v[108:111], v14 offset:352
    s_waitcnt lgkmcnt(9)
    v_mfma_f32_32x32x16_bf16 v[16:31], v[80:83], v[84:87], v[16:31]
    ds_read_b64_tr_b16 v[80:81], v8 offset:49152
    ds_read_b64_tr_b16 v[82:83], v8 offset:50176
    ds_read_b128 v[84:87], v14 offset:384
    s_waitcnt lgkmcnt(9)
    v_mfma_f32_32x32x16_bf16 v[16:31], v[88:91], v[92:95], v[16:31]
    ds_read_b64_tr_b16 v[88:89], v8 offset:53248
    ds_read_b64_tr_b16 v[90:91], v8 offset:54272
    ds_read_b128 v[92:95], v14 offset:416
    s_waitcnt lgkmcnt(9)
    v_mfma_f32_32x32x16_bf16 v[16:31], v[96:99], v[100:103], v[16:31]
    ds_read_b64_tr_b16 v[96:97], v8 offset:57344
    ds_read_b64_tr_b16 v[98:99], v8 offset:58368
    ds_read_b128 v[100:103], v14 offset:448
    s_waitcnt lgkmcnt(9)
    v_mfma_f32_32x32x16_bf16 v[16:31], v[104:107], v[108:111], v[16:31]
    ds_read_b64_tr_b16 v[104:105], v8 offset:61440
    ds_read_b64_tr_b16 v[106:107], v8 offset:62464
    ds_read_b128 v[108:111], v14 offset:480
    s_waitcnt lgkmcnt(9)
    v_mfma_f32_32x32x16_bf16 v[16:31], v[80:83], v[84:87], v[16:31]
    ds_read_b64_tr_b16 v[80:81], v9 offset:0
    ds_read_b64_tr_b16 v[82:83], v9 offset:1024
    ds_read_b128 v[84:87], v14 offset:512
    s_waitcnt lgkmcnt(9)
    v_mfma_f32_32x32x16_bf16 v[16:31], v[88:91], v[92:95], v[16:31]
    ds_read_b64_tr_b16 v[88:89], v9 offset:4096
    ds_read_b64_tr_b16 v[90:91], v9 offset:5120
    ds_read_b128 v[92:95], v14 offset:544
    s_waitcnt lgkmcnt(9)
    v_mfma_f32_32x32x16_bf16 v[16:31], v[96:99], v[100:103], v[16:31]
    ds_read_b64_tr_b16 v[96:97], v9 offset:8192
    ds_read_b64_tr_b16 v[98:99], v9 offset:9216
    ds_read_b128 v[100:103], v14 offset:576
    s_waitcnt lgkmcnt(9)
    v_mfma_f32_32x32x16_bf16 v[16:31], v[104:107], v[108:111], v[16:31]
    ds_read_b64_tr_b16 v[104:105], v9 offset:12288
    ds_read_b64_tr_b16 v[106:107], v9 offset:13312
    ds_read_b128 v[108:111], v14 offset:608
    s_waitcnt lgkmcnt(9)
    v_mfma_f32_32x32x16_bf16 v[16:31], v[80:83], v[84:87], v[16:31]
    ds_read_b64_tr_b16 v[80:81], v9 offset:16384
    ds_read_b64_tr_b16 v[82:83], v9 offset:17408
    ds_read_b128 v[84:87], v14 offset:640
    s_waitcnt lgkmcnt(9)
    v_mfma_f32_32x32x16_bf16 v[16:31], v[88:91], v[92:95], v[16:31]
    ds_read_b64_tr_b16 v[88:89], v9 offset:20480
    ds_read_b64_tr_b16 v[90:91], v9 offset:21504
    ds_read_b128 v[92:95], v14 offset:672
    s_waitcnt lgkmcnt(9)
    v_mfma_f32_32x32x16_bf16 v[16:31], v[96:99], v[100:103], v[16:31]
    ds_read_b64_tr_b16 v[96:97], v9 offset:24576
    ds_read_b64_tr_b16 v[98:99], v9 offset:25600
    ds_read_b128 v[100:103], v14 offset:704
    s_waitcnt lgkmcnt(9)
    v_mfma_f32_32x32x16_bf16 v[16:31], v[104:107], v[108:111], v[16:31]
    ds_read_b64_tr_b16 v[104:105], v9 offset:28672
    ds_read_b64_tr_b16 v[106:107], v9 offset:29696
    ds_read_b128 v[108:111], v14 offset:736
    s_waitcnt lgkmcnt(9)
    v_mfma_f32_32x32x16_bf16 v[16:31], v[80:83], v[84:87], v[16:31]
    ds_read_b64_tr_b16 v[80:81], v9 offset:32768
    ds_read_b64_tr_b16 v[82:83], v9 offset:33792
    ds_read_b128 v[84:87], v14 offset:768
    s_waitcnt lgkmcnt(9)
    v_mfma_f32_32x32x16_bf16 v[16:31], v[88:91], v[92:95], v[16:31]
    ds_read_b64_tr_b16 v[88:89], v9 offset:36864
    ds_read_b64_tr_b16 v[90:91], v9 offset:37888
    ds_read_b128 v[92:95], v14 offset:800
    s_waitcnt lgkmcnt(9)
    v_mfma_f32_32x32x16_bf16 v[16:31], v[96:99], v[100:103], v[16:31]
    ds_read_b64_tr_b16 v[96:97], v9 offset:40960
    ds_read_b64_tr_b16 v[98:99], v9 offset:41984
    ds_read_b128 v[100:103], v14 offset:832
    s_waitcnt lgkmcnt(9)
    v_mfma_f32_32x32x16_bf16 v[16:31], v[104:107], v[108:111], v[16:31]
    ds_read_b64_tr_b16 v[104:105], v9 offset:45056
    ds_read_b64_tr_b16 v[106:107], v9 offset:46080
    ds_read_b128 v[108:111], v14 offset:864
    s_waitcnt lgkmcnt(9)
    v_mfma_f32_32x32x16_bf16 v[16:31], v[80:83], v[84:87], v[16:31]
    ds_read_b64_tr_b16 v[80:81], v9 offset:49152
    ds_read_b64_tr_b16 v[82:83], v9 offset:50176
    ds_read_b128 v[84:87], v14 offset:896
    s_waitcnt lgkmcnt(9)
    v_mfma_f32_32x32x16_bf16 v[16:31], v[88:91], v[92:95], v[16:31]
    ds_read_b64_tr_b16 v[88:89], v9 offset:53248
    ds_read_b64_tr_b16 v[90:91], v9 offset:54272
    ds_read_b128 v[92:95], v14 offset:928
    s_waitcnt lgkmcnt(9)
    v_mfma_f32_32x32x16_bf16 v[16:31], v[96:99], v[100:103], v[16:31]
    ds_read_b64_tr_b16 v[96:97], v9 offset:57344
    ds_read_b64_tr_b16 v[98:99], v9 offset:58368
    ds_read_b128 v[100:103], v14 offset:960
    s_waitcnt lgkmcnt(9)
    v_mfma_f32_32x32x16_bf16 v[16:31], v[104:107], v[108:111], v[16:31]
    ds_read_b64_tr_b16 v[104:105], v9 offset:61440
    ds_read_b64_tr_b16 v[106:107], v9 offset:62464
    ds_read_b128 v[108:111], v14 offset:992
    s_waitcnt lgkmcnt(9)
    v_mfma_f32_32x32x16_bf16 v[16:31], v[80:83], v[84:87], v[16:31]
    s_waitcnt lgkmcnt(6)
    v_mfma_f32_32x32x16_bf16 v[16:31], v[88:91], v[92:95], v[16:31]
    s_waitcnt lgkmcnt(3)
    v_mfma_f32_32x32x16_bf16 v[16:31], v[96:99], v[100:103], v[16:31]
    s_waitcnt lgkmcnt(0)
    v_mfma_f32_32x32x16_bf16 v[16:31], v[104:107], v[108:111], v[16:31]
    v_and_b32 v14, 1, v1
    v_lshlrev_b32 v14, 9, v14
    v_lshl_add_u32 v14, v3, 4, v14
    s_lshl_b32 s3, s6, 7
    s_add_u32 s3, s3, 135168
    v_add_u32 v14, s3, v14
    s_mov_b32 exec_lo, 3
    s_mov_b32 exec_hi, 3
    s_nop 7
    ds_write_b128 v14, v[16:19] offset:0
    ds_write_b128 v14, v[20:23] offset:32
    ds_write_b128 v14, v[24:27] offset:64
    ds_write_b128 v14, v[28:31] offset:96
    s_mov_b64 exec, -1
    s_cmp_lg_u32 s6, 0
    s_cbranch_scc1 WT_35
    s_lshl_b32 s3, s2, 7
    v_and_b32 v4, 15, v1
    v_lshl_add_u32 v4, v4, 2, s3
    s_mov_b32 s3, 163840
    s_mov_b32 s52, 262144
WL_36:
    buffer_load_dword v5, v4, s[48:51], s3 offen sc0 sc1
    s_waitcnt vmcnt(0)
    v_cmp_ne_u32 vcc, s7, v5
    s_cbranch_vccz WE_34
    s_sub_u32 s52, s52, 1
    s_cmp_lg_u32 s52, 0
    s_cbranch_scc1 WL_36
    s_branch WE_34
WT_35:
WE_34:
    s_waitcnt vmcnt(0) lgkmcnt(0)
    s_barrier
    s_lshl_b32 s76, s80, 2
    s_add_u32 s76, s76, s6
    s_lshl_b32 s77, s76, 12
    s_add_u32 s77, s77, 524288
    v_lshlrev_b32 v13, 7, v2
    v_lshl_add_u32 v13, v3, 6, v13
    buffer_load_dwordx4 v[64:67], v13, s[48:51], s77 offen offset:0 sc1
    buffer_load_dwordx4 v[68:71], v13, s[48:51], s77 offen offset:16 sc1
    buffer_load_dwordx4 v[72:75], v13, s[48:51], s77 offen offset:32 sc1
    buffer_load_dwordx4 v[76:79], v13, s[48:51], s77 offen offset:48 sc1
    s_lshl_b32 s85, s76, 17
    s_add_u32 s85, s85, 20971520
    s_lshl_b32 s76, s76, 15
    s_add_u32 s76, s76, 10485760
    v_lshlrev_b32 v13, 4, v1
    v_lshlrev_b32 v9, 4, v1
    s_add_u32 s3, s76, 0
    buffer_load_dwordx4 v[128:131], v13, s[48:51], s3 offen offset:0 sc1
    buffer_load_dwordx4 v[132:135], v13, s[48:51], s3 offen offset:1024 sc1
    buffer_load_dwordx4 v[136:139], v13, s[48:51], s3 offen offset:2048 sc1
    buffer_load_dwordx4 v[140:143], v13, s[48:51], s3 offen offset:3072 sc1
    s_add_u32 s3, s76, 4096
    buffer_load_dwordx4 v[144:147], v13, s[48:51], s3 offen offset:0 sc1
    buffer_load_dwordx4 v[148:151], v13, s[48:51], s3 offen offset:1024 sc1
    buffer_load_dwordx4 v[152:155], v13, s[48:51], s3 offen offset:2048 sc1
    buffer_load_dwordx4 v[156:159], v13, s[48:51], s3 offen offset:3072 sc1
    s_add_u32 s3, s76, 8192
    buffer_load_dwordx4 v[160:163], v13, s[48:51], s3 offen offset:0 sc1
    buffer_load_dwordx4 v[164:167], v13, s[48:51], s3 offen offset:1024 sc1
    buffer_load_dwordx4 v[168:171], v13, s[48:51], s3 offen offset:2048 sc1
    buffer_load_dwordx4 v[172:175], v13, s[48:51], s3 offen offset:3072 sc1
    s_add_u32 s3, s76, 12288
    buffer_load_dwordx4 v[176:179], v13, s[48:51], s3 offen offset:0 sc1
    buffer_load_dwordx4 v[180:183], v13, s[48:51], s3 offen offset:1024 sc1
    buffer_load_dwordx4 v[184:187], v13, s[48:51], s3 offen offset:2048 sc1
    buffer_load_dwordx4 v[188:191], v13, s[48:51], s3 offen offset:3072 sc1
    s_add_u32 s3, s76, 16384
    buffer_load_dwordx4 v[192:195], v13, s[48:51], s3 offen offset:0 sc1
    buffer_load_dwordx4 v[196:199], v13, s[48:51], s3 offen offset:1024 sc1
    buffer_load_dwordx4 v[200:203], v13, s[48:51], s3 offen offset:2048 sc1
    buffer_load_dwordx4 v[204:207], v13, s[48:51], s3 offen offset:3072 sc1
    s_add_u32 s3, s76, 20480
    buffer_load_dwordx4 v[208:211], v13, s[48:51], s3 offen offset:0 sc1
    buffer_load_dwordx4 v[212:215], v13, s[48:51], s3 offen offset:1024 sc1
    buffer_load_dwordx4 v[216:219], v13, s[48:51], s3 offen offset:2048 sc1
    buffer_load_dwordx4 v[220:223], v13, s[48:51], s3 offen offset:3072 sc1
    s_add_u32 s3, s76, 24576
    buffer_load_dwordx4 v[224:227], v13, s[48:51], s3 offen offset:0 sc1
    buffer_load_dwordx4 v[228:231], v13, s[48:51], s3 offen offset:1024 sc1
    buffer_load_dwordx4 v[232:235], v13, s[48:51], s3 offen offset:2048 sc1
    buffer_load_dwordx4 v[236:239], v13, s[48:51], s3 offen offset:3072 sc1
    s_add_u32 s3, s76, 28672
    buffer_load_dwordx4 v[240:243], v13, s[48:51], s3 offen offset:0 sc1
    buffer_load_dwordx4 v[244:247], v13, s[48:51], s3 offen offset:1024 sc1
    buffer_load_dwordx4 v[248:251], v13, s[48:51], s3 offen offset:2048 sc1
    buffer_load_dwordx4 v[252:255], v13, s[48:51], s3 offen offset:3072 sc1
    ds_read_b64_tr_b16 v[80:81], v120 offset:0
    ds_read_b64_tr_b16 v[82:83], v120 offset:1024
    ds_read_b64_tr_b16 v[84:85], v121 offset:0
    ds_read_b64_tr_b16 v[86:87], v121 offset:1024
    ds_read_b64_tr_b16 v[88:89], v120 offset:4096
    ds_read_b64_tr_b16 v[90:91], v120 offset:5120
    ds_read_b64_tr_b16 v[92:93], v121 offset:4096
    ds_read_b64_tr_b16 v[94:95], v121 offset:5120
    ds_read_b64_tr_b16 v[96:97], v120 offset:8192
    ds_read_b64_tr_b16 v[98:99], v120 offset:9216
    ds_read_b64_tr_b16 v[100:101], v121 offset:8192
    ds_read_b64_tr_b16 v[102:103], v121 offset:9216
    ds_read_b64_tr_b16 v[104:105], v120 offset:12288
    ds_read_b64_tr_b16 v[106:107], v120 offset:13312
    ds_read_b64_tr_b16 v[108:109], v121 offset:12288
    ds_read_b64_tr_b16 v[110:111], v121 offset:13312
    s_waitcnt vmcnt(31)
    s_waitcnt lgkmcnt(12)
    v_mfma_f32_32x32x16_bf16 v[16:31], v[80:83], v[128:131], 0
    v_mfma_f32_32x32x16_bf16 v[32:47], v[84:87], v[128:131], 0
    ds_read_b64_tr_b16 v[80:81], v120 offset:16384
    ds_read_b64_tr_b16 v[82:83], v120 offset:17408
    ds_read_b64_tr_b16 v[84:85], v121 offset:16384
    ds_read_b64_tr_b16 v[86:87], v121 offset:17408
    s_waitcnt vmcnt(30)
    s_waitcnt lgkmcnt(12)
    v_mfma_f32_32x32x16_bf16 v[16:31], v[88:91], v[132:135], v[16:31]
    v_mfma_f32_32x32x16_bf16 v[32:47], v[92:95], v[132:135], v[32:47]
    ds_read_b64_tr_b16 v[88:89], v120 offset:20480
    ds_read_b64_tr_b16 v[90:91], v120 offset:21504
    ds_read_b64_tr_b16 v[92:93], v121 offset:20480
    ds_read_b64_tr_b16 v[94:95], v121 offset:21504
    s_waitcnt vmcnt(29)
    s_waitcnt lgkmcnt(12)
    v_mfma_f32_32x32x16_bf16 v[16:31], v[96:99], v[136:139], v[16:31]
    v_mfma_f32_32x32x16_bf16 v[32:47], v[100:103], v[136:139], v[32:47]
    ds_read_b64_tr_b16 v[96:97], v120 offset:24576
    ds_read_b64_tr_b16 v[98:99], v120 offset:25600
    ds_read_b64_tr_b16 v[100:101], v121 offset:24576
    ds_read_b64_tr_b16 v[102:103], v121 offset:25600
    s_waitcnt vmcnt(28)
    s_waitcnt lgkmcnt(12)
    v_mfma_f32_32x32x16_bf16 v[16:31], v[104:107], v[140:143], v[16:31]
    v_mfma_f32_32x32x16_bf16 v[32:47], v[108:111], v[140:143], v[32:47]
    ds_read_b64_tr_b16 v[104:105], v120 offset:28672
    ds_read_b64_tr_b16 v[106:107], v120 offset:29696
    ds_read_b64_tr_b16 v[108:109], v121 offset:28672
    ds_read_b64_tr_b16 v[110:111], v121 offset:29696
    s_waitcnt vmcnt(27)
    s_waitcnt lgkmcnt(12)
    v_mfma_f32_32x32x16_bf16 v[16:31], v[80:83], v[144:147], v[16:31]
    v_mfma_f32_32x32x16_bf16 v[32:47], v[84:87], v[144:147], v[32:47]
    ds_read_b64_tr_b16 v[80:81], v120 offset:32768
    ds_read_b64_tr_b16 v[82:83], v120 offset:33792
    ds_read_b64_tr_b16 v[84:85], v121 offset:32768
    ds_read_b64_tr_b16 v[86:87], v121 offset:33792
    s_waitcnt vmcnt(26)
    s_waitcnt lgkmcnt(12)
    v_mfma_f32_32x32x16_bf16 v[16:31], v[88:91], v[148:151], v[16:31]
    v_mfma_f32_32x32x16_bf16 v[32:47], v[92:95], v[148:151], v[32:47]
    ds_read_b64_tr_b16 v[88:89], v120 offset:36864
    ds_read_b64_tr_b16 v[90:91], v120 offset:37888
    ds_read_b64_tr_b16 v[92:93], v121 offset:36864
    ds_read_b64_tr_b16 v[94:95], v121 offset:37888
    s_waitcnt vmcnt(25)
    s_waitcnt lgkmcnt(12)
    v_mfma_f32_32x32x16_bf16 v[16:31], v[96:99], v[152:155], v[16:31]
    v_mfma_f32_32x32x16_bf16 v[32:47], v[100:103], v[152:155], v[32:47]
    ds_read_b64_tr_b16 v[96:97], v120 offset:40960
    ds_read_b64_tr_b16 v[98:99], v120 offset:41984
    ds_read_b64_tr_b16 v[100:101], v121 offset:40960
    ds_read_b64_tr_b16 v[102:103], v121 offset:41984
    s_waitcnt vmcnt(24)
    s_waitcnt lgkmcnt(12)
    v_mfma_f32_32x32x16_bf16 v[16:31], v[104:107], v[156:159], v[16:31]
    v_mfma_f32_32x32x16_bf16 v[32:47], v[108:111], v[156:159], v[32:47]
    ds_read_b64_tr_b16 v[104:105], v120 offset:45056
    ds_read_b64_tr_b16 v[106:107], v120 offset:46080
    ds_read_b64_tr_b16 v[108:109], v121 offset:45056
    ds_read_b64_tr_b16 v[110:111], v121 offset:46080
    s_waitcnt vmcnt(23)
    s_waitcnt lgkmcnt(12)
    v_mfma_f32_32x32x16_bf16 v[16:31], v[80:83], v[160:163], v[16:31]
    v_mfma_f32_32x32x16_bf16 v[32:47], v[84:87], v[160:163], v[32:47]
    s_add_u32 s86, s85, 32768
    buffer_load_dwordx4 a[0:3], v9, s[48:51], s86 offen offset:0 sc1
    ds_read_b64_tr_b16 v[80:81], v120 offset:49152
    ds_read_b64_tr_b16 v[82:83], v120 offset:50176
    ds_read_b64_tr_b16 v[84:85], v121 offset:49152
    ds_read_b64_tr_b16 v[86:87], v121 offset:50176
    s_waitcnt vmcnt(23)
    s_waitcnt lgkmcnt(12)
    v_mfma_f32_32x32x16_bf16 v[16:31], v[88:91], v[164:167], v[16:31]
    v_mfma_f32_32x32x16_bf16 v[32:47], v[92:95], v[164:167], v[32:47]
    buffer_load_dwordx4 a[4:7], v9, s[48:51], s86 offen offset:1024 sc1
    ds_read_b64_tr_b16 v[88:89], v120 offset:53248
    ds_read_b64_tr_b16 v[90:91], v120 offset:54272
    ds_read_b64_tr_b16 v[92:93], v121 offset:53248
    ds_read_b64_tr_b16 v[94:95], v121 offset:54272
    s_waitcnt vmcnt(23)
    s_waitcnt lgkmcnt(12)
    v_mfma_f32_32x32x16_bf16 v[16:31], v[96:99], v[168:171], v[16:31]
    v_mfma_f32_32x32x16_bf16 v[32:47], v[100:103], v[168:171], v[32:47]
    buffer_load_dwordx4 a[8:11], v9, s[48:51], s86 offen offset:2048 sc1
    ds_read_b64_tr_b16 v[96:97], v120 offset:57344
    ds_read_b64_tr_b16 v[98:99], v120 offset:58368
    ds_read_b64_tr_b16 v[100:101], v121 offset:57344
    ds_read_b64_tr_b16 v[102:103], v121 offset:58368
    s_waitcnt vmcnt(23)
    s_waitcnt lgkmcnt(12)
    v_mfma_f32_32x32x16_bf16 v[16:31], v[104:107], v[172:175], v[16:31]
    v_mfma_f32_32x32x16_bf16 v[32:47], v[108:111], v[172:175], v[32:47]
    buffer_load_dwordx4 a[12:15], v9, s[48:51], s86 offen offset:3072 sc1
    ds_read_b64_tr_b16 v[104:105], v120 offset:61440
    ds_read_b64_tr_b16 v[106:107], v120 offset:62464
    ds_read_b64_tr_b16 v[108:109], v121 offset:61440
    ds_read_b64_tr_b16 v[110:111], v121 offset:62464
    s_waitcnt vmcnt(23)
    s_waitcnt lgkmcnt(12)
    v_mfma_f32_32x32x16_bf16 v[16:31], v[80:83], v[176:179], v[16:31]
    v_mfma_f32_32x32x16_bf16 v[32:47], v[84:87], v[176:179], v[32:47]
    s_add_u32 s86, s85, 36864
    buffer_load_dwordx4 a[16:19], v9, s[48:51], s86 offen offset:0 sc1
    ds_read_b64_tr_b16 v[80:81], v124 offset:0
    ds_read_b64_tr_b16 v[82:83], v124 offset:1024
    ds_read_b64_tr_b16 v[84:85], v125 offset:0
    ds_read_b64_tr_b16 v[86:87], v125 offset:1024
    s_waitcnt vmcnt(23)
    s_waitcnt lgkmcnt(12)
    v_mfma_f32_32x32x16_bf16 v[16:31], v[88:91], v[180:183], v[16:31]
    v_mfma_f32_32x32x16_bf16 v[32:47], v[92:95], v[180:183], v[32:47]
    buffer_load_dwordx4 a[20:23], v9, s[48:51], s86 offen offset:1024 sc1
    ds_read_b64_tr_b16 v[88:89], v124 offset:4096
    ds_read_b64_tr_b16 v[90:91], v124 offset:5120
    ds_read_b64_tr_b16 v[92:93], v125 offset:4096
    ds_read_b64_tr_b16 v[94:95], v125 offset:5120
    s_waitcnt vmcnt(23)
    s_waitcnt lgkmcnt(12)
    v_mfma_f32_32x32x16_bf16 v[16:31], v[96:99], v[184:187], v[16:31]
    v_mfma_f32_32x32x16_bf16 v[32:47], v[100:103], v[184:187], v[32:47]
    buffer_load_dwordx4 a[24:27], v9, s[48:51], s86 offen offset:2048 sc1
    ds_read_b64_tr_b16 v[96:97], v124 offset:8192
    ds_read_b64_tr_b16 v[98:99], v124 offset:9216
    ds_read_b64_tr_b16 v[100:101], v125 offset:8192
    ds_read_b64_tr_b16 v[102:103], v125 offset:9216
    s_waitcnt vmcnt(23)
    s_waitcnt lgkmcnt(12)
    v_mfma_f32_32x32x16_bf16 v[16:31], v[104:107], v[188:191], v[16:31]
    v_mfma_f32_32x32x16_bf16 v[32:47], v[108:111], v[188:191], v[32:47]
    buffer_load_dwordx4 a[28:31], v9, s[48:51], s86 offen offset:3072 sc1
    ds_read_b64_tr_b16 v[104:105], v124 offset:12288
    ds_read_b64_tr_b16 v[106:107], v124 offset:13312
    ds_read_b64_tr_b16 v[108:109], v125 offset:12288
    ds_read_b64_tr_b16 v[110:111], v125 offset:13312
    s_waitcnt vmcnt(23)
    s_waitcnt lgkmcnt(12)
    v_mfma_f32_32x32x16_bf16 v[16:31], v[80:83], v[192:195], v[16:31]
    v_mfma_f32_32x32x16_bf16 v[32:47], v[84:87], v[192:195], v[32:47]
    s_add_u32 s86, s85, 40960
    buffer_load_dwordx4 a[32:35], v9, s[48:51], s86 offen offset:0 sc1
    ds_read_b64_tr_b16 v[80:81], v124 offset:16384
    ds_read_b64_tr_b16 v[82:83], v124 offset:17408
    ds_read_b64_tr_b16 v[84:85], v125 offset:16384
    ds_read_b64_tr_b16 v[86:87], v125 offset:17408
    s_waitcnt vmcnt(23)
    s_waitcnt lgkmcnt(12)
    v_mfma_f32_32x32x16_bf16 v[16:31], v[88:91], v[196:199], v[16:31]
    v_mfma_f32_32x32x16_bf16 v[32:47], v[92:95], v[196:199], v[32:47]
    buffer_load_dwordx4 a[36:39], v9, s[48:51], s86 offen offset:1024 sc1
    ds_read_b64_tr_b16 v[88:89], v124 offset:20480
    ds_read_b64_tr_b16 v[90:91], v124 offset:21504
    ds_read_b64_tr_b16 v[92:93], v125 offset:20480
    ds_read_b64_tr_b16 v[94:95], v125 offset:21504
    s_waitcnt vmcnt(23)
    s_waitcnt lgkmcnt(12)
    v_mfma_f32_32x32x16_bf16 v[16:31], v[96:99], v[200:203], v[16:31]
    v_mfma_f32_32x32x16_bf16 v[32:47], v[100:103], v[200:203], v[32:47]
    buffer_load_dwordx4 a[40:43], v9, s[48:51], s86 offen offset:2048 sc1
    ds_read_b64_tr_b16 v[96:97], v124 offset:24576
    ds_read_b64_tr_b16 v[98:99], v124 offset:25600
    ds_read_b64_tr_b16 v[100:101], v125 offset:24576
    ds_read_b64_tr_b16 v[102:103], v125 offset:25600
    s_waitcnt vmcnt(23)
    s_waitcnt lgkmcnt(12)
    v_mfma_f32_32x32x16_bf16 v[16:31], v[104:107], v[204:207], v[16:31]
    v_mfma_f32_32x32x16_bf16 v[32:47], v[108:111], v[204:207], v[32:47]
    buffer_load_dwordx4 a[44:47], v9, s[48:51], s86 offen offset:3072 sc1
    ds_read_b64_tr_b16 v[104:105], v124 offset:28672
    ds_read_b64_tr_b16 v[106:107], v124 offset:29696
    ds_read_b64_tr_b16 v[108:109], v125 offset:28672
    ds_read_b64_tr_b16 v[110:111], v125 offset:29696
    s_waitcnt vmcnt(23)
    s_waitcnt lgkmcnt(12)
    v_mfma_f32_32x32x16_bf16 v[16:31], v[80:83], v[208:211], v[16:31]
    v_mfma_f32_32x32x16_bf16 v[32:47], v[84:87], v[208:211], v[32:47]
    s_add_u32 s86, s85, 45056
    buffer_load_dwordx4 a[48:51], v9, s[48:51], s86 offen offset:0 sc1
    ds_read_b64_tr_b16 v[80:81], v124 offset:32768
    ds_read_b64_tr_b16 v[82:83], v124 offset:33792
    ds_read_b64_tr_b16 v[84:85], v125 offset:32768
    ds_read_b64_tr_b16 v[86:87], v125 offset:33792
    s_waitcnt vmcnt(23)
    s_waitcnt lgkmcnt(12)
    v_mfma_f32_32x32x16_bf16 v[16:31], v[88:91], v[212:215], v[16:31]
    v_mfma_f32_32x32x16_bf16 v[32:47], v[92:95], v[212:215], v[32:47]
    buffer_load_dwordx4 a[52:55], v9, s[48:51], s86 offen offset:1024 sc1
    ds_read_b64_tr_b16 v[88:89], v124 offset:36864
    ds_read_b64_tr_b16 v[90:91], v124 offset:37888
    ds_read_b64_tr_b16 v[92:93], v125 offset:36864
    ds_read_b64_tr_b16 v[94:95], v125 offset:37888
    s_waitcnt vmcnt(23)
    s_waitcnt lgkmcnt(12)
    v_mfma_f32_32x32x16_bf16 v[16:31], v[96:99], v[216:219], v[16:31]
    v_mfma_f32_32x32x16_bf16 v[32:47], v[100:103], v[216:219], v[32:47]
    buffer_load_dwordx4 a[56:59], v9, s[48:51], s86 offen offset:2048 sc1
    ds_read_b64_tr_b16 v[96:97], v124 offset:40960
    ds_read_b64_tr_b16 v[98:99], v124 offset:41984
    ds_read_b64_tr_b16 v[100:101], v125 offset:40960
    ds_read_b64_tr_b16 v[102:103], v125 offset:41984
    s_waitcnt vmcnt(23)
    s_waitcnt lgkmcnt(12)
    v_mfma_f32_32x32x16_bf16 v[16:31], v[104:107], v[220:223], v[16:31]
    v_mfma_f32_32x32x16_bf16 v[32:47], v[108:111], v[220:223], v[32:47]
    buffer_load_dwordx4 a[60:63], v9, s[48:51], s86 offen offset:3072 sc1
    ds_read_b64_tr_b16 v[104:105], v124 offset:45056
    ds_read_b64_tr_b16 v[106:107], v124 offset:46080
    ds_read_b64_tr_b16 v[108:109], v125 offset:45056
    ds_read_b64_tr_b16 v[110:111], v125 offset:46080
    s_waitcnt vmcnt(23)
    s_waitcnt lgkmcnt(12)
    v_mfma_f32_32x32x16_bf16 v[16:31], v[80:83], v[224:227], v[16:31]
    v_mfma_f32_32x32x16_bf16 v[32:47], v[84:87], v[224:227], v[32:47]
    s_add_u32 s86, s85, 49152
    buffer_load_dwordx4 a[64:67], v9, s[48:51], s86 offen offset:0 sc1
    ds_read_b64_tr_b16 v[80:81], v124 offset:49152
    ds_read_b64_tr_b16 v[82:83], v124 offset:50176
    ds_read_b64_tr_b16 v[84:85], v125 offset:49152
    ds_read_b64_tr_b16 v[86:87], v125 offset:50176
    s_waitcnt vmcnt(23)
    s_waitcnt lgkmcnt(12)
    v_mfma_f32_32x32x16_bf16 v[16:31], v[88:91], v[228:231], v[16:31]
    v_mfma_f32_32x32x16_bf16 v[32:47], v[92:95], v[228:231], v[32:47]
    buffer_load_dwordx4 a[68:71], v9, s[48:51], s86 offen offset:1024 sc1
    ds_read_b64_tr_b16 v[88:89], v124 offset:53248
    ds_read_b64_tr_b16 v[90:91], v124 offset:54272
    ds_read_b64_tr_b16 v[92:93], v125 offset:53248
    ds_read_b64_tr_b16 v[94:95], v125 offset:54272
    s_waitcnt vmcnt(23)
    s_waitcnt lgkmcnt(12)
    v_mfma_f32_32x32x16_bf16 v[16:31], v[96:99], v[232:235], v[16:31]
    v_mfma_f32_32x32x16_bf16 v[32:47], v[100:103], v[232:235], v[32:47]
    buffer_load_dwordx4 a[72:75], v9, s[48:51], s86 offen offset:2048 sc1
    ds_read_b64_tr_b16 v[96:97], v124 offset:57344
    ds_read_b64_tr_b16 v[98:99], v124 offset:58368
    ds_read_b64_tr_b16 v[100:101], v125 offset:57344
    ds_read_b64_tr_b16 v[102:103], v125 offset:58368
    s_waitcnt vmcnt(23)
    s_waitcnt lgkmcnt(12)
    v_mfma_f32_32x32x16_bf16 v[16:31], v[104:107], v[236:239], v[16:31]
    v_mfma_f32_32x32x16_bf16 v[32:47], v[108:111], v[236:239], v[32:47]
    buffer_load_dwordx4 a[76:79], v9, s[48:51], s86 offen offset:3072 sc1
    ds_read_b64_tr_b16 v[104:105], v124 offset:61440
    ds_read_b64_tr_b16 v[106:107], v124 offset:62464
    ds_read_b64_tr_b16 v[108:109], v125 offset:61440
    ds_read_b64_tr_b16 v[110:111], v125 offset:62464
    s_waitcnt vmcnt(23)
    s_waitcnt lgkmcnt(12)
    v_mfma_f32_32x32x16_bf16 v[16:31], v[80:83], v[240:243], v[16:31]
    v_mfma_f32_32x32x16_bf16 v[32:47], v[84:87], v[240:243], v[32:47]
    s_add_u32 s86, s85, 53248
    buffer_load_dwordx4 a[80:83], v9, s[48:51], s86 offen offset:0 sc1
    s_waitcnt vmcnt(23)
    s_waitcnt lgkmcnt(8)
    v_mfma_f32_32x32x16_bf16 v[16:31], v[88:91], v[244:247], v[16:31]
    v_mfma_f32_32x32x16_bf16 v[32:47], v[92:95], v[244:247], v[32:47]
    buffer_load_dwordx4 a[84:87], v9, s[48:51], s86 offen offset:1024 sc1
    s_waitcnt vmcnt(23)
    s_waitcnt lgkmcnt(4)
    v_mfma_f32_32x32x16_bf16 v[16:31], v[96:99], v[248:251], v[16:31]
    v_mfma_f32_32x32x16_bf16 v[32:47], v[100:103], v[248:251], v[32:47]
    buffer_load_dwordx4 a[88:91], v9, s[48:51], s86 offen offset:2048 sc1
    s_waitcnt vmcnt(23)
    s_waitcnt lgkmcnt(0)
    v_mfma_f32_32x32x16_bf16 v[16:31], v[104:107], v[252:255], v[16:31]
    v_mfma_f32_32x32x16_bf16 v[32:47], v[108:111], v[252:255], v[32:47]
    buffer_load_dwordx4 a[92:95], v9, s[48:51], s86 offen offset:3072 sc1
    v_lshlrev_b32 v6, 4, v3
    v_add_u32 v6, 135168, v6
    s_nop 0
    ds_read_b128 v[80:83], v6 offset:0
    ds_read_b128 v[84:87], v6 offset:32
    ds_read_b128 v[88:91], v6 offset:64
    ds_read_b128 v[92:95], v6 offset:96
    ds_read_b128 v[96:99], v6 offset:512
    ds_read_b128 v[100:103], v6 offset:544
    ds_read_b128 v[104:107], v6 offset:576
    ds_read_b128 v[108:111], v6 offset:608
    v_add_f32 v4, v64, v66
    v_add_f32 v5, v65, v67
    v_add_f32 v4, v4, v68
    v_add_f32 v5, v5, v69
    v_add_f32 v4, v4, v70
    v_add_f32 v5, v5, v71
    v_add_f32 v4, v4, v72
    v_add_f32 v5, v5, v73
    v_add_f32 v4, v4, v74
    v_add_f32 v5, v5, v75
    v_add_f32 v4, v4, v76
    v_add_f32 v5, v5, v77
    v_add_f32 v4, v4, v78
    v_add_f32 v5, v5, v79
    ds_read_b128 v[48:51], v6 offset:128
    ds_read_b128 v[52:55], v6 offset:160
    ds_read_b128 v[56:59], v6 offset:192
    ds_read_b128 v[60:63], v6 offset:224
    ds_read_b128 v[64:67], v6 offset:640
    ds_read_b128 v[68:71], v6 offset:672
    ds_read_b128 v[72:75], v6 offset:704
    ds_read_b128 v[76:79], v6 offset:736
    v_mov_b32 v6, v4
    v_mov_b32 v7, v5
    s_nop 1
    v_permlane32_swap_b32 v4, v6
    v_permlane32_swap_b32 v5, v7
    v_add_f32 v4, v4, v6
    v_add_f32 v5, v5, v7
    v_mul_f32 v6, 0x3b000000, v4
    v_mul_f32 v5, 0x3b000000, v5
    v_fma_f32 v5, -v6, v6, v5
    v_max_f32 v5, 0, v5
    v_add_f32 v5, 0x3727c5ac, v5
    v_rsq_f32 v4, v5
    s_nop 0
    v_mul_f32 v5, v6, v4
    v_sub_f32 v5, 0, v5
    v_lshlrev_b32 v6, 4, v3
    v_add_u32 v6, 135168, v6
    s_mov_b32 s78, 0xbdd2d3e8
    s_mov_b32 s79, 0xc0135761
    s_waitcnt lgkmcnt(8)
    v_pk_fma_f32 v[80:81], v[80:81], v[4:5], v[96:97] op_sel:[0,1,0] op_sel_hi:[1,1,1]
    v_pk_fma_f32 v[82:83], v[82:83], v[4:5], v[98:99] op_sel:[0,1,0] op_sel_hi:[1,1,1]
    v_pk_fma_f32 v[84:85], v[84:85], v[4:5], v[100:101] op_sel:[0,1,0] op_sel_hi:[1,1,1]
    v_pk_fma_f32 v[86:87], v[86:87], v[4:5], v[102:103] op_sel:[0,1,0] op_sel_hi:[1,1,1]
    v_pk_fma_f32 v[88:89], v[88:89], v[4:5], v[104:105] op_sel:[0,1,0] op_sel_hi:[1,1,1]
    v_pk_fma_f32 v[90:91], v[90:91], v[4:5], v[106:107] op_sel:[0,1,0] op_sel_hi:[1,1,1]
    v_pk_fma_f32 v[92:93], v[92:93], v[4:5], v[108:109] op_sel:[0,1,0] op_sel_hi:[1,1,1]
    v_pk_fma_f32 v[94:95], v[94:95], v[4:5], v[110:111] op_sel:[0,1,0] op_sel_hi:[1,1,1]
    v_pk_fma_f32 v[16:17], v[16:17], v[4:5], v[80:81] op_sel_hi:[1,0,1]
    v_pk_fma_f32 v[18:19], v[18:19], v[4:5], v[82:83] op_sel_hi:[1,0,1]
    v_pk_fma_f32 v[20:21], v[20:21], v[4:5], v[84:85] op_sel_hi:[1,0,1]
    v_pk_fma_f32 v[22:23], v[22:23], v[4:5], v[86:87] op_sel_hi:[1,0,1]
    v_pk_fma_f32 v[24:25], v[24:25], v[4:5], v[88:89] op_sel_hi:[1,0,1]
    v_pk_fma_f32 v[26:27], v[26:27], v[4:5], v[90:91] op_sel_hi:[1,0,1]
    v_pk_fma_f32 v[28:29], v[28:29], v[4:5], v[92:93] op_sel_hi:[1,0,1]
    v_pk_fma_f32 v[30:31], v[30:31], v[4:5], v[94:95] op_sel_hi:[1,0,1]
    v_pk_mul_f32 v[80:81], v[16:17], v[16:17]
    v_pk_mul_f32 v[82:83], v[18:19], v[18:19]
    v_pk_mul_f32 v[84:85], v[20:21], v[20:21]
    v_pk_mul_f32 v[86:87], v[22:23], v[22:23]
    v_pk_mul_f32 v[88:89], v[24:25], v[24:25]
    v_pk_mul_f32 v[90:91], v[26:27], v[26:27]
    v_pk_mul_f32 v[92:93], v[28:29], v[28:29]
    v_pk_mul_f32 v[94:95], v[30:31], v[30:31]
    v_pk_fma_f32 v[80:81], v[80:81], s[78:79], s[78:79] op_sel:[0,0,1] op_sel_hi:[1,0,1]
    v_pk_fma_f32 v[82:83], v[82:83], s[78:79], s[78:79] op_sel:[0,0,1] op_sel_hi:[1,0,1]
    v_pk_fma_f32 v[84:85], v[84:85], s[78:79], s[78:79] op_sel:[0,0,1] op_sel_hi:[1,0,1]
    v_pk_fma_f32 v[86:87], v[86:87], s[78:79], s[78:79] op_sel:[0,0,1] op_sel_hi:[1,0,1]
    v_pk_fma_f32 v[88:89], v[88:89], s[78:79], s[78:79] op_sel:[0,0,1] op_sel_hi:[1,0,1]
    v_pk_fma_f32 v[90:91], v[90:91], s[78:79], s[78:79] op_sel:[0,0,1] op_sel_hi:[1,0,1]
    v_pk_fma_f32 v[92:93], v[92:93], s[78:79], s[78:79] op_sel:[0,0,1] op_sel_hi:[1,0,1]
    v_pk_fma_f32 v[94:95], v[94:95], s[78:79], s[78:79] op_sel:[0,0,1] op_sel_hi:[1,0,1]
    v_pk_mul_f32 v[80:81], v[80:81], v[16:17]
    v_pk_mul_f32 v[82:83], v[82:83], v[18:19]
    v_pk_mul_f32 v[84:85], v[84:85], v[20:21]
    v_pk_mul_f32 v[86:87], v[86:87], v[22:23]
    v_pk_mul_f32 v[88:89], v[88:89], v[24:25]
    v_pk_mul_f32 v[90:91], v[90:91], v[26:27]
    v_pk_mul_f32 v[92:93], v[92:93], v[28:29]
    v_pk_mul_f32 v[94:95], v[94:95], v[30:31]
    v_exp_f32 v80, v80
    v_exp_f32 v81, v81
    v_exp_f32 v82, v82
    v_exp_f32 v83, v83
    v_exp_f32 v84, v84
    v_exp_f32 v85, v85
    v_exp_f32 v86, v86
    v_exp_f32 v87, v87
    v_exp_f32 v88, v88
    v_exp_f32 v89, v89
    v_exp_f32 v90, v90
    v_exp_f32 v91, v91
    v_exp_f32 v92, v92
    v_exp_f32 v93, v93
    v_exp_f32 v94, v94
    v_exp_f32 v95, v95
    v_pk_add_f32 v[80:81], v[80:81], 1.0 op_sel_hi:[1,0]
    v_pk_add_f32 v[82:83], v[82:83], 1.0 op_sel_hi:[1,0]
    v_pk_add_f32 v[84:85], v[84:85], 1.0 op_sel_hi:[1,0]
    v_pk_add_f32 v[86:87], v[86:87], 1.0 op_sel_hi:[1,0]
    v_pk_add_f32 v[88:89], v[88:89], 1.0 op_sel_hi:[1,0]
    v_pk_add_f32 v[90:91], v[90:91], 1.0 op_sel_hi:[1,0]
    v_pk_add_f32 v[92:93], v[92:93], 1.0 op_sel_hi:[1,0]
    v_pk_add_f32 v[94:95], v[94:95], 1.0 op_sel_hi:[1,0]
    v_rcp_f32 v80, v80
    v_rcp_f32 v81, v81
    v_rcp_f32 v82, v82
    v_rcp_f32 v83, v83
    v_rcp_f32 v84, v84
    v_rcp_f32 v85, v85
    v_rcp_f32 v86, v86
    v_rcp_f32 v87, v87
    v_rcp_f32 v88, v88
    v_rcp_f32 v89, v89
    v_rcp_f32 v90, v90
    v_rcp_f32 v91, v91
    v_rcp_f32 v92, v92
    v_rcp_f32 v93, v93
    v_rcp_f32 v94, v94
    v_rcp_f32 v95, v95
    v_pk_mul_f32 v[16:17], v[16:17], v[80:81]
    v_pk_mul_f32 v[18:19], v[18:19], v[82:83]
    v_pk_mul_f32 v[20:21], v[20:21], v[84:85]
    v_pk_mul_f32 v[22:23], v[22:23], v[86:87]
    v_pk_mul_f32 v[24:25], v[24:25], v[88:89]
    v_pk_mul_f32 v[26:27], v[26:27], v[90:91]
    v_pk_mul_f32 v[28:29], v[28:29], v[92:93]
    v_pk_mul_f32 v[30:31], v[30:31], v[94:95]
    s_waitcnt lgkmcnt(0)
    v_pk_fma_f32 v[48:49], v[48:49], v[4:5], v[64:65] op_sel:[0,1,0] op_sel_hi:[1,1,1]
    v_pk_fma_f32 v[50:51], v[50:51], v[4:5], v[66:67] op_sel:[0,1,0] op_sel_hi:[1,1,1]
    v_pk_fma_f32 v[52:53], v[52:53], v[4:5], v[68:69] op_sel:[0,1,0] op_sel_hi:[1,1,1]
    v_pk_fma_f32 v[54:55], v[54:55], v[4:5], v[70:71] op_sel:[0,1,0] op_sel_hi:[1,1,1]
    v_pk_fma_f32 v[56:57], v[56:57], v[4:5], v[72:73] op_sel:[0,1,0] op_sel_hi:[1,1,1]
    v_pk_fma_f32 v[58:59], v[58:59], v[4:5], v[74:75] op_sel:[0,1,0] op_sel_hi:[1,1,1]
    v_pk_fma_f32 v[60:61], v[60:61], v[4:5], v[76:77] op_sel:[0,1,0] op_sel_hi:[1,1,1]
    v_pk_fma_f32 v[62:63], v[62:63], v[4:5], v[78:79] op_sel:[0,1,0] op_sel_hi:[1,1,1]
    v_pk_fma_f32 v[32:33], v[32:33], v[4:5], v[48:49] op_sel_hi:[1,0,1]
    v_pk_fma_f32 v[34:35], v[34:35], v[4:5], v[50:51] op_sel_hi:[1,0,1]
    v_pk_fma_f32 v[36:37], v[36:37], v[4:5], v[52:53] op_sel_hi:[1,0,1]
    v_pk_fma_f32 v[38:39], v[38:39], v[4:5], v[54:55] op_sel_hi:[1,0,1]
    v_pk_fma_f32 v[40:41], v[40:41], v[4:5], v[56:57] op_sel_hi:[1,0,1]
    v_pk_fma_f32 v[42:43], v[42:43], v[4:5], v[58:59] op_sel_hi:[1,0,1]
    v_pk_fma_f32 v[44:45], v[44:45], v[4:5], v[60:61] op_sel_hi:[1,0,1]
    v_pk_fma_f32 v[46:47], v[46:47], v[4:5], v[62:63] op_sel_hi:[1,0,1]
    v_pk_mul_f32 v[48:49], v[32:33], v[32:33]
    v_pk_mul_f32 v[50:51], v[34:35], v[34:35]
    v_pk_mul_f32 v[52:53], v[36:37], v[36:37]
    v_pk_mul_f32 v[54:55], v[38:39], v[38:39]
    v_pk_mul_f32 v[56:57], v[40:41], v[40:41]
    v_pk_mul_f32 v[58:59], v[42:43], v[42:43]
    v_pk_mul_f32 v[60:61], v[44:45], v[44:45]
    v_pk_mul_f32 v[62:63], v[46:47], v[46:47]
    v_pk_fma_f32 v[48:49], v[48:49], s[78:79], s[78:79] op_sel:[0,0,1] op_sel_hi:[1,0,1]
    v_pk_fma_f32 v[50:51], v[50:51], s[78:79], s[78:79] op_sel:[0,0,1] op_sel_hi:[1,0,1]
    v_pk_fma_f32 v[52:53], v[52:53], s[78:79], s[78:79] op_sel:[0,0,1] op_sel_hi:[1,0,1]
    v_pk_fma_f32 v[54:55], v[54:55], s[78:79], s[78:79] op_sel:[0,0,1] op_sel_hi:[1,0,1]
    v_pk_fma_f32 v[56:57], v[56:57], s[78:79], s[78:79] op_sel:[0,0,1] op_sel_hi:[1,0,1]
    v_pk_fma_f32 v[58:59], v[58:59], s[78:79], s[78:79] op_sel:[0,0,1] op_sel_hi:[1,0,1]
    v_pk_fma_f32 v[60:61], v[60:61], s[78:79], s[78:79] op_sel:[0,0,1] op_sel_hi:[1,0,1]
    v_pk_fma_f32 v[62:63], v[62:63], s[78:79], s[78:79] op_sel:[0,0,1] op_sel_hi:[1,0,1]
    v_pk_mul_f32 v[48:49], v[48:49], v[32:33]
    v_pk_mul_f32 v[50:51], v[50:51], v[34:35]
    v_pk_mul_f32 v[52:53], v[52:53], v[36:37]
    v_pk_mul_f32 v[54:55], v[54:55], v[38:39]
    v_pk_mul_f32 v[56:57], v[56:57], v[40:41]
    v_pk_mul_f32 v[58:59], v[58:59], v[42:43]
    v_pk_mul_f32 v[60:61], v[60:61], v[44:45]
    v_pk_mul_f32 v[62:63], v[62:63], v[46:47]
    v_exp_f32 v48, v48
    v_exp_f32 v49, v49
    v_exp_f32 v50, v50
    v_exp_f32 v51, v51
    v_exp_f32 v52, v52
    v_exp_f32 v53, v53
    v_exp_f32 v54, v54
    v_exp_f32 v55, v55
    v_exp_f32 v56, v56
    v_exp_f32 v57, v57
    v_exp_f32 v58, v58
    v_exp_f32 v59, v59
    v_exp_f32 v60, v60
    v_exp_f32 v61, v61
    v_exp_f32 v62, v62
    v_exp_f32 v63, v63
    v_pk_add_f32 v[48:49], v[48:49], 1.0 op_sel_hi:[1,0]
    v_pk_add_f32 v[50:51], v[50:51], 1.0 op_sel_hi:[1,0]
    v_pk_add_f32 v[52:53], v[52:53], 1.0 op_sel_hi:[1,0]
    v_pk_add_f32 v[54:55], v[54:55], 1.0 op_sel_hi:[1,0]
    v_pk_add_f32 v[56:57], v[56:57], 1.0 op_sel_hi:[1,0]
    v_pk_add_f32 v[58:59], v[58:59], 1.0 op_sel_hi:[1,0]
    v_pk_add_f32 v[60:61], v[60:61], 1.0 op_sel_hi:[1,0]
    v_pk_add_f32 v[62:63], v[62:63], 1.0 op_sel_hi:[1,0]
    v_rcp_f32 v48, v48
    v_rcp_f32 v49, v49
    v_rcp_f32 v50, v50
    v_rcp_f32 v51, v51
    v_rcp_f32 v52, v52
    v_rcp_f32 v53, v53
    v_rcp_f32 v54, v54
    v_rcp_f32 v55, v55
    v_rcp_f32 v56, v56
    v_rcp_f32 v57, v57
    v_rcp_f32 v58, v58
    v_rcp_f32 v59, v59
    v_rcp_f32 v60, v60
    v_rcp_f32 v61, v61
    v_rcp_f32 v62, v62
    v_rcp_f32 v63, v63
    v_pk_mul_f32 v[32:33], v[32:33], v[48:49]
    v_pk_mul_f32 v[34:35], v[34:35], v[50:51]
    v_pk_mul_f32 v[36:37], v[36:37], v[52:53]
    v_pk_mul_f32 v[38:39], v[38:39], v[54:55]
    v_pk_mul_f32 v[40:41], v[40:41], v[56:57]
    v_pk_mul_f32 v[42:43], v[42:43], v[58:59]
    v_pk_mul_f32 v[44:45], v[44:45], v[60:61]
    v_pk_mul_f32 v[46:47], v[46:47], v[62:63]
    v_add_f32 v12, v16, v17
    v_mul_f32 v14, v16, v16
    v_fma_f32 v14, v17, v17, v14
    v_add_f32 v12, v12, v18
    v_fma_f32 v14, v18, v18, v14
    v_add_f32 v12, v12, v19
    v_fma_f32 v14, v19, v19, v14
    v_add_f32 v12, v12, v20
    v_fma_f32 v14, v20, v20, v14
    v_add_f32 v12, v12, v21
    v_fma_f32 v14, v21, v21, v14
    v_add_f32 v12, v12, v22
    v_fma_f32 v14, v22, v22, v14
    v_add_f32 v12, v12, v23
    v_fma_f32 v14, v23, v23, v14
    v_add_f32 v12, v12, v24
    v_fma_f32 v14, v24, v24, v14
    v_add_f32 v12, v12, v25
    v_fma_f32 v14, v25, v25, v14
    v_add_f32 v12, v12, v26
    v_fma_f32 v14, v26, v26, v14
    v_add_f32 v12, v12, v27
    v_fma_f32 v14, v27, v27, v14
    v_add_f32 v12, v12, v28
    v_fma_f32 v14, v28, v28, v14
    v_add_f32 v12, v12, v29
    v_fma_f32 v14, v29, v29, v14
    v_add_f32 v12, v12, v30
    v_fma_f32 v14, v30, v30, v14
    v_add_f32 v12, v12, v31
    v_fma_f32 v14, v31, v31, v14
    v_add_f32 v12, v12, v32
    v_fma_f32 v14, v32, v32, v14
    v_add_f32 v12, v12, v33
    v_fma_f32 v14, v33, v33, v14
    v_add_f32 v12, v12, v34
    v_fma_f32 v14, v34, v34, v14
    v_add_f32 v12, v12, v35
    v_fma_f32 v14, v35, v35, v14
    v_add_f32 v12, v12, v36
    v_fma_f32 v14, v36, v36, v14
    v_add_f32 v12, v12, v37
    v_fma_f32 v14, v37, v37, v14
    v_add_f32 v12, v12, v38
    v_fma_f32 v14, v38, v38, v14
    v_add_f32 v12, v12, v39
    v_fma_f32 v14, v39, v39, v14
    v_add_f32 v12, v12, v40
    v_fma_f32 v14, v40, v40, v14
    v_add_f32 v12, v12, v41
    v_fma_f32 v14, v41, v41, v14
    v_add_f32 v12, v12, v42
    v_fma_f32 v14, v42, v42, v14
    v_add_f32 v12, v12, v43
    v_fma_f32 v14, v43, v43, v14
    v_add_f32 v12, v12, v44
    v_fma_f32 v14, v44, v44, v14
    v_add_f32 v12, v12, v45
    v_fma_f32 v14, v45, v45, v14
    v_add_f32 v12, v12, v46
    v_fma_f32 v14, v46, v46, v14
    v_add_f32 v12, v12, v47
    v_fma_f32 v14, v47, v47, v14
    v_mov_b32 v13, v12
    v_mov_b32 v15, v14
    s_nop 1
    v_permlane32_swap_b32 v12, v13
    v_permlane32_swap_b32 v14, v15
    v_add_f32 v12, v12, v13
    v_add_f32 v14, v14, v15
    v_mov_b32 v13, s7
    v_mov_b32 v15, s7
    s_mul_i32 s76, s80, 14
    s_add_u32 s82, s76, s81
    s_lshl_b32 s82, s82, 11
    s_lshl_b32 s3, s6, 9
    s_add_u32 s82, s82, s3
    s_add_u32 s82, s82, 1048576
    v_lshlrev_b32 v7, 4, v2
    s_mov_b32 exec_hi, 0
    buffer_store_dwordx4 v[12:15], v7, s[48:51], s82 offen sc0 sc1
    s_mov_b32 exec_hi, -1
    ds_read_b64_tr_b16 v[80:81], v122 offset:0
    ds_read_b64_tr_b16 v[82:83], v122 offset:1024
    ds_read_b64_tr_b16 v[84:85], v123 offset:0
    ds_read_b64_tr_b16 v[86:87], v123 offset:1024
    ds_read_b64_tr_b16 v[88:89], v122 offset:4096
    ds_read_b64_tr_b16 v[90:91], v122 offset:5120
    ds_read_b64_tr_b16 v[92:93], v123 offset:4096
    ds_read_b64_tr_b16 v[94:95], v123 offset:5120
    ds_read_b64_tr_b16 v[96:97], v122 offset:8192
    ds_read_b64_tr_b16 v[98:99], v122 offset:9216
    ds_read_b64_tr_b16 v[100:101], v123 offset:8192
    ds_read_b64_tr_b16 v[102:103], v123 offset:9216
    ds_read_b64_tr_b16 v[104:105], v122 offset:12288
    ds_read_b64_tr_b16 v[106:107], v122 offset:13312
    ds_read_b64_tr_b16 v[108:109], v123 offset:12288
    ds_read_b64_tr_b16 v[110:111], v123 offset:13312
    s_waitcnt lgkmcnt(12)
    v_mfma_f32_32x32x16_bf16 v[48:63], v[80:83], v[128:131], 0
    v_mfma_f32_32x32x16_bf16 v[64:79], v[84:87], v[128:131], 0
    s_add_u32 s86, s85, 57344
    buffer_load_dwordx4 a[96:99], v9, s[48:51], s86 offen offset:0 sc1
    ds_read_b64_tr_b16 v[80:81], v122 offset:16384
    ds_read_b64_tr_b16 v[82:83], v122 offset:17408
    ds_read_b64_tr_b16 v[84:85], v123 offset:16384
    ds_read_b64_tr_b16 v[86:87], v123 offset:17408
    s_waitcnt lgkmcnt(12)
    v_mfma_f32_32x32x16_bf16 v[48:63], v[88:91], v[132:135], v[48:63]
    v_mfma_f32_32x32x16_bf16 v[64:79], v[92:95], v[132:135], v[64:79]
    buffer_load_dwordx4 a[100:103], v9, s[48:51], s86 offen offset:1024 sc1
    ds_read_b64_tr_b16 v[88:89], v122 offset:20480
    ds_read_b64_tr_b16 v[90:91], v122 offset:21504
    ds_read_b64_tr_b16 v[92:93], v123 offset:20480
    ds_read_b64_tr_b16 v[94:95], v123 offset:21504
    s_waitcnt lgkmcnt(12)
    v_mfma_f32_32x32x16_bf16 v[48:63], v[96:99], v[136:139], v[48:63]
    v_mfma_f32_32x32x16_bf16 v[64:79], v[100:103], v[136:139], v[64:79]
    buffer_load_dwordx4 a[104:107], v9, s[48:51], s86 offen offset:2048 sc1
    ds_read_b64_tr_b16 v[96:97], v122 offset:24576
    ds_read_b64_tr_b16 v[98:99], v122 offset:25600
    ds_read_b64_tr_b16 v[100:101], v123 offset:24576
    ds_read_b64_tr_b16 v[102:103], v123 offset:25600
    s_waitcnt lgkmcnt(12)
    v_mfma_f32_32x32x16_bf16 v[48:63], v[104:107], v[140:143], v[48:63]
    v_mfma_f32_32x32x16_bf16 v[64:79], v[108:111], v[140:143], v[64:79]
    buffer_load_dwordx4 a[108:111], v9, s[48:51], s86 offen offset:3072 sc1
    s_add_u32 s89, s85, 90112
    buffer_load_dwordx4 a[224:227], v9, s[48:51], s89 offen offset:0 sc1
    ds_read_b64_tr_b16 v[104:105], v122 offset:28672
    ds_read_b64_tr_b16 v[106:107], v122 offset:29696
    ds_read_b64_tr_b16 v[108:109], v123 offset:28672
    ds_read_b64_tr_b16 v[110:111], v123 offset:29696
    s_waitcnt lgkmcnt(12)
    v_mfma_f32_32x32x16_bf16 v[48:63], v[80:83], v[144:147], v[48:63]
    v_mfma_f32_32x32x16_bf16 v[64:79], v[84:87], v[144:147], v[64:79]
    s_add_u32 s86, s85, 61440
    buffer_load_dwordx4 a[112:115], v9, s[48:51], s86 offen offset:0 sc1
    ds_read_b64_tr_b16 v[80:81], v122 offset:32768
    ds_read_b64_tr_b16 v[82:83], v122 offset:33792
    ds_read_b64_tr_b16 v[84:85], v123 offset:32768
    ds_read_b64_tr_b16 v[86:87], v123 offset:33792
    s_waitcnt lgkmcnt(12)
    v_mfma_f32_32x32x16_bf16 v[48:63], v[88:91], v[148:151], v[48:63]
    v_mfma_f32_32x32x16_bf16 v[64:79], v[92:95], v[148:151], v[64:79]
    buffer_load_dwordx4 a[116:119], v9, s[48:51], s86 offen offset:1024 sc1
    ds_read_b64_tr_b16 v[88:89], v122 offset:36864
    ds_read_b64_tr_b16 v[90:91], v122 offset:37888
    ds_read_b64_tr_b16 v[92:93], v123 offset:36864
    ds_read_b64_tr_b16 v[94:95], v123 offset:37888
    s_waitcnt lgkmcnt(12)
    v_mfma_f32_32x32x16_bf16 v[48:63], v[96:99], v[152:155], v[48:63]
    v_mfma_f32_32x32x16_bf16 v[64:79], v[100:103], v[152:155], v[64:79]
    buffer_load_dwordx4 a[120:123], v9, s[48:51], s86 offen offset:2048 sc1
    ds_read_b64_tr_b16 v[96:97], v122 offset:40960
    ds_read_b64_tr_b16 v[98:99], v122 offset:41984
    ds_read_b64_tr_b16 v[100:101], v123 offset:40960
    ds_read_b64_tr_b16 v[102:103], v123 offset:41984
    s_waitcnt lgkmcnt(12)
    v_mfma_f32_32x32x16_bf16 v[48:63], v[104:107], v[156:159], v[48:63]
    v_mfma_f32_32x32x16_bf16 v[64:79], v[108:111], v[156:159], v[64:79]
    buffer_load_dwordx4 a[124:127], v9, s[48:51], s86 offen offset:3072 sc1
    buffer_load_dwordx4 a[228:231], v9, s[48:51], s89 offen offset:1024 sc1
    ds_read_b64_tr_b16 v[104:105], v122 offset:45056
    ds_read_b64_tr_b16 v[106:107], v122 offset:46080
    ds_read_b64_tr_b16 v[108:109], v123 offset:45056
    ds_read_b64_tr_b16 v[110:111], v123 offset:46080
    s_waitcnt lgkmcnt(12)
    v_mfma_f32_32x32x16_bf16 v[48:63], v[80:83], v[160:163], v[48:63]
    v_mfma_f32_32x32x16_bf16 v[64:79], v[84:87], v[160:163], v[64:79]
    s_add_u32 s86, s85, 65536
    buffer_load_dwordx4 a[128:131], v9, s[48:51], s86 offen offset:0 sc1
    ds_read_b64_tr_b16 v[80:81], v122 offset:49152
    ds_read_b64_tr_b16 v[82:83], v122 offset:50176
    ds_read_b64_tr_b16 v[84:85], v123 offset:49152
    ds_read_b64_tr_b16 v[86:87], v123 offset:50176
    s_waitcnt lgkmcnt(12)
    v_mfma_f32_32x32x16_bf16 v[48:63], v[88:91], v[164:167], v[48:63]
    v_mfma_f32_32x32x16_bf16 v[64:79], v[92:95], v[164:167], v[64:79]
    buffer_load_dwordx4 a[132:135], v9, s[48:51], s86 offen offset:1024 sc1
    ds_read_b64_tr_b16 v[88:89], v122 offset:53248
    ds_read_b64_tr_b16 v[90:91], v122 offset:54272
    ds_read_b64_tr_b16 v[92:93], v123 offset:53248
    ds_read_b64_tr_b16 v[94:95], v123 offset:54272
    s_waitcnt lgkmcnt(12)
    v_mfma_f32_32x32x16_bf16 v[48:63], v[96:99], v[168:171], v[48:63]
    v_mfma_f32_32x32x16_bf16 v[64:79], v[100:103], v[168:171], v[64:79]
    buffer_load_dwordx4 a[136:139], v9, s[48:51], s86 offen offset:2048 sc1
    ds_read_b64_tr_b16 v[96:97], v122 offset:57344
    ds_read_b64_tr_b16 v[98:99], v122 offset:58368
    ds_read_b64_tr_b16 v[100:101], v123 offset:57344
    ds_read_b64_tr_b16 v[102:103], v123 offset:58368
    s_waitcnt lgkmcnt(12)
    v_mfma_f32_32x32x16_bf16 v[48:63], v[104:107], v[172:175], v[48:63]
    v_mfma_f32_32x32x16_bf16 v[64:79], v[108:111], v[172:175], v[64:79]
    buffer_load_dwordx4 a[140:143], v9, s[48:51], s86 offen offset:3072 sc1
    buffer_load_dwordx4 a[232:235], v9, s[48:51], s89 offen offset:2048 sc1
    ds_read_b64_tr_b16 v[104:105], v122 offset:61440
    ds_read_b64_tr_b16 v[106:107], v122 offset:62464
    ds_read_b64_tr_b16 v[108:109], v123 offset:61440
    ds_read_b64_tr_b16 v[110:111], v123 offset:62464
    s_waitcnt lgkmcnt(12)
    v_mfma_f32_32x32x16_bf16 v[48:63], v[80:83], v[176:179], v[48:63]
    v_mfma_f32_32x32x16_bf16 v[64:79], v[84:87], v[176:179], v[64:79]
    s_add_u32 s86, s85, 69632
    buffer_load_dwordx4 a[144:147], v9, s[48:51], s86 offen offset:0 sc1
    ds_read_b64_tr_b16 v[80:81], v126 offset:0
    ds_read_b64_tr_b16 v[82:83], v126 offset:1024
    ds_read_b64_tr_b16 v[84:85], v127 offset:0
    ds_read_b64_tr_b16 v[86:87], v127 offset:1024
    s_waitcnt lgkmcnt(12)
    v_mfma_f32_32x32x16_bf16 v[48:63], v[88:91], v[180:183], v[48:63]
    v_mfma_f32_32x32x16_bf16 v[64:79], v[92:95], v[180:183], v[64:79]
    buffer_load_dwordx4 a[148:151], v9, s[48:51], s86 offen offset:1024 sc1
    ds_read_b64_tr_b16 v[88:89], v126 offset:4096
    ds_read_b64_tr_b16 v[90:91], v126 offset:5120
    ds_read_b64_tr_b16 v[92:93], v127 offset:4096
    ds_read_b64_tr_b16 v[94:95], v127 offset:5120
    s_waitcnt lgkmcnt(12)
    v_mfma_f32_32x32x16_bf16 v[48:63], v[96:99], v[184:187], v[48:63]
    v_mfma_f32_32x32x16_bf16 v[64:79], v[100:103], v[184:187], v[64:79]
    buffer_load_dwordx4 a[152:155], v9, s[48:51], s86 offen offset:2048 sc1
    ds_read_b64_tr_b16 v[96:97], v126 offset:8192
    ds_read_b64_tr_b16 v[98:99], v126 offset:9216
    ds_read_b64_tr_b16 v[100:101], v127 offset:8192
    ds_read_b64_tr_b16 v[102:103], v127 offset:9216
    s_waitcnt lgkmcnt(12)
    v_mfma_f32_32x32x16_bf16 v[48:63], v[104:107], v[188:191], v[48:63]
    v_mfma_f32_32x32x16_bf16 v[64:79], v[108:111], v[188:191], v[64:79]
    buffer_load_dwordx4 a[156:159], v9, s[48:51], s86 offen offset:3072 sc1
    buffer_load_dwordx4 a[236:239], v9, s[48:51], s89 offen offset:3072 sc1
    ds_read_b64_tr_b16 v[104:105], v126 offset:12288
    ds_read_b64_tr_b16 v[106:107], v126 offset:13312
    ds_read_b64_tr_b16 v[108:109], v127 offset:12288
    ds_read_b64_tr_b16 v[110:111], v127 offset:13312
    s_waitcnt lgkmcnt(12)
    v_mfma_f32_32x32x16_bf16 v[48:63], v[80:83], v[192:195], v[48:63]
    v_mfma_f32_32x32x16_bf16 v[64:79], v[84:87], v[192:195], v[64:79]
    s_add_u32 s86, s85, 73728
    buffer_load_dwordx4 a[160:163], v9, s[48:51], s86 offen offset:0 sc1
    ds_read_b64_tr_b16 v[80:81], v126 offset:16384
    ds_read_b64_tr_b16 v[82:83], v126 offset:17408
    ds_read_b64_tr_b16 v[84:85], v127 offset:16384
    ds_read_b64_tr_b16 v[86:87], v127 offset:17408
    s_waitcnt lgkmcnt(12)
    v_mfma_f32_32x32x16_bf16 v[48:63], v[88:91], v[196:199], v[48:63]
    v_mfma_f32_32x32x16_bf16 v[64:79], v[92:95], v[196:199], v[64:79]
    buffer_load_dwordx4 a[164:167], v9, s[48:51], s86 offen offset:1024 sc1
    ds_read_b64_tr_b16 v[88:89], v126 offset:20480
    ds_read_b64_tr_b16 v[90:91], v126 offset:21504
    ds_read_b64_tr_b16 v[92:93], v127 offset:20480
    ds_read_b64_tr_b16 v[94:95], v127 offset:21504
    s_waitcnt lgkmcnt(12)
    v_mfma_f32_32x32x16_bf16 v[48:63], v[96:99], v[200:203], v[48:63]
    v_mfma_f32_32x32x16_bf16 v[64:79], v[100:103], v[200:203], v[64:79]
    buffer_load_dwordx4 a[168:171], v9, s[48:51], s86 offen offset:2048 sc1
    ds_read_b64_tr_b16 v[96:97], v126 offset:24576
    ds_read_b64_tr_b16 v[98:99], v126 offset:25600
    ds_read_b64_tr_b16 v[100:101], v127 offset:24576
    ds_read_b64_tr_b16 v[102:103], v127 offset:25600
    s_waitcnt lgkmcnt(12)
    v_mfma_f32_32x32x16_bf16 v[48:63], v[104:107], v[204:207], v[48:63]
    v_mfma_f32_32x32x16_bf16 v[64:79], v[108:111], v[204:207], v[64:79]
    buffer_load_dwordx4 a[172:175], v9, s[48:51], s86 offen offset:3072 sc1
    s_add_u32 s89, s85, 94208
    buffer_load_dwordx4 a[240:243], v9, s[48:51], s89 offen offset:0 sc1
    ds_read_b64_tr_b16 v[104:105], v126 offset:28672
    ds_read_b64_tr_b16 v[106:107], v126 offset:29696
    ds_read_b64_tr_b16 v[108:109], v127 offset:28672
    ds_read_b64_tr_b16 v[110:111], v127 offset:29696
    s_waitcnt lgkmcnt(12)
    v_mfma_f32_32x32x16_bf16 v[48:63], v[80:83], v[208:211], v[48:63]
    v_mfma_f32_32x32x16_bf16 v[64:79], v[84:87], v[208:211], v[64:79]
    s_add_u32 s86, s85, 77824
    buffer_load_dwordx4 a[176:179], v9, s[48:51], s86 offen offset:0 sc1
    ds_read_b64_tr_b16 v[80:81], v126 offset:32768
    ds_read_b64_tr_b16 v[82:83], v126 offset:33792
    ds_read_b64_tr_b16 v[84:85], v127 offset:32768
    ds_read_b64_tr_b16 v[86:87], v127 offset:33792
    s_waitcnt lgkmcnt(12)
    v_mfma_f32_32x32x16_bf16 v[48:63], v[88:91], v[212:215], v[48:63]
    v_mfma_f32_32x32x16_bf16 v[64:79], v[92:95], v[212:215], v[64:79]
    buffer_load_dwordx4 a[180:183], v9, s[48:51], s86 offen offset:1024 sc1
    ds_read_b64_tr_b16 v[88:89], v126 offset:36864
    ds_read_b64_tr_b16 v[90:91], v126 offset:37888
    ds_read_b64_tr_b16 v[92:93], v127 offset:36864
    ds_read_b64_tr_b16 v[94:95], v127 offset:37888
    s_waitcnt lgkmcnt(12)
    v_mfma_f32_32x32x16_bf16 v[48:63], v[96:99], v[216:219], v[48:63]
    v_mfma_f32_32x32x16_bf16 v[64:79], v[100:103], v[216:219], v[64:79]
    buffer_load_dwordx4 a[184:187], v9, s[48:51], s86 offen offset:2048 sc1
    ds_read_b64_tr_b16 v[96:97], v126 offset:40960
    ds_read_b64_tr_b16 v[98:99], v126 offset:41984
    ds_read_b64_tr_b16 v[100:101], v127 offset:40960
    ds_read_b64_tr_b16 v[102:103], v127 offset:41984
    s_waitcnt lgkmcnt(12)
    v_mfma_f32_32x32x16_bf16 v[48:63], v[104:107], v[220:223], v[48:63]
    v_mfma_f32_32x32x16_bf16 v[64:79], v[108:111], v[220:223], v[64:79]
    buffer_load_dwordx4 a[188:191], v9, s[48:51], s86 offen offset:3072 sc1
    buffer_load_dwordx4 a[244:247], v9, s[48:51], s89 offen offset:1024 sc1
    ds_read_b64_tr_b16 v[104:105], v126 offset:45056
    ds_read_b64_tr_b16 v[106:107], v126 offset:46080
    ds_read_b64_tr_b16 v[108:109], v127 offset:45056
    ds_read_b64_tr_b16 v[110:111], v127 offset:46080
    s_waitcnt lgkmcnt(12)
    v_mfma_f32_32x32x16_bf16 v[48:63], v[80:83], v[224:227], v[48:63]
    v_mfma_f32_32x32x16_bf16 v[64:79], v[84:87], v[224:227], v[64:79]
    s_add_u32 s86, s85, 81920
    buffer_load_dwordx4 a[192:195], v9, s[48:51], s86 offen offset:0 sc1
    ds_read_b64_tr_b16 v[80:81], v126 offset:49152
    ds_read_b64_tr_b16 v[82:83], v126 offset:50176
    ds_read_b64_tr_b16 v[84:85], v127 offset:49152
    ds_read_b64_tr_b16 v[86:87], v127 offset:50176
    s_waitcnt lgkmcnt(12)
    v_mfma_f32_32x32x16_bf16 v[48:63], v[88:91], v[228:231], v[48:63]
    v_mfma_f32_32x32x16_bf16 v[64:79], v[92:95], v[228:231], v[64:79]
    buffer_load_dwordx4 a[196:199], v9, s[48:51], s86 offen offset:1024 sc1
    ds_read_b64_tr_b16 v[88:89], v126 offset:53248
    ds_read_b64_tr_b16 v[90:91], v126 offset:54272
    ds_read_b64_tr_b16 v[92:93], v127 offset:53248
    ds_read_b64_tr_b16 v[94:95], v127 offset:54272
    s_waitcnt lgkmcnt(12)
    v_mfma_f32_32x32x16_bf16 v[48:63], v[96:99], v[232:235], v[48:63]
    v_mfma_f32_32x32x16_bf16 v[64:79], v[100:103], v[232:235], v[64:79]
    buffer_load_dwordx4 a[200:203], v9, s[48:51], s86 offen offset:2048 sc1
    ds_read_b64_tr_b16 v[96:97], v126 offset:57344
    ds_read_b64_tr_b16 v[98:99], v126 offset:58368
    ds_read_b64_tr_b16 v[100:101], v127 offset:57344
    ds_read_b64_tr_b16 v[102:103], v127 offset:58368
    s_waitcnt lgkmcnt(12)
    v_mfma_f32_32x32x16_bf16 v[48:63], v[104:107], v[236:239], v[48:63]
    v_mfma_f32_32x32x16_bf16 v[64:79], v[108:111], v[236:239], v[64:79]
    buffer_load_dwordx4 a[204:207], v9, s[48:51], s86 offen offset:3072 sc1
    buffer_load_dwordx4 a[248:251], v9, s[48:51], s89 offen offset:2048 sc1
    ds_read_b64_tr_b16 v[104:105], v126 offset:61440
    ds_read_b64_tr_b16 v[106:107], v126 offset:62464
    ds_read_b64_tr_b16 v[108:109], v127 offset:61440
    ds_read_b64_tr_b16 v[110:111], v127 offset:62464
    s_waitcnt lgkmcnt(12)
    v_mfma_f32_32x32x16_bf16 v[48:63], v[80:83], v[240:243], v[48:63]
    v_mfma_f32_32x32x16_bf16 v[64:79], v[84:87], v[240:243], v[64:79]
    s_add_u32 s86, s85, 86016
    buffer_load_dwordx4 a[208:211], v9, s[48:51], s86 offen offset:0 sc1
    s_waitcnt lgkmcnt(8)
    v_mfma_f32_32x32x16_bf16 v[48:63], v[88:91], v[244:247], v[48:63]
    v_mfma_f32_32x32x16_bf16 v[64:79], v[92:95], v[244:247], v[64:79]
    buffer_load_dwordx4 a[212:215], v9, s[48:51], s86 offen offset:1024 sc1
    s_waitcnt lgkmcnt(4)
    v_mfma_f32_32x32x16_bf16 v[48:63], v[96:99], v[248:251], v[48:63]
    v_mfma_f32_32x32x16_bf16 v[64:79], v[100:103], v[248:251], v[64:79]
    buffer_load_dwordx4 a[216:219], v9, s[48:51], s86 offen offset:2048 sc1
    s_waitcnt lgkmcnt(0)
    v_mfma_f32_32x32x16_bf16 v[48:63], v[104:107], v[252:255], v[48:63]
    v_mfma_f32_32x32x16_bf16 v[64:79], v[108:111], v[252:255], v[64:79]
    buffer_load_dwordx4 a[220:223], v9, s[48:51], s86 offen offset:3072 sc1
    buffer_load_dwordx4 a[252:255], v9, s[48:51], s89 offen offset:3072 sc1
    ds_read_b128 v[80:83], v6 offset:256
    ds_read_b128 v[84:87], v6 offset:288
    ds_read_b128 v[88:91], v6 offset:320
    ds_read_b128 v[92:95], v6 offset:352
    ds_read_b128 v[96:99], v6 offset:768
    ds_read_b128 v[100:103], v6 offset:800
    ds_read_b128 v[104:107], v6 offset:832
    ds_read_b128 v[108:111], v6 offset:864
    ds_read_b128 v[128:131], v6 offset:384
    ds_read_b128 v[132:135], v6 offset:416
    ds_read_b128 v[136:139], v6 offset:448
    ds_read_b128 v[140:143], v6 offset:480
    ds_read_b128 v[144:147], v6 offset:896
    ds_read_b128 v[148:151], v6 offset:928
    ds_read_b128 v[152:155], v6 offset:960
    ds_read_b128 v[156:159], v6 offset:992
    s_waitcnt lgkmcnt(8)
    v_pk_fma_f32 v[80:81], v[80:81], v[4:5], v[96:97] op_sel:[0,1,0] op_sel_hi:[1,1,1]
    v_pk_fma_f32 v[82:83], v[82:83], v[4:5], v[98:99] op_sel:[0,1,0] op_sel_hi:[1,1,1]
    v_pk_fma_f32 v[84:85], v[84:85], v[4:5], v[100:101] op_sel:[0,1,0] op_sel_hi:[1,1,1]
    v_pk_fma_f32 v[86:87], v[86:87], v[4:5], v[102:103] op_sel:[0,1,0] op_sel_hi:[1,1,1]
    v_pk_fma_f32 v[88:89], v[88:89], v[4:5], v[104:105] op_sel:[0,1,0] op_sel_hi:[1,1,1]
    v_pk_fma_f32 v[90:91], v[90:91], v[4:5], v[106:107] op_sel:[0,1,0] op_sel_hi:[1,1,1]
    v_pk_fma_f32 v[92:93], v[92:93], v[4:5], v[108:109] op_sel:[0,1,0] op_sel_hi:[1,1,1]
    v_pk_fma_f32 v[94:95], v[94:95], v[4:5], v[110:111] op_sel:[0,1,0] op_sel_hi:[1,1,1]
    v_pk_fma_f32 v[48:49], v[48:49], v[4:5], v[80:81] op_sel_hi:[1,0,1]
    v_pk_fma_f32 v[50:51], v[50:51], v[4:5], v[82:83] op_sel_hi:[1,0,1]
    v_pk_fma_f32 v[52:53], v[52:53], v[4:5], v[84:85] op_sel_hi:[1,0,1]
    v_pk_fma_f32 v[54:55], v[54:55], v[4:5], v[86:87] op_sel_hi:[1,0,1]
    v_pk_fma_f32 v[56:57], v[56:57], v[4:5], v[88:89] op_sel_hi:[1,0,1]
    v_pk_fma_f32 v[58:59], v[58:59], v[4:5], v[90:91] op_sel_hi:[1,0,1]
    v_pk_fma_f32 v[60:61], v[60:61], v[4:5], v[92:93] op_sel_hi:[1,0,1]
    v_pk_fma_f32 v[62:63], v[62:63], v[4:5], v[94:95] op_sel_hi:[1,0,1]
    v_pk_mul_f32 v[80:81], v[48:49], v[48:49]
    v_pk_mul_f32 v[82:83], v[50:51], v[50:51]
    v_pk_mul_f32 v[84:85], v[52:53], v[52:53]
    v_pk_mul_f32 v[86:87], v[54:55], v[54:55]
    v_pk_mul_f32 v[88:89], v[56:57], v[56:57]
    v_pk_mul_f32 v[90:91], v[58:59], v[58:59]
    v_pk_mul_f32 v[92:93], v[60:61], v[60:61]
    v_pk_mul_f32 v[94:95], v[62:63], v[62:63]
    v_pk_fma_f32 v[80:81], v[80:81], s[78:79], s[78:79] op_sel:[0,0,1] op_sel_hi:[1,0,1]
    v_pk_fma_f32 v[82:83], v[82:83], s[78:79], s[78:79] op_sel:[0,0,1] op_sel_hi:[1,0,1]
    v_pk_fma_f32 v[84:85], v[84:85], s[78:79], s[78:79] op_sel:[0,0,1] op_sel_hi:[1,0,1]
    v_pk_fma_f32 v[86:87], v[86:87], s[78:79], s[78:79] op_sel:[0,0,1] op_sel_hi:[1,0,1]
    v_pk_fma_f32 v[88:89], v[88:89], s[78:79], s[78:79] op_sel:[0,0,1] op_sel_hi:[1,0,1]
    v_pk_fma_f32 v[90:91], v[90:91], s[78:79], s[78:79] op_sel:[0,0,1] op_sel_hi:[1,0,1]
    v_pk_fma_f32 v[92:93], v[92:93], s[78:79], s[78:79] op_sel:[0,0,1] op_sel_hi:[1,0,1]
    v_pk_fma_f32 v[94:95], v[94:95], s[78:79], s[78:79] op_sel:[0,0,1] op_sel_hi:[1,0,1]
    v_pk_mul_f32 v[80:81], v[80:81], v[48:49]
    v_pk_mul_f32 v[82:83], v[82:83], v[50:51]
    v_pk_mul_f32 v[84:85], v[84:85], v[52:53]
    v_pk_mul_f32 v[86:87], v[86:87], v[54:55]
    v_pk_mul_f32 v[88:89], v[88:89], v[56:57]
    v_pk_mul_f32 v[90:91], v[90:91], v[58:59]
    v_pk_mul_f32 v[92:93], v[92:93], v[60:61]
    v_pk_mul_f32 v[94:95], v[94:95], v[62:63]
    v_exp_f32 v80, v80
    v_exp_f32 v81, v81
    v_exp_f32 v82, v82
    v_exp_f32 v83, v83
    v_exp_f32 v84, v84
    v_exp_f32 v85, v85
    v_exp_f32 v86, v86
    v_exp_f32 v87, v87
    v_exp_f32 v88, v88
    v_exp_f32 v89, v89
    v_exp_f32 v90, v90
    v_exp_f32 v91, v91
    v_exp_f32 v92, v92
    v_exp_f32 v93, v93
    v_exp_f32 v94, v94
    v_exp_f32 v95, v95
    v_pk_add_f32 v[80:81], v[80:81], 1.0 op_sel_hi:[1,0]
    v_pk_add_f32 v[82:83], v[82:83], 1.0 op_sel_hi:[1,0]
    v_pk_add_f32 v[84:85], v[84:85], 1.0 op_sel_hi:[1,0]
    v_pk_add_f32 v[86:87], v[86:87], 1.0 op_sel_hi:[1,0]
    v_pk_add_f32 v[88:89], v[88:89], 1.0 op_sel_hi:[1,0]
    v_pk_add_f32 v[90:91], v[90:91], 1.0 op_sel_hi:[1,0]
    v_pk_add_f32 v[92:93], v[92:93], 1.0 op_sel_hi:[1,0]
    v_pk_add_f32 v[94:95], v[94:95], 1.0 op_sel_hi:[1,0]
    v_rcp_f32 v80, v80
    v_rcp_f32 v81, v81
    v_rcp_f32 v82, v82
    v_rcp_f32 v83, v83
    v_rcp_f32 v84, v84
    v_rcp_f32 v85, v85
    v_rcp_f32 v86, v86
    v_rcp_f32 v87, v87
    v_rcp_f32 v88, v88
    v_rcp_f32 v89, v89
    v_rcp_f32 v90, v90
    v_rcp_f32 v91, v91
    v_rcp_f32 v92, v92
    v_rcp_f32 v93, v93
    v_rcp_f32 v94, v94
    v_rcp_f32 v95, v95
    v_pk_mul_f32 v[48:49], v[48:49], v[80:81]
    v_pk_mul_f32 v[50:51], v[50:51], v[82:83]
    v_pk_mul_f32 v[52:53], v[52:53], v[84:85]
    v_pk_mul_f32 v[54:55], v[54:55], v[86:87]
    v_pk_mul_f32 v[56:57], v[56:57], v[88:89]
    v_pk_mul_f32 v[58:59], v[58:59], v[90:91]
    v_pk_mul_f32 v[60:61], v[60:61], v[92:93]
    v_pk_mul_f32 v[62:63], v[62:63], v[94:95]
    s_waitcnt lgkmcnt(0)
    v_pk_fma_f32 v[128:129], v[128:129], v[4:5], v[144:145] op_sel:[0,1,0] op_sel_hi:[1,1,1]
    v_pk_fma_f32 v[130:131], v[130:131], v[4:5], v[146:147] op_sel:[0,1,0] op_sel_hi:[1,1,1]
    v_pk_fma_f32 v[132:133], v[132:133], v[4:5], v[148:149] op_sel:[0,1,0] op_sel_hi:[1,1,1]
    v_pk_fma_f32 v[134:135], v[134:135], v[4:5], v[150:151] op_sel:[0,1,0] op_sel_hi:[1,1,1]
    v_pk_fma_f32 v[136:137], v[136:137], v[4:5], v[152:153] op_sel:[0,1,0] op_sel_hi:[1,1,1]
    v_pk_fma_f32 v[138:139], v[138:139], v[4:5], v[154:155] op_sel:[0,1,0] op_sel_hi:[1,1,1]
    v_pk_fma_f32 v[140:141], v[140:141], v[4:5], v[156:157] op_sel:[0,1,0] op_sel_hi:[1,1,1]
    v_pk_fma_f32 v[142:143], v[142:143], v[4:5], v[158:159] op_sel:[0,1,0] op_sel_hi:[1,1,1]
    v_pk_fma_f32 v[64:65], v[64:65], v[4:5], v[128:129] op_sel_hi:[1,0,1]
    v_pk_fma_f32 v[66:67], v[66:67], v[4:5], v[130:131] op_sel_hi:[1,0,1]
    v_pk_fma_f32 v[68:69], v[68:69], v[4:5], v[132:133] op_sel_hi:[1,0,1]
    v_pk_fma_f32 v[70:71], v[70:71], v[4:5], v[134:135] op_sel_hi:[1,0,1]
    v_pk_fma_f32 v[72:73], v[72:73], v[4:5], v[136:137] op_sel_hi:[1,0,1]
    v_pk_fma_f32 v[74:75], v[74:75], v[4:5], v[138:139] op_sel_hi:[1,0,1]
    v_pk_fma_f32 v[76:77], v[76:77], v[4:5], v[140:141] op_sel_hi:[1,0,1]
    v_pk_fma_f32 v[78:79], v[78:79], v[4:5], v[142:143] op_sel_hi:[1,0,1]
    v_pk_mul_f32 v[128:129], v[64:65], v[64:65]
    v_pk_mul_f32 v[130:131], v[66:67], v[66:67]
    v_pk_mul_f32 v[132:133], v[68:69], v[68:69]
    v_pk_mul_f32 v[134:135], v[70:71], v[70:71]
    v_pk_mul_f32 v[136:137], v[72:73], v[72:73]
    v_pk_mul_f32 v[138:139], v[74:75], v[74:75]
    v_pk_mul_f32 v[140:141], v[76:77], v[76:77]
    v_pk_mul_f32 v[142:143], v[78:79], v[78:79]
    v_pk_fma_f32 v[128:129], v[128:129], s[78:79], s[78:79] op_sel:[0,0,1] op_sel_hi:[1,0,1]
    v_pk_fma_f32 v[130:131], v[130:131], s[78:79], s[78:79] op_sel:[0,0,1] op_sel_hi:[1,0,1]
    v_pk_fma_f32 v[132:133], v[132:133], s[78:79], s[78:79] op_sel:[0,0,1] op_sel_hi:[1,0,1]
    v_pk_fma_f32 v[134:135], v[134:135], s[78:79], s[78:79] op_sel:[0,0,1] op_sel_hi:[1,0,1]
    v_pk_fma_f32 v[136:137], v[136:137], s[78:79], s[78:79] op_sel:[0,0,1] op_sel_hi:[1,0,1]
    v_pk_fma_f32 v[138:139], v[138:139], s[78:79], s[78:79] op_sel:[0,0,1] op_sel_hi:[1,0,1]
    v_pk_fma_f32 v[140:141], v[140:141], s[78:79], s[78:79] op_sel:[0,0,1] op_sel_hi:[1,0,1]
    v_pk_fma_f32 v[142:143], v[142:143], s[78:79], s[78:79] op_sel:[0,0,1] op_sel_hi:[1,0,1]
    v_pk_mul_f32 v[128:129], v[128:129], v[64:65]
    v_pk_mul_f32 v[130:131], v[130:131], v[66:67]
    v_pk_mul_f32 v[132:133], v[132:133], v[68:69]
    v_pk_mul_f32 v[134:135], v[134:135], v[70:71]
    v_pk_mul_f32 v[136:137], v[136:137], v[72:73]
    v_pk_mul_f32 v[138:139], v[138:139], v[74:75]
    v_pk_mul_f32 v[140:141], v[140:141], v[76:77]
    v_pk_mul_f32 v[142:143], v[142:143], v[78:79]
    v_exp_f32 v128, v128
    v_exp_f32 v129, v129
    v_exp_f32 v130, v130
    v_exp_f32 v131, v131
    v_exp_f32 v132, v132
    v_exp_f32 v133, v133
    v_exp_f32 v134, v134
    v_exp_f32 v135, v135
    v_exp_f32 v136, v136
    v_exp_f32 v137, v137
    v_exp_f32 v138, v138
    v_exp_f32 v139, v139
    v_exp_f32 v140, v140
    v_exp_f32 v141, v141
    v_exp_f32 v142, v142
    v_exp_f32 v143, v143
    v_pk_add_f32 v[128:129], v[128:129], 1.0 op_sel_hi:[1,0]
    v_pk_add_f32 v[130:131], v[130:131], 1.0 op_sel_hi:[1,0]
    v_pk_add_f32 v[132:133], v[132:133], 1.0 op_sel_hi:[1,0]
    v_pk_add_f32 v[134:135], v[134:135], 1.0 op_sel_hi:[1,0]
    v_pk_add_f32 v[136:137], v[136:137], 1.0 op_sel_hi:[1,0]
    v_pk_add_f32 v[138:139], v[138:139], 1.0 op_sel_hi:[1,0]
    v_pk_add_f32 v[140:141], v[140:141], 1.0 op_sel_hi:[1,0]
    v_pk_add_f32 v[142:143], v[142:143], 1.0 op_sel_hi:[1,0]
    v_rcp_f32 v128, v128
    v_rcp_f32 v129, v129
    v_rcp_f32 v130, v130
    v_rcp_f32 v131, v131
    v_rcp_f32 v132, v132
    v_rcp_f32 v133, v133
    v_rcp_f32 v134, v134
    v_rcp_f32 v135, v135
    v_rcp_f32 v136, v136
    v_rcp_f32 v137, v137
    v_rcp_f32 v138, v138
    v_rcp_f32 v139, v139
    v_rcp_f32 v140, v140
    v_rcp_f32 v141, v141
    v_rcp_f32 v142, v142
    v_rcp_f32 v143, v143
    v_pk_mul_f32 v[64:65], v[64:65], v[128:129]
    v_pk_mul_f32 v[66:67], v[66:67], v[130:131]
    v_pk_mul_f32 v[68:69], v[68:69], v[132:133]
    v_pk_mul_f32 v[70:71], v[70:71], v[134:135]
    v_pk_mul_f32 v[72:73], v[72:73], v[136:137]
    v_pk_mul_f32 v[74:75], v[74:75], v[138:139]
    v_pk_mul_f32 v[76:77], v[76:77], v[140:141]
    v_pk_mul_f32 v[78:79], v[78:79], v[142:143]
    v_cvt_pk_bf16_f32 v112, v48, v49
    v_cvt_pk_bf16_f32 v113, v50, v51
    v_cvt_pk_bf16_f32 v114, v52, v53
    v_cvt_pk_bf16_f32 v115, v54, v55
    v_cvt_pk_bf16_f32 v116, v56, v57
    v_cvt_pk_bf16_f32 v117, v58, v59
    v_cvt_pk_bf16_f32 v118, v60, v61
    v_cvt_pk_bf16_f32 v119, v62, v63
    v_cvt_pk_bf16_f32 v120, v64, v65
    v_cvt_pk_bf16_f32 v121, v66, v67
    v_cvt_pk_bf16_f32 v122, v68, v69
    v_cvt_pk_bf16_f32 v123, v70, v71
    v_cvt_pk_bf16_f32 v124, v72, v73
    v_cvt_pk_bf16_f32 v125, v74, v75
    v_cvt_pk_bf16_f32 v126, v76, v77
    v_cvt_pk_bf16_f32 v127, v78, v79
    s_lshl_b32 s76, s76, 11
    s_lshl_b32 s3, s6, 9
    s_add_u32 s76, s76, s3
    s_add_u32 s76, s76, 1048576
    v_mul_u32_u24 v8, 14336, v3
    v_add_u32 v8, v8, v7
    s_mov_b32 s52, 262144
S2_37:
    s_add_u32 s3, s76, 0
    buffer_load_dwordx4 v[48:51], v8, s[48:51], s3 offen sc0 sc1
    s_add_u32 s3, s76, 2048
    buffer_load_dwordx4 v[52:55], v8, s[48:51], s3 offen sc0 sc1
    s_add_u32 s3, s76, 4096
    buffer_load_dwordx4 v[56:59], v8, s[48:51], s3 offen sc0 sc1
    s_add_u32 s3, s76, 6144
    buffer_load_dwordx4 v[60:63], v8, s[48:51], s3 offen sc0 sc1
    s_add_u32 s3, s76, 8192
    buffer_load_dwordx4 v[64:67], v8, s[48:51], s3 offen sc0 sc1
    s_add_u32 s3, s76, 10240
    buffer_load_dwordx4 v[68:71], v8, s[48:51], s3 offen sc0 sc1
    s_add_u32 s3, s76, 12288
    buffer_load_dwordx4 v[72:75], v8, s[48:51], s3 offen sc0 sc1
    s_waitcnt vmcnt(0)
    v_mov_b32 v9, 0
    v_xor_b32 v10, s7, v49
    v_xor_b32 v11, s7, v51
    v_or3_b32 v9, v9, v10, v11
    v_xor_b32 v10, s7, v53
    v_xor_b32 v11, s7, v55
    v_or3_b32 v9, v9, v10, v11
    v_xor_b32 v10, s7, v57
    v_xor_b32 v11, s7, v59
    v_or3_b32 v9, v9, v10, v11
    v_xor_b32 v10, s7, v61
    v_xor_b32 v11, s7, v63
    v_or3_b32 v9, v9, v10, v11
    v_xor_b32 v10, s7, v65
    v_xor_b32 v11, s7, v67
    v_or3_b32 v9, v9, v10, v11
    v_xor_b32 v10, s7, v69
    v_xor_b32 v11, s7, v71
    v_or3_b32 v9, v9, v10, v11
    v_xor_b32 v10, s7, v73
    v_xor_b32 v11, s7, v75
    v_or3_b32 v9, v9, v10, v11
    v_cmp_ne_u32 vcc, 0, v9
    s_cbranch_vccz S2_38
    s_sub_u32 s52, s52, 1
    s_cmp_lg_u32 s52, 0
    s_cbranch_scc1 S2_37
S2_38:
    v_mov_b32 v4, v48
    v_mov_b32 v5, v50
    v_add_f32 v4, v4, v52
    v_add_f32 v5, v5, v54
    v_add_f32 v4, v4, v56
    v_add_f32 v5, v5, v58
    v_add_f32 v4, v4, v60
    v_add_f32 v5, v5, v62
    v_add_f32 v4, v4, v64
    v_add_f32 v5, v5, v66
    v_add_f32 v4, v4, v68
    v_add_f32 v5, v5, v70
    v_add_f32 v4, v4, v72
    v_add_f32 v5, v5, v74
    v_mov_b32 v6, v4
    v_mov_b32 v7, v5
    s_nop 1
    v_permlane32_swap_b32 v4, v6
    v_permlane32_swap_b32 v5, v7
    v_add_f32 v4, v4, v6
    v_add_f32 v5, v5, v7
    v_mul_f32 v6, 0x3a924925, v4
    v_mul_f32 v5, 0x3a924925, v5
    v_fma_f32 v5, -v6, v6, v5
    v_max_f32 v5, 0, v5
    v_add_f32 v5, 0x3727c5ac, v5
    v_rsq_f32 v4, v5
    s_nop 0
    v_mul_f32 v5, v6, v4
    v_sub_f32 v5, 0, v5
    v_pk_fma_f32 v[16:17], v[16:17], v[4:5], v[4:5] op_sel:[0,0,1] op_sel_hi:[1,0,1]
    v_pk_fma_f32 v[18:19], v[18:19], v[4:5], v[4:5] op_sel:[0,0,1] op_sel_hi:[1,0,1]
    v_pk_fma_f32 v[20:21], v[20:21], v[4:5], v[4:5] op_sel:[0,0,1] op_sel_hi:[1,0,1]
    v_pk_fma_f32 v[22:23], v[22:23], v[4:5], v[4:5] op_sel:[0,0,1] op_sel_hi:[1,0,1]
    v_pk_fma_f32 v[24:25], v[24:25], v[4:5], v[4:5] op_sel:[0,0,1] op_sel_hi:[1,0,1]
    v_pk_fma_f32 v[26:27], v[26:27], v[4:5], v[4:5] op_sel:[0,0,1] op_sel_hi:[1,0,1]
    v_pk_fma_f32 v[28:29], v[28:29], v[4:5], v[4:5] op_sel:[0,0,1] op_sel_hi:[1,0,1]
    v_pk_fma_f32 v[30:31], v[30:31], v[4:5], v[4:5] op_sel:[0,0,1] op_sel_hi:[1,0,1]
    v_pk_fma_f32 v[32:33], v[32:33], v[4:5], v[4:5] op_sel:[0,0,1] op_sel_hi:[1,0,1]
    v_pk_fma_f32 v[34:35], v[34:35], v[4:5], v[4:5] op_sel:[0,0,1] op_sel_hi:[1,0,1]
    v_pk_fma_f32 v[36:37], v[36:37], v[4:5], v[4:5] op_sel:[0,0,1] op_sel_hi:[1,0,1]
    v_pk_fma_f32 v[38:39], v[38:39], v[4:5], v[4:5] op_sel:[0,0,1] op_sel_hi:[1,0,1]
    v_pk_fma_f32 v[40:41], v[40:41], v[4:5], v[4:5] op_sel:[0,0,1] op_sel_hi:[1,0,1]
    v_pk_fma_f32 v[42:43], v[42:43], v[4:5], v[4:5] op_sel:[0,0,1] op_sel_hi:[1,0,1]
    v_pk_fma_f32 v[44:45], v[44:45], v[4:5], v[4:5] op_sel:[0,0,1] op_sel_hi:[1,0,1]
    v_pk_fma_f32 v[46:47], v[46:47], v[4:5], v[4:5] op_sel:[0,0,1] op_sel_hi:[1,0,1]
    s_lshl_b32 s3, s6, 12
    s_add_u32 s3, s3, 147456
    v_lshlrev_b32 v8, 7, v2
    v_lshl_add_u32 v8, v3, 4, v8
    v_add_u32 v8, s3, v8
    v_bfe_u32 v9, v2, 1, 1
    v_lshl_add_u32 v10, v9, 6, v8
    v_xor_b32 v9, 1, v9
    v_lshl_add_u32 v11, v9, 6, v8
    v_mov_b32 v6, v10
    v_mov_b32 v7, v11
    v_bfe_u32 v10, v1, 2, 2
    v_lshl_add_u32 v11, v3, 3, v10
    v_lshlrev_b32 v11, 7, v11
    v_bfe_u32 v12, v1, 4, 1
    v_lshl_add_u32 v11, v12, 5, v11
    v_and_b32 v12, 3, v1
    v_lshl_add_u32 v11, v12, 3, v11
    v_add_u32 v11, s3, v11
    v_lshrrev_b32 v10, 1, v10
    v_lshl_add_u32 v14, v10, 6, v11
    v_xor_b32 v10, 1, v10
    v_lshl_add_u32 v15, v10, 6, v11
    v_lshlrev_b32 v12, 4, v1
    v_cvt_pk_bf16_f32 v48, v16, v17
    v_cvt_pk_bf16_f32 v49, v18, v19
    v_cvt_pk_bf16_f32 v50, v20, v21
    v_cvt_pk_bf16_f32 v51, v22, v23
    s_nop 0
    v_permlane32_swap_b32 v48, v50
    v_permlane32_swap_b32 v49, v51
    ds_write_b128 v6, v[48:51] offset:0
    v_cvt_pk_bf16_f32 v52, v24, v25
    v_cvt_pk_bf16_f32 v53, v26, v27
    v_cvt_pk_bf16_f32 v54, v28, v29
    v_cvt_pk_bf16_f32 v55, v30, v31
    s_nop 0
    v_permlane32_swap_b32 v52, v54
    v_permlane32_swap_b32 v53, v55
    ds_write_b128 v6, v[52:55] offset:32
    v_cvt_pk_bf16_f32 v56, v32, v33
    v_cvt_pk_bf16_f32 v57, v34, v35
    v_cvt_pk_bf16_f32 v58, v36, v37
    v_cvt_pk_bf16_f32 v59, v38, v39
    s_nop 0
    v_permlane32_swap_b32 v56, v58
    v_permlane32_swap_b32 v57, v59
    ds_write_b128 v7, v[56:59] offset:0
    v_cvt_pk_bf16_f32 v60, v40, v41
    v_cvt_pk_bf16_f32 v61, v42, v43
    v_cvt_pk_bf16_f32 v62, v44, v45
    v_cvt_pk_bf16_f32 v63, v46, v47
    s_nop 0
    v_permlane32_swap_b32 v60, v62
    v_permlane32_swap_b32 v61, v63
    ds_write_b128 v7, v[60:63] offset:32
    s_waitcnt lgkmcnt(0)
    ds_read_b64_tr_b16 v[64:65], v14 offset:0
    ds_read_b64_tr_b16 v[66:67], v14 offset:512
    ds_read_b64_tr_b16 v[68:69], v15 offset:0
    ds_read_b64_tr_b16 v[70:71], v15 offset:512
    ds_read_b64_tr_b16 v[72:73], v14 offset:2048
    ds_read_b64_tr_b16 v[74:75], v14 offset:2560
    ds_read_b64_tr_b16 v[76:77], v15 offset:2048
    ds_read_b64_tr_b16 v[78:79], v15 offset:2560
    s_lshl_b32 s76, s81, 18
    s_lshl_b32 s3, s80, 14
    s_add_u32 s76, s76, s3
    s_lshl_b32 s3, s6, 12
    s_add_u32 s76, s76, s3
    s_add_u32 s76, s76, 12582912
    s_waitcnt lgkmcnt(0)
    buffer_store_dwordx4 v[64:67], v12, s[48:51], s76 offen offset:0 sc1
    buffer_store_dwordx4 v[68:71], v12, s[48:51], s76 offen offset:1024 sc1
    buffer_store_dwordx4 v[72:75], v12, s[48:51], s76 offen offset:2048 sc1
    buffer_store_dwordx4 v[76:79], v12, s[48:51], s76 offen offset:3072 sc1
    s_waitcnt vmcnt(0)
    s_barrier
    s_cmp_lg_u32 s6, 0
    s_cbranch_scc1 SG_39
    v_lshrrev_b32 v5, 2, v1
    v_and_b32 v4, 3, v1
    v_lshl_add_u32 v5, v4, 3, v5
    s_and_b32 s3, s4, 4
    s_lshr_b32 s52, s5, 2
    s_lshl_b32 s52, s52, 5
    s_add_u32 s3, s3, s52
    v_add_u32 v5, s3, v5
    s_lshl_b32 s3, s80, 2
    v_lshl_add_u32 v5, v5, 7, s3
    s_mov_b32 s3, 196608
    v_mov_b32 v4, s7
    s_mov_b32 exec_lo, 0xffff
    s_mov_b32 exec_hi, 0x0
    buffer_store_dword v4, v5, s[48:51], s3 offen sc0 sc1
    s_mov_b64 exec, -1
SG_39:
    s_lshl_b32 s76, s80, 2
    s_add_u32 s76, s76, s6
    s_lshl_b32 s82, s76, 17
    s_add_u32 s82, s82, 20971520
    v_lshlrev_b32 v13, 4, v1
    s_lshl_b32 s3, s76, 6
    v_lshlrev_b32 v14, 1, v2
    buffer_load_ushort v15, v14, s[28:31], s3 offen
    s_add_u32 s86, s82, 0
    buffer_load_dwordx4 v[128:131], v13, s[48:51], s86 offen offset:0 sc1
    buffer_load_dwordx4 v[132:135], v13, s[48:51], s86 offen offset:1024 sc1
    buffer_load_dwordx4 v[136:139], v13, s[48:51], s86 offen offset:2048 sc1
    buffer_load_dwordx4 v[140:143], v13, s[48:51], s86 offen offset:3072 sc1
    s_add_u32 s86, s82, 4096
    buffer_load_dwordx4 v[144:147], v13, s[48:51], s86 offen offset:0 sc1
    buffer_load_dwordx4 v[148:151], v13, s[48:51], s86 offen offset:1024 sc1
    buffer_load_dwordx4 v[152:155], v13, s[48:51], s86 offen offset:2048 sc1
    buffer_load_dwordx4 v[156:159], v13, s[48:51], s86 offen offset:3072 sc1
    s_add_u32 s86, s82, 8192
    buffer_load_dwordx4 v[160:163], v13, s[48:51], s86 offen offset:0 sc1
    buffer_load_dwordx4 v[164:167], v13, s[48:51], s86 offen offset:1024 sc1
    buffer_load_dwordx4 v[168:171], v13, s[48:51], s86 offen offset:2048 sc1
    buffer_load_dwordx4 v[172:175], v13, s[48:51], s86 offen offset:3072 sc1
    s_add_u32 s86, s82, 12288
    buffer_load_dwordx4 v[176:179], v13, s[48:51], s86 offen offset:0 sc1
    buffer_load_dwordx4 v[180:183], v13, s[48:51], s86 offen offset:1024 sc1
    buffer_load_dwordx4 v[184:187], v13, s[48:51], s86 offen offset:2048 sc1
    buffer_load_dwordx4 v[188:191], v13, s[48:51], s86 offen offset:3072 sc1
    s_add_u32 s86, s82, 16384
    buffer_load_dwordx4 v[192:195], v13, s[48:51], s86 offen offset:0 sc1
    buffer_load_dwordx4 v[196:199], v13, s[48:51], s86 offen offset:1024 sc1
    buffer_load_dwordx4 v[200:203], v13, s[48:51], s86 offen offset:2048 sc1
    buffer_load_dwordx4 v[204:207], v13, s[48:51], s86 offen offset:3072 sc1
    s_add_u32 s86, s82, 20480
    buffer_load_dwordx4 v[208:211], v13, s[48:51], s86 offen offset:0 sc1
    buffer_load_dwordx4 v[212:215], v13, s[48:51], s86 offen offset:1024 sc1
    buffer_load_dwordx4 v[216:219], v13, s[48:51], s86 offen offset:2048 sc1
    buffer_load_dwordx4 v[220:223], v13, s[48:51], s86 offen offset:3072 sc1
    s_add_u32 s86, s82, 24576
    buffer_load_dwordx4 v[224:227], v13, s[48:51], s86 offen offset:0 sc1
    buffer_load_dwordx4 v[228:231], v13, s[48:51], s86 offen offset:1024 sc1
    buffer_load_dwordx4 v[232:235], v13, s[48:51], s86 offen offset:2048 sc1
    buffer_load_dwordx4 v[236:239], v13, s[48:51], s86 offen offset:3072 sc1
    s_add_u32 s86, s82, 28672
    buffer_load_dwordx4 v[240:243], v13, s[48:51], s86 offen offset:0 sc1
    buffer_load_dwordx4 v[244:247], v13, s[48:51], s86 offen offset:1024 sc1
    buffer_load_dwordx4 v[248:251], v13, s[48:51], s86 offen offset:2048 sc1
    buffer_load_dwordx4 v[252:255], v13, s[48:51], s86 offen offset:3072 sc1
    s_lshl_b32 s87, s6, 13
    s_mul_i32 s88, s6, 65536
    s_lshl_b32 s3, s71, 7
    s_add_u32 s88, s88, s3
    v_lshlrev_b32 v8, 4, v1
    v_add_u32 v9, 0x10000, v8
    v_lshrrev_b32 v5, 3, v1
    v_bfe_u32 v6, v1, 2, 1
    v_bfe_u32 v12, v1, 4, 1
    v_xor_b32 v6, v6, v12
    v_lshlrev_b32 v6, 6, v6
    v_and_b32 v12, 3, v1
    v_lshl_add_u32 v12, v12, 4, v6
    v_mul_u32_u24 v5, 1024, v5
    v_add_u32 v12, v12, v5
    s_cmp_lg_u32 s6, 0
    s_cbranch_scc1 WT_41
    s_lshl_b32 s3, s2, 7
    v_and_b32 v4, 15, v1
    v_lshl_add_u32 v4, v4, 2, s3
    s_mov_b32 s3, 196608
    s_mov_b32 s52, 262144
WL_42:
    buffer_load_dword v5, v4, s[48:51], s3 offen sc0 sc1
    s_waitcnt vmcnt(0)
    v_cmp_ne_u32 vcc, s7, v5
    s_cbranch_vccz WE_40
    s_sub_u32 s52, s52, 1
    s_cmp_lg_u32 s52, 0
    s_cbranch_scc1 WL_42
    s_branch WE_40
WT_41:
WE_40:
    s_waitcnt vmcnt(0) lgkmcnt(0)
    s_barrier
    s_lshl_b32 s83, s81, 18
    s_lshl_b32 s3, s6, 13
    s_add_u32 s83, s83, s3
    s_add_u32 s83, s83, 12582912
    s_lshl_b32 s84, s6, 13
    s_add_u32 m0, s84, 0
    s_add_u32 s3, s83, 0
    buffer_load_dwordx4 v13, s[48:51], s3 offen sc1 lds
    s_add_u32 m0, s84, 1024
    s_add_u32 s3, s83, 1024
    buffer_load_dwordx4 v13, s[48:51], s3 offen sc1 lds
    s_add_u32 m0, s84, 2048
    s_add_u32 s3, s83, 2048
    buffer_load_dwordx4 v13, s[48:51], s3 offen sc1 lds
    s_add_u32 m0, s84, 3072
    s_add_u32 s3, s83, 3072
    buffer_load_dwordx4 v13, s[48:51], s3 offen sc1 lds
    s_add_u32 m0, s84, 4096
    s_add_u32 s3, s83, 4096
    buffer_load_dwordx4 v13, s[48:51], s3 offen sc1 lds
    s_add_u32 m0, s84, 5120
    s_add_u32 s3, s83, 5120
    buffer_load_dwordx4 v13, s[48:51], s3 offen sc1 lds
    s_add_u32 m0, s84, 6144
    s_add_u32 s3, s83, 6144
    buffer_load_dwordx4 v13, s[48:51], s3 offen sc1 lds
    s_add_u32 m0, s84, 7168
    s_add_u32 s3, s83, 7168
    buffer_load_dwordx4 v13, s[48:51], s3 offen sc1 lds
    s_add_u32 m0, s84, 32768
    s_add_u32 s3, s83, 32768
    buffer_load_dwordx4 v13, s[48:51], s3 offen sc1 lds
    s_add_u32 m0, s84, 33792
    s_add_u32 s3, s83, 33792
    buffer_load_dwordx4 v13, s[48:51], s3 offen sc1 lds
    s_add_u32 m0, s84, 34816
    s_add_u32 s3, s83, 34816
    buffer_load_dwordx4 v13, s[48:51], s3 offen sc1 lds
    s_add_u32 m0, s84, 35840
    s_add_u32 s3, s83, 35840
    buffer_load_dwordx4 v13, s[48:51], s3 offen sc1 lds
    s_add_u32 m0, s84, 36864
    s_add_u32 s3, s83, 36864
    buffer_load_dwordx4 v13, s[48:51], s3 offen sc1 lds
    s_add_u32 m0, s84, 37888
    s_add_u32 s3, s83, 37888
    buffer_load_dwordx4 v13, s[48:51], s3 offen sc1 lds
    s_add_u32 m0, s84, 38912
    s_add_u32 s3, s83, 38912
    buffer_load_dwordx4 v13, s[48:51], s3 offen sc1 lds
    s_add_u32 m0, s84, 39936
    s_add_u32 s3, s83, 39936
    buffer_load_dwordx4 v13, s[48:51], s3 offen sc1 lds
    s_add_u32 m0, s84, 65536
    s_add_u32 s3, s83, 65536
    buffer_load_dwordx4 v13, s[48:51], s3 offen sc1 lds
    s_add_u32 m0, s84, 66560
    s_add_u32 s3, s83, 66560
    buffer_load_dwordx4 v13, s[48:51], s3 offen sc1 lds
    s_waitcnt vmcnt(10)
    s_barrier
    ds_read_b128 v[80:83], v8 offset:0
    ds_read_b128 v[84:87], v8 offset:1024
    ds_read_b128 v[88:91], v8 offset:2048
    ds_read_b128 v[92:95], v8 offset:3072
    ds_read_b128 v[96:99], v8 offset:4096
    ds_read_b128 v[100:103], v8 offset:5120
    ds_read_b128 v[104:107], v8 offset:6144
    ds_read_b128 v[108:111], v8 offset:7168
    s_waitcnt lgkmcnt(6)
    v_mfma_f32_32x32x16_bf16 v[16:31], v[80:83], v[128:131], 0
    v_mfma_f32_32x32x16_bf16 v[32:47], v[84:87], v[128:131], 0
    ds_read_b128 v[80:83], v8 offset:8192
    ds_read_b128 v[84:87], v8 offset:9216
    s_waitcnt lgkmcnt(6)
    v_mfma_f32_32x32x16_bf16 v[16:31], v[88:91], v[132:135], v[16:31]
    v_mfma_f32_32x32x16_bf16 v[32:47], v[92:95], v[132:135], v[32:47]
    s_add_u32 s86, s82, 98304
    buffer_load_dwordx4 v[128:131], v13, s[48:51], s86 offen offset:0 sc1
    s_add_u32 m0, s84, 67584
    s_add_u32 s3, s83, 67584
    buffer_load_dwordx4 v13, s[48:51], s3 offen sc1 lds
    ds_read_b128 v[88:91], v8 offset:10240
    ds_read_b128 v[92:95], v8 offset:11264
    s_waitcnt lgkmcnt(6)
    v_mfma_f32_32x32x16_bf16 v[16:31], v[96:99], v[136:139], v[16:31]
    v_mfma_f32_32x32x16_bf16 v[32:47], v[100:103], v[136:139], v[32:47]
    ds_read_b128 v[96:99], v8 offset:12288
    ds_read_b128 v[100:103], v8 offset:13312
    s_waitcnt lgkmcnt(6)
    v_mfma_f32_32x32x16_bf16 v[16:31], v[104:107], v[140:143], v[16:31]
    v_mfma_f32_32x32x16_bf16 v[32:47], v[108:111], v[140:143], v[32:47]
    buffer_load_dwordx4 v[132:135], v13, s[48:51], s86 offen offset:1024 sc1
    s_add_u32 m0, s84, 68608
    s_add_u32 s3, s83, 68608
    buffer_load_dwordx4 v13, s[48:51], s3 offen sc1 lds
    ds_read_b128 v[104:107], v8 offset:14336
    ds_read_b128 v[108:111], v8 offset:15360
    s_waitcnt lgkmcnt(6)
    v_mfma_f32_32x32x16_bf16 v[16:31], v[80:83], v[144:147], v[16:31]
    v_mfma_f32_32x32x16_bf16 v[32:47], v[84:87], v[144:147], v[32:47]
    ds_read_b128 v[80:83], v8 offset:16384
    ds_read_b128 v[84:87], v8 offset:17408
    s_waitcnt lgkmcnt(6)
    v_mfma_f32_32x32x16_bf16 v[16:31], v[88:91], v[148:151], v[16:31]
    v_mfma_f32_32x32x16_bf16 v[32:47], v[92:95], v[148:151], v[32:47]
    buffer_load_dwordx4 v[136:139], v13, s[48:51], s86 offen offset:2048 sc1
    s_add_u32 m0, s84, 69632
    s_add_u32 s3, s83, 69632
    buffer_load_dwordx4 v13, s[48:51], s3 offen sc1 lds
    ds_read_b128 v[88:91], v8 offset:18432
    ds_read_b128 v[92:95], v8 offset:19456
    s_waitcnt lgkmcnt(6)
    v_mfma_f32_32x32x16_bf16 v[16:31], v[96:99], v[152:155], v[16:31]
    v_mfma_f32_32x32x16_bf16 v[32:47], v[100:103], v[152:155], v[32:47]
    ds_read_b128 v[96:99], v8 offset:20480
    ds_read_b128 v[100:103], v8 offset:21504
    s_waitcnt lgkmcnt(6)
    v_mfma_f32_32x32x16_bf16 v[16:31], v[104:107], v[156:159], v[16:31]
    v_mfma_f32_32x32x16_bf16 v[32:47], v[108:111], v[156:159], v[32:47]
    buffer_load_dwordx4 v[140:143], v13, s[48:51], s86 offen offset:3072 sc1
    s_add_u32 m0, s84, 70656
    s_add_u32 s3, s83, 70656
    buffer_load_dwordx4 v13, s[48:51], s3 offen sc1 lds
    ds_read_b128 v[104:107], v8 offset:22528
    ds_read_b128 v[108:111], v8 offset:23552
    s_waitcnt lgkmcnt(6)
    v_mfma_f32_32x32x16_bf16 v[16:31], v[80:83], v[160:163], v[16:31]
    v_mfma_f32_32x32x16_bf16 v[32:47], v[84:87], v[160:163], v[32:47]
    ds_read_b128 v[80:83], v8 offset:24576
    ds_read_b128 v[84:87], v8 offset:25600
    s_waitcnt lgkmcnt(6)
    v_mfma_f32_32x32x16_bf16 v[16:31], v[88:91], v[164:167], v[16:31]
    v_mfma_f32_32x32x16_bf16 v[32:47], v[92:95], v[164:167], v[32:47]
    s_add_u32 s86, s82, 102400
    buffer_load_dwordx4 v[144:147], v13, s[48:51], s86 offen offset:0 sc1
    s_add_u32 m0, s84, 71680
    s_add_u32 s3, s83, 71680
    buffer_load_dwordx4 v13, s[48:51], s3 offen sc1 lds
    ds_read_b128 v[88:91], v8 offset:26624
    ds_read_b128 v[92:95], v8 offset:27648
    s_waitcnt lgkmcnt(6)
    v_mfma_f32_32x32x16_bf16 v[16:31], v[96:99], v[168:171], v[16:31]
    v_mfma_f32_32x32x16_bf16 v[32:47], v[100:103], v[168:171], v[32:47]
    ds_read_b128 v[96:99], v8 offset:28672
    ds_read_b128 v[100:103], v8 offset:29696
    s_waitcnt lgkmcnt(6)
    v_mfma_f32_32x32x16_bf16 v[16:31], v[104:107], v[172:175], v[16:31]
    v_mfma_f32_32x32x16_bf16 v[32:47], v[108:111], v[172:175], v[32:47]
    buffer_load_dwordx4 v[148:151], v13, s[48:51], s86 offen offset:1024 sc1
    s_add_u32 m0, s84, 72704
    s_add_u32 s3, s83, 72704
    buffer_load_dwordx4 v13, s[48:51], s3 offen sc1 lds
    ds_read_b128 v[104:107], v8 offset:30720
    ds_read_b128 v[108:111], v8 offset:31744
    s_waitcnt lgkmcnt(6)
    v_mfma_f32_32x32x16_bf16 v[16:31], v[80:83], v[176:179], v[16:31]
    v_mfma_f32_32x32x16_bf16 v[32:47], v[84:87], v[176:179], v[32:47]
    s_waitcnt vmcnt(14)
    s_barrier
    ds_read_b128 v[80:83], v8 offset:32768
    ds_read_b128 v[84:87], v8 offset:33792
    s_waitcnt lgkmcnt(6)
    v_mfma_f32_32x32x16_bf16 v[16:31], v[88:91], v[180:183], v[16:31]
    v_mfma_f32_32x32x16_bf16 v[32:47], v[92:95], v[180:183], v[32:47]
    buffer_load_dwordx4 v[152:155], v13, s[48:51], s86 offen offset:2048 sc1
    s_add_u32 m0, s84, 98304
    s_add_u32 s3, s83, 98304
    buffer_load_dwordx4 v13, s[48:51], s3 offen sc1 lds
    ds_read_b128 v[88:91], v8 offset:34816
    ds_read_b128 v[92:95], v8 offset:35840
    s_waitcnt lgkmcnt(6)
    v_mfma_f32_32x32x16_bf16 v[16:31], v[96:99], v[184:187], v[16:31]
    v_mfma_f32_32x32x16_bf16 v[32:47], v[100:103], v[184:187], v[32:47]
    ds_read_b128 v[96:99], v8 offset:36864
    ds_read_b128 v[100:103], v8 offset:37888
    s_waitcnt lgkmcnt(6)
    v_mfma_f32_32x32x16_bf16 v[16:31], v[104:107], v[188:191], v[16:31]
    v_mfma_f32_32x32x16_bf16 v[32:47], v[108:111], v[188:191], v[32:47]
    buffer_load_dwordx4 v[156:159], v13, s[48:51], s86 offen offset:3072 sc1
    s_add_u32 m0, s84, 99328
    s_add_u32 s3, s83, 99328
    buffer_load_dwordx4 v13, s[48:51], s3 offen sc1 lds
    ds_read_b128 v[104:107], v8 offset:38912
    ds_read_b128 v[108:111], v8 offset:39936
    s_waitcnt lgkmcnt(6)
    v_mfma_f32_32x32x16_bf16 v[16:31], v[80:83], v[192:195], v[16:31]
    v_mfma_f32_32x32x16_bf16 v[32:47], v[84:87], v[192:195], v[32:47]
    ds_read_b128 v[80:83], v8 offset:40960
    ds_read_b128 v[84:87], v8 offset:41984
    s_waitcnt lgkmcnt(6)
    v_mfma_f32_32x32x16_bf16 v[16:31], v[88:91], v[196:199], v[16:31]
    v_mfma_f32_32x32x16_bf16 v[32:47], v[92:95], v[196:199], v[32:47]
    s_add_u32 s86, s82, 106496
    buffer_load_dwordx4 v[160:163], v13, s[48:51], s86 offen offset:0 sc1
    s_add_u32 m0, s84, 100352
    s_add_u32 s3, s83, 100352
    buffer_load_dwordx4 v13, s[48:51], s3 offen sc1 lds
    ds_read_b128 v[88:91], v8 offset:43008
    ds_read_b128 v[92:95], v8 offset:44032
    s_waitcnt lgkmcnt(6)
    v_mfma_f32_32x32x16_bf16 v[16:31], v[96:99], v[200:203], v[16:31]
    v_mfma_f32_32x32x16_bf16 v[32:47], v[100:103], v[200:203], v[32:47]
    ds_read_b128 v[96:99], v8 offset:45056
    ds_read_b128 v[100:103], v8 offset:46080
    s_waitcnt lgkmcnt(6)
    v_mfma_f32_32x32x16_bf16 v[16:31], v[104:107], v[204:207], v[16:31]
    v_mfma_f32_32x32x16_bf16 v[32:47], v[108:111], v[204:207], v[32:47]
    buffer_load_dwordx4 v[164:167], v13, s[48:51], s86 offen offset:1024 sc1
    s_add_u32 m0, s84, 101376
    s_add_u32 s3, s83, 101376
    buffer_load_dwordx4 v13, s[48:51], s3 offen sc1 lds
    ds_read_b128 v[104:107], v8 offset:47104
    ds_read_b128 v[108:111], v8 offset:48128
    s_waitcnt lgkmcnt(6)
    v_mfma_f32_32x32x16_bf16 v[16:31], v[80:83], v[208:211], v[16:31]
    v_mfma_f32_32x32x16_bf16 v[32:47], v[84:87], v[208:211], v[32:47]
    ds_read_b128 v[80:83], v8 offset:49152
    ds_read_b128 v[84:87], v8 offset:50176
    s_waitcnt lgkmcnt(6)
    v_mfma_f32_32x32x16_bf16 v[16:31], v[88:91], v[212:215], v[16:31]
    v_mfma_f32_32x32x16_bf16 v[32:47], v[92:95], v[212:215], v[32:47]
    buffer_load_dwordx4 v[168:171], v13, s[48:51], s86 offen offset:2048 sc1
    s_add_u32 m0, s84, 102400
    s_add_u32 s3, s83, 102400
    buffer_load_dwordx4 v13, s[48:51], s3 offen sc1 lds
    ds_read_b128 v[88:91], v8 offset:51200
    ds_read_b128 v[92:95], v8 offset:52224
    s_waitcnt lgkmcnt(6)
    v_mfma_f32_32x32x16_bf16 v[16:31], v[96:99], v[216:219], v[16:31]
    v_mfma_f32_32x32x16_bf16 v[32:47], v[100:103], v[216:219], v[32:47]
    ds_read_b128 v[96:99], v8 offset:53248
    ds_read_b128 v[100:103], v8 offset:54272
    s_waitcnt lgkmcnt(6)
    v_mfma_f32_32x32x16_bf16 v[16:31], v[104:107], v[220:223], v[16:31]
    v_mfma_f32_32x32x16_bf16 v[32:47], v[108:111], v[220:223], v[32:47]
    buffer_load_dwordx4 v[172:175], v13, s[48:51], s86 offen offset:3072 sc1
    s_add_u32 m0, s84, 103424
    s_add_u32 s3, s83, 103424
    buffer_load_dwordx4 v13, s[48:51], s3 offen sc1 lds
    ds_read_b128 v[104:107], v8 offset:55296
    ds_read_b128 v[108:111], v8 offset:56320
    s_waitcnt lgkmcnt(6)
    v_mfma_f32_32x32x16_bf16 v[16:31], v[80:83], v[224:227], v[16:31]
    v_mfma_f32_32x32x16_bf16 v[32:47], v[84:87], v[224:227], v[32:47]
    ds_read_b128 v[80:83], v8 offset:57344
    ds_read_b128 v[84:87], v8 offset:58368
    s_waitcnt lgkmcnt(6)
    v_mfma_f32_32x32x16_bf16 v[16:31], v[88:91], v[228:231], v[16:31]
    v_mfma_f32_32x32x16_bf16 v[32:47], v[92:95], v[228:231], v[32:47]
    s_add_u32 s86, s82, 110592
    buffer_load_dwordx4 v[176:179], v13, s[48:51], s86 offen offset:0 sc1
    s_add_u32 m0, s84, 104448
    s_add_u32 s3, s83, 104448
    buffer_load_dwordx4 v13, s[48:51], s3 offen sc1 lds
    ds_read_b128 v[88:91], v8 offset:59392
    ds_read_b128 v[92:95], v8 offset:60416
    s_waitcnt lgkmcnt(6)
    v_mfma_f32_32x32x16_bf16 v[16:31], v[96:99], v[232:235], v[16:31]
    v_mfma_f32_32x32x16_bf16 v[32:47], v[100:103], v[232:235], v[32:47]
    ds_read_b128 v[96:99], v8 offset:61440
    ds_read_b128 v[100:103], v8 offset:62464
    s_waitcnt lgkmcnt(6)
    v_mfma_f32_32x32x16_bf16 v[16:31], v[104:107], v[236:239], v[16:31]
    v_mfma_f32_32x32x16_bf16 v[32:47], v[108:111], v[236:239], v[32:47]
    buffer_load_dwordx4 v[180:183], v13, s[48:51], s86 offen offset:1024 sc1
    s_add_u32 m0, s84, 105472
    s_add_u32 s3, s83, 105472
    buffer_load_dwordx4 v13, s[48:51], s3 offen sc1 lds
    ds_read_b128 v[104:107], v8 offset:63488
    ds_read_b128 v[108:111], v8 offset:64512
    s_waitcnt lgkmcnt(6)
    v_mfma_f32_32x32x16_bf16 v[16:31], v[80:83], v[240:243], v[16:31]
    v_mfma_f32_32x32x16_bf16 v[32:47], v[84:87], v[240:243], v[32:47]
    s_waitcnt vmcnt(16)
    s_barrier
    ds_read_b128 v[80:83], v9 offset:0
    ds_read_b128 v[84:87], v9 offset:1024
    s_waitcnt lgkmcnt(6)
    v_mfma_f32_32x32x16_bf16 v[16:31], v[88:91], v[244:247], v[16:31]
    v_mfma_f32_32x32x16_bf16 v[32:47], v[92:95], v[244:247], v[32:47]
    buffer_load_dwordx4 v[184:187], v13, s[48:51], s86 offen offset:2048 sc1
    s_add_u32 m0, s84, 0
    s_add_u32 s3, s83, 131072
    buffer_load_dwordx4 v13, s[48:51], s3 offen sc1 lds
    ds_read_b128 v[88:91], v9 offset:2048
    ds_read_b128 v[92:95], v9 offset:3072
    s_waitcnt lgkmcnt(6)
    v_mfma_f32_32x32x16_bf16 v[16:31], v[96:99], v[248:251], v[16:31]
    v_mfma_f32_32x32x16_bf16 v[32:47], v[100:103], v[248:251], v[32:47]
    ds_read_b128 v[96:99], v9 offset:4096
    ds_read_b128 v[100:103], v9 offset:5120
    s_waitcnt lgkmcnt(6)
    v_mfma_f32_32x32x16_bf16 v[16:31], v[104:107], v[252:255], v[16:31]
    v_mfma_f32_32x32x16_bf16 v[32:47], v[108:111], v[252:255], v[32:47]
    buffer_load_dwordx4 v[188:191], v13, s[48:51], s86 offen offset:3072 sc1
    s_add_u32 m0, s84, 1024
    s_add_u32 s3, s83, 132096
    buffer_load_dwordx4 v13, s[48:51], s3 offen sc1 lds
    ds_read_b128 v[104:107], v9 offset:6144
    ds_read_b128 v[108:111], v9 offset:7168
    s_waitcnt lgkmcnt(6)
    v_mfma_f32_32x32x16_bf16 v[16:31], v[80:83], a[0:3], v[16:31]
    v_mfma_f32_32x32x16_bf16 v[32:47], v[84:87], a[0:3], v[32:47]
    ds_read_b128 v[80:83], v9 offset:8192
    ds_read_b128 v[84:87], v9 offset:9216
    s_waitcnt lgkmcnt(6)
    v_mfma_f32_32x32x16_bf16 v[16:31], v[88:91], a[4:7], v[16:31]
    v_mfma_f32_32x32x16_bf16 v[32:47], v[92:95], a[4:7], v[32:47]
    s_add_u32 s86, s82, 114688
    buffer_load_dwordx4 v[192:195], v13, s[48:51], s86 offen offset:0 sc1
    s_add_u32 m0, s84, 2048
    s_add_u32 s3, s83, 133120
    buffer_load_dwordx4 v13, s[48:51], s3 offen sc1 lds
    ds_read_b128 v[88:91], v9 offset:10240
    ds_read_b128 v[92:95], v9 offset:11264
    s_waitcnt lgkmcnt(6)
    v_mfma_f32_32x32x16_bf16 v[16:31], v[96:99], a[8:11], v[16:31]
    v_mfma_f32_32x32x16_bf16 v[32:47], v[100:103], a[8:11], v[32:47]
    ds_read_b128 v[96:99], v9 offset:12288
    ds_read_b128 v[100:103], v9 offset:13312
    s_waitcnt lgkmcnt(6)
    v_mfma_f32_32x32x16_bf16 v[16:31], v[104:107], a[12:15], v[16:31]
    v_mfma_f32_32x32x16_bf16 v[32:47], v[108:111], a[12:15], v[32:47]
    buffer_load_dwordx4 v[196:199], v13, s[48:51], s86 offen offset:1024 sc1
    s_add_u32 m0, s84, 3072
    s_add_u32 s3, s83, 134144
    buffer_load_dwordx4 v13, s[48:51], s3 offen sc1 lds
    ds_read_b128 v[104:107], v9 offset:14336
    ds_read_b128 v[108:111], v9 offset:15360
    s_waitcnt lgkmcnt(6)
    v_mfma_f32_32x32x16_bf16 v[16:31], v[80:83], a[16:19], v[16:31]
    v_mfma_f32_32x32x16_bf16 v[32:47], v[84:87], a[16:19], v[32:47]
    ds_read_b128 v[80:83], v9 offset:16384
    ds_read_b128 v[84:87], v9 offset:17408
    s_waitcnt lgkmcnt(6)
    v_mfma_f32_32x32x16_bf16 v[16:31], v[88:91], a[20:23], v[16:31]
    v_mfma_f32_32x32x16_bf16 v[32:47], v[92:95], a[20:23], v[32:47]
    buffer_load_dwordx4 v[200:203], v13, s[48:51], s86 offen offset:2048 sc1
    s_add_u32 m0, s84, 4096
    s_add_u32 s3, s83, 135168
    buffer_load_dwordx4 v13, s[48:51], s3 offen sc1 lds
    ds_read_b128 v[88:91], v9 offset:18432
    ds_read_b128 v[92:95], v9 offset:19456
    s_waitcnt lgkmcnt(6)
    v_mfma_f32_32x32x16_bf16 v[16:31], v[96:99], a[24:27], v[16:31]
    v_mfma_f32_32x32x16_bf16 v[32:47], v[100:103], a[24:27], v[32:47]
    ds_read_b128 v[96:99], v9 offset:20480
    ds_read_b128 v[100:103], v9 offset:21504
    s_waitcnt lgkmcnt(6)
    v_mfma_f32_32x32x16_bf16 v[16:31], v[104:107], a[28:31], v[16:31]
    v_mfma_f32_32x32x16_bf16 v[32:47], v[108:111], a[28:31], v[32:47]
    buffer_load_dwordx4 v[204:207], v13, s[48:51], s86 offen offset:3072 sc1
    s_add_u32 m0, s84, 5120
    s_add_u32 s3, s83, 136192
    buffer_load_dwordx4 v13, s[48:51], s3 offen sc1 lds
    ds_read_b128 v[104:107], v9 offset:22528
    ds_read_b128 v[108:111], v9 offset:23552
    s_waitcnt lgkmcnt(6)
    v_mfma_f32_32x32x16_bf16 v[16:31], v[80:83], a[32:35], v[16:31]
    v_mfma_f32_32x32x16_bf16 v[32:47], v[84:87], a[32:35], v[32:47]
    ds_read_b128 v[80:83], v9 offset:24576
    ds_read_b128 v[84:87], v9 offset:25600
    s_waitcnt lgkmcnt(6)
    v_mfma_f32_32x32x16_bf16 v[16:31], v[88:91], a[36:39], v[16:31]
    v_mfma_f32_32x32x16_bf16 v[32:47], v[92:95], a[36:39], v[32:47]
    s_add_u32 s86, s82, 118784
    buffer_load_dwordx4 v[208:211], v13, s[48:51], s86 offen offset:0 sc1
    s_add_u32 m0, s84, 6144
    s_add_u32 s3, s83, 137216
    buffer_load_dwordx4 v13, s[48:51], s3 offen sc1 lds
    ds_read_b128 v[88:91], v9 offset:26624
    ds_read_b128 v[92:95], v9 offset:27648
    s_waitcnt lgkmcnt(6)
    v_mfma_f32_32x32x16_bf16 v[16:31], v[96:99], a[40:43], v[16:31]
    v_mfma_f32_32x32x16_bf16 v[32:47], v[100:103], a[40:43], v[32:47]
    ds_read_b128 v[96:99], v9 offset:28672
    ds_read_b128 v[100:103], v9 offset:29696
    s_waitcnt lgkmcnt(6)
    v_mfma_f32_32x32x16_bf16 v[16:31], v[104:107], a[44:47], v[16:31]
    v_mfma_f32_32x32x16_bf16 v[32:47], v[108:111], a[44:47], v[32:47]
    buffer_load_dwordx4 v[212:215], v13, s[48:51], s86 offen offset:1024 sc1
    s_add_u32 m0, s84, 7168
    s_add_u32 s3, s83, 138240
    buffer_load_dwordx4 v13, s[48:51], s3 offen sc1 lds
    ds_read_b128 v[104:107], v9 offset:30720
    ds_read_b128 v[108:111], v9 offset:31744
    s_waitcnt lgkmcnt(6)
    v_mfma_f32_32x32x16_bf16 v[16:31], v[80:83], a[48:51], v[16:31]
    v_mfma_f32_32x32x16_bf16 v[32:47], v[84:87], a[48:51], v[32:47]
    s_waitcnt vmcnt(16)
    s_barrier
    ds_read_b128 v[80:83], v9 offset:32768
    ds_read_b128 v[84:87], v9 offset:33792
    s_waitcnt lgkmcnt(6)
    v_mfma_f32_32x32x16_bf16 v[16:31], v[88:91], a[52:55], v[16:31]
    v_mfma_f32_32x32x16_bf16 v[32:47], v[92:95], a[52:55], v[32:47]
    buffer_load_dwordx4 v[216:219], v13, s[48:51], s86 offen offset:2048 sc1
    s_add_u32 m0, s84, 32768
    s_add_u32 s3, s83, 163840
    buffer_load_dwordx4 v13, s[48:51], s3 offen sc1 lds
    ds_read_b128 v[88:91], v9 offset:34816
    ds_read_b128 v[92:95], v9 offset:35840
    s_waitcnt lgkmcnt(6)
    v_mfma_f32_32x32x16_bf16 v[16:31], v[96:99], a[56:59], v[16:31]
    v_mfma_f32_32x32x16_bf16 v[32:47], v[100:103], a[56:59], v[32:47]
    ds_read_b128 v[96:99], v9 offset:36864
    ds_read_b128 v[100:103], v9 offset:37888
    s_waitcnt lgkmcnt(6)
    v_mfma_f32_32x32x16_bf16 v[16:31], v[104:107], a[60:63], v[16:31]
    v_mfma_f32_32x32x16_bf16 v[32:47], v[108:111], a[60:63], v[32:47]
    buffer_load_dwordx4 v[220:223], v13, s[48:51], s86 offen offset:3072 sc1
    s_add_u32 m0, s84, 33792
    s_add_u32 s3, s83, 164864
    buffer_load_dwordx4 v13, s[48:51], s3 offen sc1 lds
    ds_read_b128 v[104:107], v9 offset:38912
    ds_read_b128 v[108:111], v9 offset:39936
    s_waitcnt lgkmcnt(6)
    v_mfma_f32_32x32x16_bf16 v[16:31], v[80:83], a[64:67], v[16:31]
    v_mfma_f32_32x32x16_bf16 v[32:47], v[84:87], a[64:67], v[32:47]
    ds_read_b128 v[80:83], v9 offset:40960
    ds_read_b128 v[84:87], v9 offset:41984
    s_waitcnt lgkmcnt(6)
    v_mfma_f32_32x32x16_bf16 v[16:31], v[88:91], a[68:71], v[16:31]
    v_mfma_f32_32x32x16_bf16 v[32:47], v[92:95], a[68:71], v[32:47]
    s_add_u32 s86, s82, 122880
    buffer_load_dwordx4 v[224:227], v13, s[48:51], s86 offen offset:0 sc1
    s_add_u32 m0, s84, 34816
    s_add_u32 s3, s83, 165888
    buffer_load_dwordx4 v13, s[48:51], s3 offen sc1 lds
    ds_read_b128 v[88:91], v9 offset:43008
    ds_read_b128 v[92:95], v9 offset:44032
    s_waitcnt lgkmcnt(6)
    v_mfma_f32_32x32x16_bf16 v[16:31], v[96:99], a[72:75], v[16:31]
    v_mfma_f32_32x32x16_bf16 v[32:47], v[100:103], a[72:75], v[32:47]
    ds_read_b128 v[96:99], v9 offset:45056
    ds_read_b128 v[100:103], v9 offset:46080
    s_waitcnt lgkmcnt(6)
    v_mfma_f32_32x32x16_bf16 v[16:31], v[104:107], a[76:79], v[16:31]
    v_mfma_f32_32x32x16_bf16 v[32:47], v[108:111], a[76:79], v[32:47]
    buffer_load_dwordx4 v[228:231], v13, s[48:51], s86 offen offset:1024 sc1
    s_add_u32 m0, s84, 35840
    s_add_u32 s3, s83, 166912
    buffer_load_dwordx4 v13, s[48:51], s3 offen sc1 lds
    ds_read_b128 v[104:107], v9 offset:47104
    ds_read_b128 v[108:111], v9 offset:48128
    s_waitcnt lgkmcnt(6)
    v_mfma_f32_32x32x16_bf16 v[16:31], v[80:83], a[80:83], v[16:31]
    v_mfma_f32_32x32x16_bf16 v[32:47], v[84:87], a[80:83], v[32:47]
    ds_read_b128 v[80:83], v9 offset:49152
    ds_read_b128 v[84:87], v9 offset:50176
    s_waitcnt lgkmcnt(6)
    v_mfma_f32_32x32x16_bf16 v[16:31], v[88:91], a[84:87], v[16:31]
    v_mfma_f32_32x32x16_bf16 v[32:47], v[92:95], a[84:87], v[32:47]
    buffer_load_dwordx4 v[232:235], v13, s[48:51], s86 offen offset:2048 sc1
    s_add_u32 m0, s84, 36864
    s_add_u32 s3, s83, 167936
    buffer_load_dwordx4 v13, s[48:51], s3 offen sc1 lds
    ds_read_b128 v[88:91], v9 offset:51200
    ds_read_b128 v[92:95], v9 offset:52224
    s_waitcnt lgkmcnt(6)
    v_mfma_f32_32x32x16_bf16 v[16:31], v[96:99], a[88:91], v[16:31]
    v_mfma_f32_32x32x16_bf16 v[32:47], v[100:103], a[88:91], v[32:47]
    ds_read_b128 v[96:99], v9 offset:53248
    ds_read_b128 v[100:103], v9 offset:54272
    s_waitcnt lgkmcnt(6)
    v_mfma_f32_32x32x16_bf16 v[16:31], v[104:107], a[92:95], v[16:31]
    v_mfma_f32_32x32x16_bf16 v[32:47], v[108:111], a[92:95], v[32:47]
    buffer_load_dwordx4 v[236:239], v13, s[48:51], s86 offen offset:3072 sc1
    s_add_u32 m0, s84, 37888
    s_add_u32 s3, s83, 168960
    buffer_load_dwordx4 v13, s[48:51], s3 offen sc1 lds
    ds_read_b128 v[104:107], v9 offset:55296
    ds_read_b128 v[108:111], v9 offset:56320
    s_waitcnt lgkmcnt(6)
    v_mfma_f32_32x32x16_bf16 v[16:31], v[80:83], a[96:99], v[16:31]
    v_mfma_f32_32x32x16_bf16 v[32:47], v[84:87], a[96:99], v[32:47]
    ds_read_b128 v[80:83], v9 offset:57344
    ds_read_b128 v[84:87], v9 offset:58368
    s_waitcnt lgkmcnt(6)
    v_mfma_f32_32x32x16_bf16 v[16:31], v[88:91], a[100:103], v[16:31]
    v_mfma_f32_32x32x16_bf16 v[32:47], v[92:95], a[100:103], v[32:47]
    s_add_u32 s86, s82, 126976
    buffer_load_dwordx4 v[240:243], v13, s[48:51], s86 offen offset:0 sc1
    s_add_u32 m0, s84, 38912
    s_add_u32 s3, s83, 169984
    buffer_load_dwordx4 v13, s[48:51], s3 offen sc1 lds
    ds_read_b128 v[88:91], v9 offset:59392
    ds_read_b128 v[92:95], v9 offset:60416
    s_waitcnt lgkmcnt(6)
    v_mfma_f32_32x32x16_bf16 v[16:31], v[96:99], a[104:107], v[16:31]
    v_mfma_f32_32x32x16_bf16 v[32:47], v[100:103], a[104:107], v[32:47]
    ds_read_b128 v[96:99], v9 offset:61440
    ds_read_b128 v[100:103], v9 offset:62464
    s_waitcnt lgkmcnt(6)
    v_mfma_f32_32x32x16_bf16 v[16:31], v[104:107], a[108:111], v[16:31]
    v_mfma_f32_32x32x16_bf16 v[32:47], v[108:111], a[108:111], v[32:47]
    buffer_load_dwordx4 v[244:247], v13, s[48:51], s86 offen offset:1024 sc1
    s_add_u32 m0, s84, 39936
    s_add_u32 s3, s83, 171008
    buffer_load_dwordx4 v13, s[48:51], s3 offen sc1 lds
    ds_read_b128 v[104:107], v9 offset:63488
    ds_read_b128 v[108:111], v9 offset:64512
    s_waitcnt lgkmcnt(6)
    v_mfma_f32_32x32x16_bf16 v[16:31], v[80:83], a[112:115], v[16:31]
    v_mfma_f32_32x32x16_bf16 v[32:47], v[84:87], a[112:115], v[32:47]
    s_waitcnt vmcnt(16)
    s_barrier
    ds_read_b128 v[80:83], v8 offset:0
    ds_read_b128 v[84:87], v8 offset:1024
    s_waitcnt lgkmcnt(6)
    v_mfma_f32_32x32x16_bf16 v[16:31], v[88:91], a[116:119], v[16:31]
    v_mfma_f32_32x32x16_bf16 v[32:47], v[92:95], a[116:119], v[32:47]
    buffer_load_dwordx4 v[248:251], v13, s[48:51], s86 offen offset:2048 sc1
    s_add_u32 m0, s84, 65536
    s_add_u32 s3, s83, 196608
    buffer_load_dwordx4 v13, s[48:51], s3 offen sc1 lds
    ds_read_b128 v[88:91], v8 offset:2048
    ds_read_b128 v[92:95], v8 offset:3072
    s_waitcnt lgkmcnt(6)
    v_mfma_f32_32x32x16_bf16 v[16:31], v[96:99], a[120:123], v[16:31]
    v_mfma_f32_32x32x16_bf16 v[32:47], v[100:103], a[120:123], v[32:47]
    ds_read_b128 v[96:99], v8 offset:4096
    ds_read_b128 v[100:103], v8 offset:5120
    s_waitcnt lgkmcnt(6)
    v_mfma_f32_32x32x16_bf16 v[16:31], v[104:107], a[124:127], v[16:31]
    v_mfma_f32_32x32x16_bf16 v[32:47], v[108:111], a[124:127], v[32:47]
    buffer_load_dwordx4 v[252:255], v13, s[48:51], s86 offen offset:3072 sc1
    s_add_u32 m0, s84, 66560
    s_add_u32 s3, s83, 197632
    buffer_load_dwordx4 v13, s[48:51], s3 offen sc1 lds
    ds_read_b128 v[104:107], v8 offset:6144
    ds_read_b128 v[108:111], v8 offset:7168
    s_waitcnt lgkmcnt(6)
    v_mfma_f32_32x32x16_bf16 v[16:31], v[80:83], a[128:131], v[16:31]
    v_mfma_f32_32x32x16_bf16 v[32:47], v[84:87], a[128:131], v[32:47]
    ds_read_b128 v[80:83], v8 offset:8192
    ds_read_b128 v[84:87], v8 offset:9216
    s_waitcnt lgkmcnt(6)
    v_mfma_f32_32x32x16_bf16 v[16:31], v[88:91], a[132:135], v[16:31]
    v_mfma_f32_32x32x16_bf16 v[32:47], v[92:95], a[132:135], v[32:47]
    s_add_u32 m0, s84, 67584
    s_add_u32 s3, s83, 198656
    buffer_load_dwordx4 v13, s[48:51], s3 offen sc1 lds
    ds_read_b128 v[88:91], v8 offset:10240
    ds_read_b128 v[92:95], v8 offset:11264
    s_waitcnt lgkmcnt(6)
    v_mfma_f32_32x32x16_bf16 v[16:31], v[96:99], a[136:139], v[16:31]
    v_mfma_f32_32x32x16_bf16 v[32:47], v[100:103], a[136:139], v[32:47]
    ds_read_b128 v[96:99], v8 offset:12288
    ds_read_b128 v[100:103], v8 offset:13312
    s_waitcnt lgkmcnt(6)
    v_mfma_f32_32x32x16_bf16 v[16:31], v[104:107], a[140:143], v[16:31]
    v_mfma_f32_32x32x16_bf16 v[32:47], v[108:111], a[140:143], v[32:47]
    s_add_u32 m0, s84, 68608
    s_add_u32 s3, s83, 199680
    buffer_load_dwordx4 v13, s[48:51], s3 offen sc1 lds
    ds_read_b128 v[104:107], v8 offset:14336
    ds_read_b128 v[108:111], v8 offset:15360
    s_waitcnt lgkmcnt(6)
    v_mfma_f32_32x32x16_bf16 v[16:31], v[80:83], a[144:147], v[16:31]
    v_mfma_f32_32x32x16_bf16 v[32:47], v[84:87], a[144:147], v[32:47]
    ds_read_b128 v[80:83], v8 offset:16384
    ds_read_b128 v[84:87], v8 offset:17408
    s_waitcnt lgkmcnt(6)
    v_mfma_f32_32x32x16_bf16 v[16:31], v[88:91], a[148:151], v[16:31]
    v_mfma_f32_32x32x16_bf16 v[32:47], v[92:95], a[148:151], v[32:47]
    s_add_u32 m0, s84, 69632
    s_add_u32 s3, s83, 200704
    buffer_load_dwordx4 v13, s[48:51], s3 offen sc1 lds
    ds_read_b128 v[88:91], v8 offset:18432
    ds_read_b128 v[92:95], v8 offset:19456
    s_waitcnt lgkmcnt(6)
    v_mfma_f32_32x32x16_bf16 v[16:31], v[96:99], a[152:155], v[16:31]
    v_mfma_f32_32x32x16_bf16 v[32:47], v[100:103], a[152:155], v[32:47]
    ds_read_b128 v[96:99], v8 offset:20480
    ds_read_b128 v[100:103], v8 offset:21504
    s_waitcnt lgkmcnt(6)
    v_mfma_f32_32x32x16_bf16 v[16:31], v[104:107], a[156:159], v[16:31]
    v_mfma_f32_32x32x16_bf16 v[32:47], v[108:111], a[156:159], v[32:47]
    s_add_u32 m0, s84, 70656
    s_add_u32 s3, s83, 201728
    buffer_load_dwordx4 v13, s[48:51], s3 offen sc1 lds
    ds_read_b128 v[104:107], v8 offset:22528
    ds_read_b128 v[108:111], v8 offset:23552
    s_waitcnt lgkmcnt(6)
    v_mfma_f32_32x32x16_bf16 v[16:31], v[80:83], a[160:163], v[16:31]
    v_mfma_f32_32x32x16_bf16 v[32:47], v[84:87], a[160:163], v[32:47]
    ds_read_b128 v[80:83], v8 offset:24576
    ds_read_b128 v[84:87], v8 offset:25600
    s_waitcnt lgkmcnt(6)
    v_mfma_f32_32x32x16_bf16 v[16:31], v[88:91], a[164:167], v[16:31]
    v_mfma_f32_32x32x16_bf16 v[32:47], v[92:95], a[164:167], v[32:47]
    s_add_u32 m0, s84, 71680
    s_add_u32 s3, s83, 202752
    buffer_load_dwordx4 v13, s[48:51], s3 offen sc1 lds
    ds_read_b128 v[88:91], v8 offset:26624
    ds_read_b128 v[92:95], v8 offset:27648
    s_waitcnt lgkmcnt(6)
    v_mfma_f32_32x32x16_bf16 v[16:31], v[96:99], a[168:171], v[16:31]
    v_mfma_f32_32x32x16_bf16 v[32:47], v[100:103], a[168:171], v[32:47]
    ds_read_b128 v[96:99], v8 offset:28672
    ds_read_b128 v[100:103], v8 offset:29696
    s_waitcnt lgkmcnt(6)
    v_mfma_f32_32x32x16_bf16 v[16:31], v[104:107], a[172:175], v[16:31]
    v_mfma_f32_32x32x16_bf16 v[32:47], v[108:111], a[172:175], v[32:47]
    s_add_u32 m0, s84, 72704
    s_add_u32 s3, s83, 203776
    buffer_load_dwordx4 v13, s[48:51], s3 offen sc1 lds
    ds_read_b128 v[104:107], v8 offset:30720
    ds_read_b128 v[108:111], v8 offset:31744
    s_waitcnt lgkmcnt(6)
    v_mfma_f32_32x32x16_bf16 v[16:31], v[80:83], a[176:179], v[16:31]
    v_mfma_f32_32x32x16_bf16 v[32:47], v[84:87], a[176:179], v[32:47]
    s_waitcnt vmcnt(10)
    s_barrier
    ds_read_b128 v[80:83], v8 offset:32768
    ds_read_b128 v[84:87], v8 offset:33792
    s_waitcnt lgkmcnt(6)
    v_mfma_f32_32x32x16_bf16 v[16:31], v[88:91], a[180:183], v[16:31]
    v_mfma_f32_32x32x16_bf16 v[32:47], v[92:95], a[180:183], v[32:47]
    s_add_u32 m0, s84, 98304
    s_add_u32 s3, s83, 229376
    buffer_load_dwordx4 v13, s[48:51], s3 offen sc1 lds
    ds_read_b128 v[88:91], v8 offset:34816
    ds_read_b128 v[92:95], v8 offset:35840
    s_waitcnt lgkmcnt(6)
    v_mfma_f32_32x32x16_bf16 v[16:31], v[96:99], a[184:187], v[16:31]
    v_mfma_f32_32x32x16_bf16 v[32:47], v[100:103], a[184:187], v[32:47]
    ds_read_b128 v[96:99], v8 offset:36864
    ds_read_b128 v[100:103], v8 offset:37888
    s_waitcnt lgkmcnt(6)
    v_mfma_f32_32x32x16_bf16 v[16:31], v[104:107], a[188:191], v[16:31]
    v_mfma_f32_32x32x16_bf16 v[32:47], v[108:111], a[188:191], v[32:47]
    s_add_u32 m0, s84, 99328
    s_add_u32 s3, s83, 230400
    buffer_load_dwordx4 v13, s[48:51], s3 offen sc1 lds
    ds_read_b128 v[104:107], v8 offset:38912
    ds_read_b128 v[108:111], v8 offset:39936
    s_waitcnt lgkmcnt(6)
    v_mfma_f32_32x32x16_bf16 v[16:31], v[80:83], a[192:195], v[16:31]
    v_mfma_f32_32x32x16_bf16 v[32:47], v[84:87], a[192:195], v[32:47]
    ds_read_b128 v[80:83], v8 offset:40960
    ds_read_b128 v[84:87], v8 offset:41984
    s_waitcnt lgkmcnt(6)
    v_mfma_f32_32x32x16_bf16 v[16:31], v[88:91], a[196:199], v[16:31]
    v_mfma_f32_32x32x16_bf16 v[32:47], v[92:95], a[196:199], v[32:47]
    s_add_u32 m0, s84, 100352
    s_add_u32 s3, s83, 231424
    buffer_load_dwordx4 v13, s[48:51], s3 offen sc1 lds
    ds_read_b128 v[88:91], v8 offset:43008
    ds_read_b128 v[92:95], v8 offset:44032
    s_waitcnt lgkmcnt(6)
    v_mfma_f32_32x32x16_bf16 v[16:31], v[96:99], a[200:203], v[16:31]
    v_mfma_f32_32x32x16_bf16 v[32:47], v[100:103], a[200:203], v[32:47]
    ds_read_b128 v[96:99], v8 offset:45056
    ds_read_b128 v[100:103], v8 offset:46080
    s_waitcnt lgkmcnt(6)
    v_mfma_f32_32x32x16_bf16 v[16:31], v[104:107], a[204:207], v[16:31]
    v_mfma_f32_32x32x16_bf16 v[32:47], v[108:111], a[204:207], v[32:47]
    s_add_u32 m0, s84, 101376
    s_add_u32 s3, s83, 232448
    buffer_load_dwordx4 v13, s[48:51], s3 offen sc1 lds
    ds_read_b128 v[104:107], v8 offset:47104
    ds_read_b128 v[108:111], v8 offset:48128
    s_waitcnt lgkmcnt(6)
    v_mfma_f32_32x32x16_bf16 v[16:31], v[80:83], a[208:211], v[16:31]
    v_mfma_f32_32x32x16_bf16 v[32:47], v[84:87], a[208:211], v[32:47]
    ds_read_b128 v[80:83], v8 offset:49152
    ds_read_b128 v[84:87], v8 offset:50176
    s_waitcnt lgkmcnt(6)
    v_mfma_f32_32x32x16_bf16 v[16:31], v[88:91], a[212:215], v[16:31]
    v_mfma_f32_32x32x16_bf16 v[32:47], v[92:95], a[212:215], v[32:47]
    s_add_u32 m0, s84, 102400
    s_add_u32 s3, s83, 233472
    buffer_load_dwordx4 v13, s[48:51], s3 offen sc1 lds
    ds_read_b128 v[88:91], v8 offset:51200
    ds_read_b128 v[92:95], v8 offset:52224
    s_waitcnt lgkmcnt(6)
    v_mfma_f32_32x32x16_bf16 v[16:31], v[96:99], a[216:219], v[16:31]
    v_mfma_f32_32x32x16_bf16 v[32:47], v[100:103], a[216:219], v[32:47]
    ds_read_b128 v[96:99], v8 offset:53248
    ds_read_b128 v[100:103], v8 offset:54272
    s_waitcnt lgkmcnt(6)
    v_mfma_f32_32x32x16_bf16 v[16:31], v[104:107], a[220:223], v[16:31]
    v_mfma_f32_32x32x16_bf16 v[32:47], v[108:111], a[220:223], v[32:47]
    s_add_u32 m0, s84, 103424
    s_add_u32 s3, s83, 234496
    buffer_load_dwordx4 v13, s[48:51], s3 offen sc1 lds
    ds_read_b128 v[104:107], v8 offset:55296
    ds_read_b128 v[108:111], v8 offset:56320
    s_waitcnt lgkmcnt(6)
    v_mfma_f32_32x32x16_bf16 v[16:31], v[80:83], a[224:227], v[16:31]
    v_mfma_f32_32x32x16_bf16 v[32:47], v[84:87], a[224:227], v[32:47]
    ds_read_b128 v[80:83], v8 offset:57344
    ds_read_b128 v[84:87], v8 offset:58368
    s_waitcnt lgkmcnt(6)
    v_mfma_f32_32x32x16_bf16 v[16:31], v[88:91], a[228:231], v[16:31]
    v_mfma_f32_32x32x16_bf16 v[32:47], v[92:95], a[228:231], v[32:47]
    s_add_u32 m0, s84, 104448
    s_add_u32 s3, s83, 235520
    buffer_load_dwordx4 v13, s[48:51], s3 offen sc1 lds
    ds_read_b128 v[88:91], v8 offset:59392
    ds_read_b128 v[92:95], v8 offset:60416
    s_waitcnt lgkmcnt(6)
    v_mfma_f32_32x32x16_bf16 v[16:31], v[96:99], a[232:235], v[16:31]
    v_mfma_f32_32x32x16_bf16 v[32:47], v[100:103], a[232:235], v[32:47]
    ds_read_b128 v[96:99], v8 offset:61440
    ds_read_b128 v[100:103], v8 offset:62464
    s_waitcnt lgkmcnt(6)
    v_mfma_f32_32x32x16_bf16 v[16:31], v[104:107], a[236:239], v[16:31]
    v_mfma_f32_32x32x16_bf16 v[32:47], v[108:111], a[236:239], v[32:47]
    s_add_u32 m0, s84, 105472
    s_add_u32 s3, s83, 236544
    buffer_load_dwordx4 v13, s[48:51], s3 offen sc1 lds
    ds_read_b128 v[104:107], v8 offset:63488
    ds_read_b128 v[108:111], v8 offset:64512
    s_waitcnt lgkmcnt(6)
    v_mfma_f32_32x32x16_bf16 v[16:31], v[80:83], a[240:243], v[16:31]
    v_mfma_f32_32x32x16_bf16 v[32:47], v[84:87], a[240:243], v[32:47]
    s_waitcnt vmcnt(8)
    s_barrier
    ds_read_b128 v[80:83], v9 offset:0
    ds_read_b128 v[84:87], v9 offset:1024
    s_waitcnt lgkmcnt(6)
    v_mfma_f32_32x32x16_bf16 v[16:31], v[88:91], a[244:247], v[16:31]
    v_mfma_f32_32x32x16_bf16 v[32:47], v[92:95], a[244:247], v[32:47]
    s_add_u32 m0, s87, 0
    s_add_u32 s3, s88, 0
    buffer_load_dwordx4 v12, s[32:35], s3 offen lds
    ds_read_b128 v[88:91], v9 offset:2048
    ds_read_b128 v[92:95], v9 offset:3072
    s_waitcnt lgkmcnt(6)
    v_mfma_f32_32x32x16_bf16 v[16:31], v[96:99], a[248:251], v[16:31]
    v_mfma_f32_32x32x16_bf16 v[32:47], v[100:103], a[248:251], v[32:47]
    ds_read_b128 v[96:99], v9 offset:4096
    ds_read_b128 v[100:103], v9 offset:5120
    s_waitcnt lgkmcnt(6)
    v_mfma_f32_32x32x16_bf16 v[16:31], v[104:107], a[252:255], v[16:31]
    v_mfma_f32_32x32x16_bf16 v[32:47], v[108:111], a[252:255], v[32:47]
    s_add_u32 m0, s87, 1024
    s_add_u32 s3, s88, 8192
    buffer_load_dwordx4 v12, s[32:35], s3 offen lds
    ds_read_b128 v[104:107], v9 offset:6144
    ds_read_b128 v[108:111], v9 offset:7168
    s_waitcnt vmcnt(63)
    s_waitcnt lgkmcnt(6)
    v_mfma_f32_32x32x16_bf16 v[16:31], v[80:83], v[128:131], v[16:31]
    v_mfma_f32_32x32x16_bf16 v[32:47], v[84:87], v[128:131], v[32:47]
    ds_read_b128 v[80:83], v9 offset:8192
    ds_read_b128 v[84:87], v9 offset:9216
    s_waitcnt vmcnt(63)
    s_waitcnt lgkmcnt(6)
    v_mfma_f32_32x32x16_bf16 v[16:31], v[88:91], v[132:135], v[16:31]
    v_mfma_f32_32x32x16_bf16 v[32:47], v[92:95], v[132:135], v[32:47]
    s_add_u32 m0, s87, 2048
    s_add_u32 s3, s88, 16384
    buffer_load_dwordx4 v12, s[32:35], s3 offen lds
    ds_read_b128 v[88:91], v9 offset:10240
    ds_read_b128 v[92:95], v9 offset:11264
    s_waitcnt vmcnt(63)
    s_waitcnt lgkmcnt(6)
    v_mfma_f32_32x32x16_bf16 v[16:31], v[96:99], v[136:139], v[16:31]
    v_mfma_f32_32x32x16_bf16 v[32:47], v[100:103], v[136:139], v[32:47]
    ds_read_b128 v[96:99], v9 offset:12288
    ds_read_b128 v[100:103], v9 offset:13312
    s_waitcnt vmcnt(63)
    s_waitcnt lgkmcnt(6)
    v_mfma_f32_32x32x16_bf16 v[16:31], v[104:107], v[140:143], v[16:31]
    v_mfma_f32_32x32x16_bf16 v[32:47], v[108:111], v[140:143], v[32:47]
    s_add_u32 m0, s87, 3072
    s_add_u32 s3, s88, 24576
    buffer_load_dwordx4 v12, s[32:35], s3 offen lds
    ds_read_b128 v[104:107], v9 offset:14336
    ds_read_b128 v[108:111], v9 offset:15360
    s_waitcnt vmcnt(63)
    s_waitcnt lgkmcnt(6)
    v_mfma_f32_32x32x16_bf16 v[16:31], v[80:83], v[144:147], v[16:31]
    v_mfma_f32_32x32x16_bf16 v[32:47], v[84:87], v[144:147], v[32:47]
    ds_read_b128 v[80:83], v9 offset:16384
    ds_read_b128 v[84:87], v9 offset:17408
    s_waitcnt vmcnt(63)
    s_waitcnt lgkmcnt(6)
    v_mfma_f32_32x32x16_bf16 v[16:31], v[88:91], v[148:151], v[16:31]
    v_mfma_f32_32x32x16_bf16 v[32:47], v[92:95], v[148:151], v[32:47]
    s_add_u32 m0, s87, 4096
    s_add_u32 s3, s88, 32768
    buffer_load_dwordx4 v12, s[32:35], s3 offen lds
    ds_read_b128 v[88:91], v9 offset:18432
    ds_read_b128 v[92:95], v9 offset:19456
    s_waitcnt vmcnt(63)
    s_waitcnt lgkmcnt(6)
    v_mfma_f32_32x32x16_bf16 v[16:31], v[96:99], v[152:155], v[16:31]
    v_mfma_f32_32x32x16_bf16 v[32:47], v[100:103], v[152:155], v[32:47]
    ds_read_b128 v[96:99], v9 offset:20480
    ds_read_b128 v[100:103], v9 offset:21504
    s_waitcnt vmcnt(63)
    s_waitcnt lgkmcnt(6)
    v_mfma_f32_32x32x16_bf16 v[16:31], v[104:107], v[156:159], v[16:31]
    v_mfma_f32_32x32x16_bf16 v[32:47], v[108:111], v[156:159], v[32:47]
    s_add_u32 m0, s87, 5120
    s_add_u32 s3, s88, 40960
    buffer_load_dwordx4 v12, s[32:35], s3 offen lds
    ds_read_b128 v[104:107], v9 offset:22528
    ds_read_b128 v[108:111], v9 offset:23552
    s_waitcnt vmcnt(63)
    s_waitcnt lgkmcnt(6)
    v_mfma_f32_32x32x16_bf16 v[16:31], v[80:83], v[160:163], v[16:31]
    v_mfma_f32_32x32x16_bf16 v[32:47], v[84:87], v[160:163], v[32:47]
    ds_read_b128 v[80:83], v9 offset:24576
    ds_read_b128 v[84:87], v9 offset:25600
    s_waitcnt vmcnt(63)
    s_waitcnt lgkmcnt(6)
    v_mfma_f32_32x32x16_bf16 v[16:31], v[88:91], v[164:167], v[16:31]
    v_mfma_f32_32x32x16_bf16 v[32:47], v[92:95], v[164:167], v[32:47]
    s_add_u32 m0, s87, 6144
    s_add_u32 s3, s88, 49152
    buffer_load_dwordx4 v12, s[32:35], s3 offen lds
    ds_read_b128 v[88:91], v9 offset:26624
    ds_read_b128 v[92:95], v9 offset:27648
    s_waitcnt vmcnt(63)
    s_waitcnt lgkmcnt(6)
    v_mfma_f32_32x32x16_bf16 v[16:31], v[96:99], v[168:171], v[16:31]
    v_mfma_f32_32x32x16_bf16 v[32:47], v[100:103], v[168:171], v[32:47]
    ds_read_b128 v[96:99], v9 offset:28672
    ds_read_b128 v[100:103], v9 offset:29696
    s_waitcnt vmcnt(62)
    s_waitcnt lgkmcnt(6)
    v_mfma_f32_32x32x16_bf16 v[16:31], v[104:107], v[172:175], v[16:31]
    v_mfma_f32_32x32x16_bf16 v[32:47], v[108:111], v[172:175], v[32:47]
    s_add_u32 m0, s87, 7168
    s_add_u32 s3, s88, 57344
    buffer_load_dwordx4 v12, s[32:35], s3 offen lds
    ds_read_b128 v[104:107], v9 offset:30720
    ds_read_b128 v[108:111], v9 offset:31744
    s_waitcnt vmcnt(61)
    s_waitcnt lgkmcnt(6)
    v_mfma_f32_32x32x16_bf16 v[16:31], v[80:83], v[176:179], v[16:31]
    v_mfma_f32_32x32x16_bf16 v[32:47], v[84:87], v[176:179], v[32:47]
    s_waitcnt vmcnt(8)
    s_barrier
    ds_read_b128 v[80:83], v9 offset:32768
    ds_read_b128 v[84:87], v9 offset:33792
    s_waitcnt vmcnt(59)
    s_waitcnt lgkmcnt(6)
    v_mfma_f32_32x32x16_bf16 v[16:31], v[88:91], v[180:183], v[16:31]
    v_mfma_f32_32x32x16_bf16 v[32:47], v[92:95], v[180:183], v[32:47]
    s_add_u32 m0, s87, 32768
    s_add_u32 s3, s88, 262144
    buffer_load_dwordx4 v12, s[32:35], s3 offen lds
    ds_read_b128 v[88:91], v9 offset:34816
    ds_read_b128 v[92:95], v9 offset:35840
    s_waitcnt vmcnt(58)
    s_waitcnt lgkmcnt(6)
    v_mfma_f32_32x32x16_bf16 v[16:31], v[96:99], v[184:187], v[16:31]
    v_mfma_f32_32x32x16_bf16 v[32:47], v[100:103], v[184:187], v[32:47]
    ds_read_b128 v[96:99], v9 offset:36864
    ds_read_b128 v[100:103], v9 offset:37888
    s_waitcnt vmcnt(56)
    s_waitcnt lgkmcnt(6)
    v_mfma_f32_32x32x16_bf16 v[16:31], v[104:107], v[188:191], v[16:31]
    v_mfma_f32_32x32x16_bf16 v[32:47], v[108:111], v[188:191], v[32:47]
    s_add_u32 m0, s87, 33792
    s_add_u32 s3, s88, 270336
    buffer_load_dwordx4 v12, s[32:35], s3 offen lds
    ds_read_b128 v[104:107], v9 offset:38912
    ds_read_b128 v[108:111], v9 offset:39936
    s_waitcnt vmcnt(55)
    s_waitcnt lgkmcnt(6)
    v_mfma_f32_32x32x16_bf16 v[16:31], v[80:83], v[192:195], v[16:31]
    v_mfma_f32_32x32x16_bf16 v[32:47], v[84:87], v[192:195], v[32:47]
    ds_read_b128 v[80:83], v9 offset:40960
    ds_read_b128 v[84:87], v9 offset:41984
    s_waitcnt vmcnt(53)
    s_waitcnt lgkmcnt(6)
    v_mfma_f32_32x32x16_bf16 v[16:31], v[88:91], v[196:199], v[16:31]
    v_mfma_f32_32x32x16_bf16 v[32:47], v[92:95], v[196:199], v[32:47]
    s_add_u32 m0, s87, 34816
    s_add_u32 s3, s88, 278528
    buffer_load_dwordx4 v12, s[32:35], s3 offen lds
    ds_read_b128 v[88:91], v9 offset:43008
    ds_read_b128 v[92:95], v9 offset:44032
    s_waitcnt vmcnt(52)
    s_waitcnt lgkmcnt(6)
    v_mfma_f32_32x32x16_bf16 v[16:31], v[96:99], v[200:203], v[16:31]
    v_mfma_f32_32x32x16_bf16 v[32:47], v[100:103], v[200:203], v[32:47]
    ds_read_b128 v[96:99], v9 offset:45056
    ds_read_b128 v[100:103], v9 offset:46080
    s_waitcnt vmcnt(50)
    s_waitcnt lgkmcnt(6)
    v_mfma_f32_32x32x16_bf16 v[16:31], v[104:107], v[204:207], v[16:31]
    v_mfma_f32_32x32x16_bf16 v[32:47], v[108:111], v[204:207], v[32:47]
    s_add_u32 m0, s87, 35840
    s_add_u32 s3, s88, 286720
    buffer_load_dwordx4 v12, s[32:35], s3 offen lds
    ds_read_b128 v[104:107], v9 offset:47104
    ds_read_b128 v[108:111], v9 offset:48128
    s_waitcnt vmcnt(49)
    s_waitcnt lgkmcnt(6)
    v_mfma_f32_32x32x16_bf16 v[16:31], v[80:83], v[208:211], v[16:31]
    v_mfma_f32_32x32x16_bf16 v[32:47], v[84:87], v[208:211], v[32:47]
    ds_read_b128 v[80:83], v9 offset:49152
    ds_read_b128 v[84:87], v9 offset:50176
    s_waitcnt vmcnt(47)
    s_waitcnt lgkmcnt(6)
    v_mfma_f32_32x32x16_bf16 v[16:31], v[88:91], v[212:215], v[16:31]
    v_mfma_f32_32x32x16_bf16 v[32:47], v[92:95], v[212:215], v[32:47]
    s_add_u32 m0, s87, 36864
    s_add_u32 s3, s88, 294912
    buffer_load_dwordx4 v12, s[32:35], s3 offen lds
    ds_read_b128 v[88:91], v9 offset:51200
    ds_read_b128 v[92:95], v9 offset:52224
    s_waitcnt vmcnt(46)
    s_waitcnt lgkmcnt(6)
    v_mfma_f32_32x32x16_bf16 v[16:31], v[96:99], v[216:219], v[16:31]
    v_mfma_f32_32x32x16_bf16 v[32:47], v[100:103], v[216:219], v[32:47]
    ds_read_b128 v[96:99], v9 offset:53248
    ds_read_b128 v[100:103], v9 offset:54272
    s_waitcnt vmcnt(44)
    s_waitcnt lgkmcnt(6)
    v_mfma_f32_32x32x16_bf16 v[16:31], v[104:107], v[220:223], v[16:31]
    v_mfma_f32_32x32x16_bf16 v[32:47], v[108:111], v[220:223], v[32:47]
    s_add_u32 m0, s87, 37888
    s_add_u32 s3, s88, 303104
    buffer_load_dwordx4 v12, s[32:35], s3 offen lds
    ds_read_b128 v[104:107], v9 offset:55296
    ds_read_b128 v[108:111], v9 offset:56320
    s_waitcnt vmcnt(43)
    s_waitcnt lgkmcnt(6)
    v_mfma_f32_32x32x16_bf16 v[16:31], v[80:83], v[224:227], v[16:31]
    v_mfma_f32_32x32x16_bf16 v[32:47], v[84:87], v[224:227], v[32:47]
    ds_read_b128 v[80:83], v9 offset:57344
    ds_read_b128 v[84:87], v9 offset:58368
    s_waitcnt vmcnt(41)
    s_waitcnt lgkmcnt(6)
    v_mfma_f32_32x32x16_bf16 v[16:31], v[88:91], v[228:231], v[16:31]
    v_mfma_f32_32x32x16_bf16 v[32:47], v[92:95], v[228:231], v[32:47]
    s_add_u32 m0, s87, 38912
    s_add_u32 s3, s88, 311296
    buffer_load_dwordx4 v12, s[32:35], s3 offen lds
    ds_read_b128 v[88:91], v9 offset:59392
    ds_read_b128 v[92:95], v9 offset:60416
    s_waitcnt vmcnt(40)
    s_waitcnt lgkmcnt(6)
    v_mfma_f32_32x32x16_bf16 v[16:31], v[96:99], v[232:235], v[16:31]
    v_mfma_f32_32x32x16_bf16 v[32:47], v[100:103], v[232:235], v[32:47]
    ds_read_b128 v[96:99], v9 offset:61440
    ds_read_b128 v[100:103], v9 offset:62464
    s_waitcnt vmcnt(38)
    s_waitcnt lgkmcnt(6)
    v_mfma_f32_32x32x16_bf16 v[16:31], v[104:107], v[236:239], v[16:31]
    v_mfma_f32_32x32x16_bf16 v[32:47], v[108:111], v[236:239], v[32:47]
    s_add_u32 m0, s87, 39936
    s_add_u32 s3, s88, 319488
    buffer_load_dwordx4 v12, s[32:35], s3 offen lds
    ds_read_b128 v[104:107], v9 offset:63488
    ds_read_b128 v[108:111], v9 offset:64512
    s_waitcnt vmcnt(37)
    s_waitcnt lgkmcnt(6)
    v_mfma_f32_32x32x16_bf16 v[16:31], v[80:83], v[240:243], v[16:31]
    v_mfma_f32_32x32x16_bf16 v[32:47], v[84:87], v[240:243], v[32:47]
    s_waitcnt vmcnt(35)
    s_waitcnt lgkmcnt(4)
    v_mfma_f32_32x32x16_bf16 v[16:31], v[88:91], v[244:247], v[16:31]
    v_mfma_f32_32x32x16_bf16 v[32:47], v[92:95], v[244:247], v[32:47]
    s_waitcnt vmcnt(33)
    s_waitcnt lgkmcnt(2)
    v_mfma_f32_32x32x16_bf16 v[16:31], v[96:99], v[248:251], v[16:31]
    v_mfma_f32_32x32x16_bf16 v[32:47], v[100:103], v[248:251], v[32:47]
    s_waitcnt vmcnt(31)
    s_waitcnt lgkmcnt(0)
    v_mfma_f32_32x32x16_bf16 v[16:31], v[104:107], v[252:255], v[16:31]
    v_mfma_f32_32x32x16_bf16 v[32:47], v[108:111], v[252:255], v[32:47]
    s_barrier
    v_lshlrev_b32 v15, 16, v15
    s_lshl_b32 s76, s76, 0
    s_mul_i32 s76, s76, 56
    s_lshl_b32 s3, s81, 2
    s_add_u32 s76, s76, s3
    s_lshl_b32 s76, s76, 10
    s_add_u32 s76, s76, 16777216
    s_nop 7
    v_lshlrev_b32 v10, 16, v112
    v_and_b32 v11, 0xffff0000, v112
    v_add_f32 v16, v16, v15
    v_add_f32 v17, v17, v15
    v_mul_f32 v16, v16, v10
    v_mul_f32 v17, v17, v11
    v_lshlrev_b32 v10, 16, v113
    v_and_b32 v11, 0xffff0000, v113
    v_add_f32 v18, v18, v15
    v_add_f32 v19, v19, v15
    v_mul_f32 v18, v18, v10
    v_mul_f32 v19, v19, v11
    v_lshlrev_b32 v10, 16, v114
    v_and_b32 v11, 0xffff0000, v114
    v_add_f32 v20, v20, v15
    v_add_f32 v21, v21, v15
    v_mul_f32 v20, v20, v10
    v_mul_f32 v21, v21, v11
    v_lshlrev_b32 v10, 16, v115
    v_and_b32 v11, 0xffff0000, v115
    v_add_f32 v22, v22, v15
    v_add_f32 v23, v23, v15
    v_mul_f32 v22, v22, v10
    v_mul_f32 v23, v23, v11
    v_lshlrev_b32 v10, 16, v116
    v_and_b32 v11, 0xffff0000, v116
    v_add_f32 v24, v24, v15
    v_add_f32 v25, v25, v15
    v_mul_f32 v24, v24, v10
    v_mul_f32 v25, v25, v11
    v_lshlrev_b32 v10, 16, v117
    v_and_b32 v11, 0xffff0000, v117
    v_add_f32 v26, v26, v15
    v_add_f32 v27, v27, v15
    v_mul_f32 v26, v26, v10
    v_mul_f32 v27, v27, v11
    v_lshlrev_b32 v10, 16, v118
    v_and_b32 v11, 0xffff0000, v118
    v_add_f32 v28, v28, v15
    v_add_f32 v29, v29, v15
    v_mul_f32 v28, v28, v10
    v_mul_f32 v29, v29, v11
    v_lshlrev_b32 v10, 16, v119
    v_and_b32 v11, 0xffff0000, v119
    v_add_f32 v30, v30, v15
    v_add_f32 v31, v31, v15
    v_mul_f32 v30, v30, v10
    v_mul_f32 v31, v31, v11
    v_lshlrev_b32 v10, 16, v120
    v_and_b32 v11, 0xffff0000, v120
    v_add_f32 v32, v32, v15
    v_add_f32 v33, v33, v15
    v_mul_f32 v32, v32, v10
    v_mul_f32 v33, v33, v11
    v_lshlrev_b32 v10, 16, v121
    v_and_b32 v11, 0xffff0000, v121
    v_add_f32 v34, v34, v15
    v_add_f32 v35, v35, v15
    v_mul_f32 v34, v34, v10
    v_mul_f32 v35, v35, v11
    v_lshlrev_b32 v10, 16, v122
    v_and_b32 v11, 0xffff0000, v122
    v_add_f32 v36, v36, v15
    v_add_f32 v37, v37, v15
    v_mul_f32 v36, v36, v10
    v_mul_f32 v37, v37, v11
    v_lshlrev_b32 v10, 16, v123
    v_and_b32 v11, 0xffff0000, v123
    v_add_f32 v38, v38, v15
    v_add_f32 v39, v39, v15
    v_mul_f32 v38, v38, v10
    v_mul_f32 v39, v39, v11
    v_lshlrev_b32 v10, 16, v124
    v_and_b32 v11, 0xffff0000, v124
    v_add_f32 v40, v40, v15
    v_add_f32 v41, v41, v15
    v_mul_f32 v40, v40, v10
    v_mul_f32 v41, v41, v11
    v_lshlrev_b32 v10, 16, v125
    v_and_b32 v11, 0xffff0000, v125
    v_add_f32 v42, v42, v15
    v_add_f32 v43, v43, v15
    v_mul_f32 v42, v42, v10
    v_mul_f32 v43, v43, v11
    v_lshlrev_b32 v10, 16, v126
    v_and_b32 v11, 0xffff0000, v126
    v_add_f32 v44, v44, v15
    v_add_f32 v45, v45, v15
    v_mul_f32 v44, v44, v10
    v_mul_f32 v45, v45, v11
    v_lshlrev_b32 v10, 16, v127
    v_and_b32 v11, 0xffff0000, v127
    v_add_f32 v46, v46, v15
    v_add_f32 v47, v47, v15
    v_mul_f32 v46, v46, v10
    v_mul_f32 v47, v47, v11
    v_cvt_pk_bf16_f32 v48, v16, v17
    v_cvt_pk_bf16_f32 v49, v18, v19
    v_cvt_pk_bf16_f32 v50, v20, v21
    v_cvt_pk_bf16_f32 v51, v22, v23
    s_nop 0
    v_permlane32_swap_b32 v48, v50
    v_permlane32_swap_b32 v49, v51
    buffer_store_dwordx4 v[48:51], v13, s[48:51], s76 offen offset:0 sc1
    v_cvt_pk_bf16_f32 v52, v24, v25
    v_cvt_pk_bf16_f32 v53, v26, v27
    v_cvt_pk_bf16_f32 v54, v28, v29
    v_cvt_pk_bf16_f32 v55, v30, v31
    s_nop 0
    v_permlane32_swap_b32 v52, v54
    v_permlane32_swap_b32 v53, v55
    buffer_store_dwordx4 v[52:55], v13, s[48:51], s76 offen offset:1024 sc1
    v_cvt_pk_bf16_f32 v56, v32, v33
    v_cvt_pk_bf16_f32 v57, v34, v35
    v_cvt_pk_bf16_f32 v58, v36, v37
    v_cvt_pk_bf16_f32 v59, v38, v39
    s_nop 0
    v_permlane32_swap_b32 v56, v58
    v_permlane32_swap_b32 v57, v59
    buffer_store_dwordx4 v[56:59], v13, s[48:51], s76 offen offset:2048 sc1
    v_cvt_pk_bf16_f32 v60, v40, v41
    v_cvt_pk_bf16_f32 v61, v42, v43
    v_cvt_pk_bf16_f32 v62, v44, v45
    v_cvt_pk_bf16_f32 v63, v46, v47
    s_nop 0
    v_permlane32_swap_b32 v60, v62
    v_permlane32_swap_b32 v61, v63
    buffer_store_dwordx4 v[60:63], v13, s[48:51], s76 offen offset:3072 sc1
    s_mul_i32 s87, s6, 12288
    s_add_u32 s87, s87, 65536
    s_mul_i32 s88, s6, 98304
    s_lshl_b32 s3, s71, 7
    s_add_u32 s88, s88, s3
    s_add_u32 s88, s88, 524288
    s_add_u32 m0, s87, 0
    s_add_u32 s3, s88, 0
    buffer_load_dwordx4 v12, s[32:35], s3 offen lds
    s_add_u32 m0, s87, 1024
    s_add_u32 s3, s88, 8192
    buffer_load_dwordx4 v12, s[32:35], s3 offen lds
    s_add_u32 m0, s87, 2048
    s_add_u32 s3, s88, 16384
    buffer_load_dwordx4 v12, s[32:35], s3 offen lds
    s_add_u32 m0, s87, 3072
    s_add_u32 s3, s88, 24576
    buffer_load_dwordx4 v12, s[32:35], s3 offen lds
    s_add_u32 m0, s87, 4096
    s_add_u32 s3, s88, 32768
    buffer_load_dwordx4 v12, s[32:35], s3 offen lds
    s_add_u32 m0, s87, 5120
    s_add_u32 s3, s88, 40960
    buffer_load_dwordx4 v12, s[32:35], s3 offen lds
    s_add_u32 m0, s87, 6144
    s_add_u32 s3, s88, 49152
    buffer_load_dwordx4 v12, s[32:35], s3 offen lds
    s_add_u32 m0, s87, 7168
    s_add_u32 s3, s88, 57344
    buffer_load_dwordx4 v12, s[32:35], s3 offen lds
    s_add_u32 m0, s87, 8192
    s_add_u32 s3, s88, 65536
    buffer_load_dwordx4 v12, s[32:35], s3 offen lds
    s_add_u32 m0, s87, 9216
    s_add_u32 s3, s88, 73728
    buffer_load_dwordx4 v12, s[32:35], s3 offen lds
    s_add_u32 m0, s87, 10240
    s_add_u32 s3, s88, 81920
    buffer_load_dwordx4 v12, s[32:35], s3 offen lds
    s_add_u32 m0, s87, 11264
    s_add_u32 s3, s88, 90112
    buffer_load_dwordx4 v12, s[32:35], s3 offen lds
    s_waitcnt vmcnt(12)
    s_barrier
    s_cmp_lg_u32 s6, 0
    s_cbranch_scc1 SG_43
    v_lshrrev_b32 v4, 3, v1
    s_and_b32 s3, s80, 1
    s_lshl_b32 s3, s3, 1
    v_add_u32 v4, s3, v4
    v_lshlrev_b32 v4, 6, v4
    v_and_b32 v5, 7, v1
    v_lshl_add_u32 v5, v5, 3, v4
    s_lshr_b32 s3, s80, 1
    v_add_u32 v5, s3, v5
    s_lshl_b32 s3, s81, 2
    v_lshl_add_u32 v5, v5, 7, s3
    s_mov_b32 s3, 229376
    v_mov_b32 v4, s7
    s_mov_b32 exec_lo, 0xffff
    s_mov_b32 exec_hi, 0x0
    buffer_store_dword v4, v5, s[48:51], s3 offen sc0 sc1
    s_mov_b64 exec, -1
SG_43:
    s_branch P6MAIN
P6START:
    s_lshl_b32 s76, s71, 7
    v_lshrrev_b32 v11, 3, v1
    v_bfe_u32 v12, v1, 2, 1
    v_bfe_u32 v10, v1, 4, 1
    v_xor_b32 v12, v12, v10
    v_lshlrev_b32 v12, 6, v12
    v_and_b32 v10, 3, v1
    v_lshl_add_u32 v10, v10, 4, v12
    v_mul_u32_u24 v11, 1024, v11
    v_add_u32 v10, v10, v11
    s_mul_i32 s68, s6, 229376
    s_add_u32 s68, s68, s76
    s_mul_i32 s69, s6, 28672
    s_add_u32 m0, s69, 0
    s_add_u32 s3, s68, 0
    buffer_load_dwordx4 v10, s[32:35], s3 offen lds
    s_add_u32 m0, s69, 1024
    s_add_u32 s3, s68, 8192
    buffer_load_dwordx4 v10, s[32:35], s3 offen lds
    s_add_u32 m0, s69, 2048
    s_add_u32 s3, s68, 16384
    buffer_load_dwordx4 v10, s[32:35], s3 offen lds
    s_add_u32 m0, s69, 3072
    s_add_u32 s3, s68, 24576
    buffer_load_dwordx4 v10, s[32:35], s3 offen lds
    s_add_u32 m0, s69, 4096
    s_add_u32 s3, s68, 32768
    buffer_load_dwordx4 v10, s[32:35], s3 offen lds
    s_add_u32 m0, s69, 5120
    s_add_u32 s3, s68, 40960
    buffer_load_dwordx4 v10, s[32:35], s3 offen lds
    s_add_u32 m0, s69, 6144
    s_add_u32 s3, s68, 49152
    buffer_load_dwordx4 v10, s[32:35], s3 offen lds
    s_add_u32 m0, s69, 7168
    s_add_u32 s3, s68, 57344
    buffer_load_dwordx4 v10, s[32:35], s3 offen lds
    s_add_u32 m0, s69, 8192
    s_add_u32 s3, s68, 65536
    buffer_load_dwordx4 v10, s[32:35], s3 offen lds
    s_add_u32 m0, s69, 9216
    s_add_u32 s3, s68, 73728
    buffer_load_dwordx4 v10, s[32:35], s3 offen lds
    s_add_u32 m0, s69, 10240
    s_add_u32 s3, s68, 81920
    buffer_load_dwordx4 v10, s[32:35], s3 offen lds
    s_add_u32 m0, s69, 11264
    s_add_u32 s3, s68, 90112
    buffer_load_dwordx4 v10, s[32:35], s3 offen lds
    s_add_u32 m0, s69, 12288
    s_add_u32 s3, s68, 98304
    buffer_load_dwordx4 v10, s[32:35], s3 offen lds
    s_add_u32 m0, s69, 13312
    s_add_u32 s3, s68, 106496
    buffer_load_dwordx4 v10, s[32:35], s3 offen lds
    s_add_u32 m0, s69, 14336
    s_add_u32 s3, s68, 114688
    buffer_load_dwordx4 v10, s[32:35], s3 offen lds
    s_add_u32 m0, s69, 15360
    s_add_u32 s3, s68, 122880
    buffer_load_dwordx4 v10, s[32:35], s3 offen lds
    s_add_u32 m0, s69, 16384
    s_add_u32 s3, s68, 131072
    buffer_load_dwordx4 v10, s[32:35], s3 offen lds
    s_add_u32 m0, s69, 17408
    s_add_u32 s3, s68, 139264
    buffer_load_dwordx4 v10, s[32:35], s3 offen lds
    s_add_u32 m0, s69, 18432
    s_add_u32 s3, s68, 147456
    buffer_load_dwordx4 v10, s[32:35], s3 offen lds
    s_add_u32 m0, s69, 19456
    s_add_u32 s3, s68, 155648
    buffer_load_dwordx4 v10, s[32:35], s3 offen lds
    s_add_u32 m0, s69, 20480
    s_add_u32 s3, s68, 163840
    buffer_load_dwordx4 v10, s[32:35], s3 offen lds
    s_add_u32 m0, s69, 21504
    s_add_u32 s3, s68, 172032
    buffer_load_dwordx4 v10, s[32:35], s3 offen lds
    s_add_u32 m0, s69, 22528
    s_add_u32 s3, s68, 180224
    buffer_load_dwordx4 v10, s[32:35], s3 offen lds
    s_add_u32 m0, s69, 23552
    s_add_u32 s3, s68, 188416
    buffer_load_dwordx4 v10, s[32:35], s3 offen lds
    s_add_u32 m0, s69, 24576
    s_add_u32 s3, s68, 196608
    buffer_load_dwordx4 v10, s[32:35], s3 offen lds
    s_add_u32 m0, s69, 25600
    s_add_u32 s3, s68, 204800
    buffer_load_dwordx4 v10, s[32:35], s3 offen lds
    s_add_u32 m0, s69, 26624
    s_add_u32 s3, s68, 212992
    buffer_load_dwordx4 v10, s[32:35], s3 offen lds
    s_add_u32 m0, s69, 27648
    s_add_u32 s3, s68, 221184
    buffer_load_dwordx4 v10, s[32:35], s3 offen lds
    s_sub_u32 s52, s5, 28
    s_lshl_b32 s3, s52, 2
    s_add_u32 s3, s3, s6
    s_mul_i32 s76, s3, 57344
    s_and_b32 s77, s4, 3
    s_lshl_b32 s77, s77, 4
    s_add_u32 s77, s77, s3
    s_lshl_b32 s77, s77, 17
    s_add_u32 s77, s77, 21069824
    v_lshlrev_b32 v13, 4, v1
    s_add_u32 s3, s77, 0
    buffer_load_dwordx4 v[128:131], v13, s[48:51], s3 offen sc1
    s_add_u32 s3, s77, 1024
    buffer_load_dwordx4 v[132:135], v13, s[48:51], s3 offen sc1
    s_add_u32 s3, s77, 2048
    buffer_load_dwordx4 v[136:139], v13, s[48:51], s3 offen sc1
    s_add_u32 s3, s77, 3072
    buffer_load_dwordx4 v[140:143], v13, s[48:51], s3 offen sc1
    s_add_u32 s3, s77, 4096
    buffer_load_dwordx4 v[144:147], v13, s[48:51], s3 offen sc1
    s_add_u32 s3, s77, 5120
    buffer_load_dwordx4 v[148:151], v13, s[48:51], s3 offen sc1
    s_add_u32 s3, s77, 6144
    buffer_load_dwordx4 v[152:155], v13, s[48:51], s3 offen sc1
    s_add_u32 s3, s77, 7168
    buffer_load_dwordx4 v[156:159], v13, s[48:51], s3 offen sc1
    s_add_u32 s3, s77, 8192
    buffer_load_dwordx4 v[128:131], v13, s[48:51], s3 offen sc1
    s_add_u32 s3, s77, 9216
    buffer_load_dwordx4 v[132:135], v13, s[48:51], s3 offen sc1
    s_add_u32 s3, s77, 10240
    buffer_load_dwordx4 v[136:139], v13, s[48:51], s3 offen sc1
    s_add_u32 s3, s77, 11264
    buffer_load_dwordx4 v[140:143], v13, s[48:51], s3 offen sc1
    s_add_u32 s3, s77, 12288
    buffer_load_dwordx4 v[144:147], v13, s[48:51], s3 offen sc1
    s_add_u32 s3, s77, 13312
    buffer_load_dwordx4 v[148:151], v13, s[48:51], s3 offen sc1
    s_add_u32 s3, s77, 14336
    buffer_load_dwordx4 v[152:155], v13, s[48:51], s3 offen sc1
    s_add_u32 s3, s77, 15360
    buffer_load_dwordx4 v[156:159], v13, s[48:51], s3 offen sc1
    s_add_u32 s3, s77, 16384
    buffer_load_dwordx4 v[128:131], v13, s[48:51], s3 offen sc1
    s_add_u32 s3, s77, 17408
    buffer_load_dwordx4 v[132:135], v13, s[48:51], s3 offen sc1
    s_add_u32 s3, s77, 18432
    buffer_load_dwordx4 v[136:139], v13, s[48:51], s3 offen sc1
    s_add_u32 s3, s77, 19456
    buffer_load_dwordx4 v[140:143], v13, s[48:51], s3 offen sc1
    s_add_u32 s3, s77, 20480
    buffer_load_dwordx4 v[144:147], v13, s[48:51], s3 offen sc1
    s_add_u32 s3, s77, 21504
    buffer_load_dwordx4 v[148:151], v13, s[48:51], s3 offen sc1
    s_add_u32 s3, s77, 22528
    buffer_load_dwordx4 v[152:155], v13, s[48:51], s3 offen sc1
    s_add_u32 s3, s77, 23552
    buffer_load_dwordx4 v[156:159], v13, s[48:51], s3 offen sc1
    s_add_u32 s3, s77, 24576
    buffer_load_dwordx4 v[128:131], v13, s[48:51], s3 offen sc1
    s_add_u32 s3, s77, 25600
    buffer_load_dwordx4 v[132:135], v13, s[48:51], s3 offen sc1
    s_add_u32 s3, s77, 26624
    buffer_load_dwordx4 v[136:139], v13, s[48:51], s3 offen sc1
    s_add_u32 s3, s77, 27648
    buffer_load_dwordx4 v[140:143], v13, s[48:51], s3 offen sc1
    s_add_u32 s3, s77, 28672
    buffer_load_dwordx4 v[144:147], v13, s[48:51], s3 offen sc1
    s_add_u32 s3, s77, 29696
    buffer_load_dwordx4 v[148:151], v13, s[48:51], s3 offen sc1
    s_add_u32 s3, s77, 30720
    buffer_load_dwordx4 v[152:155], v13, s[48:51], s3 offen sc1
    s_add_u32 s3, s77, 31744
    buffer_load_dwordx4 v[156:159], v13, s[48:51], s3 offen sc1
    s_add_u32 s3, s76, 0
    buffer_load_dwordx4 v[160:163], v13, s[32:35], s3 offen
    s_add_u32 s3, s76, 1024
    buffer_load_dwordx4 v[164:167], v13, s[32:35], s3 offen
    s_add_u32 s3, s76, 2048
    buffer_load_dwordx4 v[168:171], v13, s[32:35], s3 offen
    s_add_u32 s3, s76, 3072
    buffer_load_dwordx4 v[172:175], v13, s[32:35], s3 offen
    s_add_u32 s3, s76, 4096
    buffer_load_dwordx4 v[176:179], v13, s[32:35], s3 offen
    s_add_u32 s3, s76, 5120
    buffer_load_dwordx4 v[180:183], v13, s[32:35], s3 offen
    s_add_u32 s3, s76, 6144
    buffer_load_dwordx4 v[184:187], v13, s[32:35], s3 offen
    s_add_u32 s3, s76, 7168
    buffer_load_dwordx4 v[188:191], v13, s[32:35], s3 offen
    s_add_u32 s3, s76, 8192
    buffer_load_dwordx4 v[160:163], v13, s[32:35], s3 offen
    s_add_u32 s3, s76, 9216
    buffer_load_dwordx4 v[164:167], v13, s[32:35], s3 offen
    s_add_u32 s3, s76, 10240
    buffer_load_dwordx4 v[168:171], v13, s[32:35], s3 offen
    s_add_u32 s3, s76, 11264
    buffer_load_dwordx4 v[172:175], v13, s[32:35], s3 offen
    s_add_u32 s3, s76, 12288
    buffer_load_dwordx4 v[176:179], v13, s[32:35], s3 offen
    s_add_u32 s3, s76, 13312
    buffer_load_dwordx4 v[180:183], v13, s[32:35], s3 offen
    s_add_u32 s3, s76, 14336
    buffer_load_dwordx4 v[184:187], v13, s[32:35], s3 offen
    s_add_u32 s3, s76, 15360
    buffer_load_dwordx4 v[188:191], v13, s[32:35], s3 offen
    s_add_u32 s3, s76, 16384
    buffer_load_dwordx4 v[160:163], v13, s[32:35], s3 offen
    s_add_u32 s3, s76, 17408
    buffer_load_dwordx4 v[164:167], v13, s[32:35], s3 offen
    s_add_u32 s3, s76, 18432
    buffer_load_dwordx4 v[168:171], v13, s[32:35], s3 offen
    s_add_u32 s3, s76, 19456
    buffer_load_dwordx4 v[172:175], v13, s[32:35], s3 offen
    s_add_u32 s3, s76, 20480
    buffer_load_dwordx4 v[176:179], v13, s[32:35], s3 offen
    s_add_u32 s3, s76, 21504
    buffer_load_dwordx4 v[180:183], v13, s[32:35], s3 offen
    s_add_u32 s3, s76, 22528
    buffer_load_dwordx4 v[184:187], v13, s[32:35], s3 offen
    s_add_u32 s3, s76, 23552
    buffer_load_dwordx4 v[188:191], v13, s[32:35], s3 offen
    s_add_u32 s3, s76, 24576
    buffer_load_dwordx4 v[160:163], v13, s[32:35], s3 offen
    s_add_u32 s3, s76, 25600
    buffer_load_dwordx4 v[164:167], v13, s[32:35], s3 offen
    s_add_u32 s3, s76, 26624
    buffer_load_dwordx4 v[168:171], v13, s[32:35], s3 offen
    s_add_u32 s3, s76, 27648
    buffer_load_dwordx4 v[172:175], v13, s[32:35], s3 offen
    s_add_u32 s3, s76, 28672
    buffer_load_dwordx4 v[176:179], v13, s[32:35], s3 offen
    s_add_u32 s3, s76, 29696
    buffer_load_dwordx4 v[180:183], v13, s[32:35], s3 offen
    s_add_u32 s3, s76, 30720
    buffer_load_dwordx4 v[184:187], v13, s[32:35], s3 offen
    s_add_u32 s3, s76, 31744
    buffer_load_dwordx4 v[188:191], v13, s[32:35], s3 offen
    s_add_u32 s3, s76, 32768
    buffer_load_dwordx4 v[160:163], v13, s[32:35], s3 offen
    s_add_u32 s3, s76, 33792
    buffer_load_dwordx4 v[164:167], v13, s[32:35], s3 offen
    s_add_u32 s3, s76, 34816
    buffer_load_dwordx4 v[168:171], v13, s[32:35], s3 offen
    s_add_u32 s3, s76, 35840
    buffer_load_dwordx4 v[172:175], v13, s[32:35], s3 offen
    s_add_u32 s3, s76, 36864
    buffer_load_dwordx4 v[176:179], v13, s[32:35], s3 offen
    s_add_u32 s3, s76, 37888
    buffer_load_dwordx4 v[180:183], v13, s[32:35], s3 offen
    s_add_u32 s3, s76, 38912
    buffer_load_dwordx4 v[184:187], v13, s[32:35], s3 offen
    s_add_u32 s3, s76, 39936
    buffer_load_dwordx4 v[188:191], v13, s[32:35], s3 offen
    s_add_u32 s3, s76, 40960
    buffer_load_dwordx4 v[160:163], v13, s[32:35], s3 offen
    s_add_u32 s3, s76, 41984
    buffer_load_dwordx4 v[164:167], v13, s[32:35], s3 offen
    s_add_u32 s3, s76, 43008
    buffer_load_dwordx4 v[168:171], v13, s[32:35], s3 offen
    s_add_u32 s3, s76, 44032
    buffer_load_dwordx4 v[172:175], v13, s[32:35], s3 offen
    s_add_u32 s3, s76, 45056
    buffer_load_dwordx4 v[176:179], v13, s[32:35], s3 offen
    s_add_u32 s3, s76, 46080
    buffer_load_dwordx4 v[180:183], v13, s[32:35], s3 offen
    s_add_u32 s3, s76, 47104
    buffer_load_dwordx4 v[184:187], v13, s[32:35], s3 offen
    s_add_u32 s3, s76, 48128
    buffer_load_dwordx4 v[188:191], v13, s[32:35], s3 offen
    s_add_u32 s3, s76, 49152
    buffer_load_dwordx4 v[160:163], v13, s[32:35], s3 offen
    s_add_u32 s3, s76, 50176
    buffer_load_dwordx4 v[164:167], v13, s[32:35], s3 offen
    s_add_u32 s3, s76, 51200
    buffer_load_dwordx4 v[168:171], v13, s[32:35], s3 offen
    s_add_u32 s3, s76, 52224
    buffer_load_dwordx4 v[172:175], v13, s[32:35], s3 offen
    s_add_u32 s3, s76, 53248
    buffer_load_dwordx4 v[176:179], v13, s[32:35], s3 offen
    s_add_u32 s3, s76, 54272
    buffer_load_dwordx4 v[180:183], v13, s[32:35], s3 offen
    s_add_u32 s3, s76, 55296
    buffer_load_dwordx4 v[184:187], v13, s[32:35], s3 offen
    s_add_u32 s3, s76, 56320
    buffer_load_dwordx4 v[188:191], v13, s[32:35], s3 offen
P6MAIN:
    v_lshlrev_b32 v14, 4, v3
    s_lshl_b32 s77, s75, 2
    s_add_u32 s3, s77, 288768
    buffer_load_dwordx4 v[112:115], v14, s[48:51], s3 offen sc1
    s_add_u32 s3, s77, 288800
    buffer_load_dwordx4 v[116:119], v14, s[48:51], s3 offen sc1
    s_add_u32 s3, s77, 288832
    buffer_load_dwordx4 v[120:123], v14, s[48:51], s3 offen sc1
    s_add_u32 s3, s77, 288864
    buffer_load_dwordx4 v[124:127], v14, s[48:51], s3 offen sc1
    s_mul_i32 s76, s73, 57344
    v_bfe_u32 v10, v1, 2, 2
    v_lshl_add_u32 v11, v3, 3, v10
    v_lshlrev_b32 v11, 7, v11
    v_bfe_u32 v12, v1, 4, 1
    v_lshl_add_u32 v11, v12, 5, v11
    v_and_b32 v12, 3, v1
    v_lshl_add_u32 v11, v12, 3, v11
    v_add_u32 v11, s76, v11
    v_lshrrev_b32 v10, 1, v10
    v_lshl_add_u32 v8, v10, 6, v11
    v_xor_b32 v10, 1, v10
    v_lshl_add_u32 v9, v10, 6, v11
    s_cmp_lg_u32 s6, 0
    s_cbranch_scc1 WT_45
    s_lshl_b32 s3, s2, 7
    v_and_b32 v4, 15, v1
    v_min_u32 v4, 13, v4
    v_lshl_add_u32 v4, v4, 2, s3
    s_mov_b32 s3, 229376
    s_mov_b32 s52, 262144
WL_46:
    buffer_load_dword v5, v4, s[48:51], s3 offen sc0 sc1
    s_waitcnt vmcnt(0)
    v_cmp_ne_u32 vcc, s7, v5
    s_cbranch_vccz WE_44
    s_sub_u32 s52, s52, 1
    s_cmp_lg_u32 s52, 0
    s_cbranch_scc1 WL_46
    s_branch WE_44
WT_45:
WE_44:
    s_waitcnt vmcnt(0) lgkmcnt(0)
    s_barrier
    s_mul_i32 s76, s74, 56
    s_mul_i32 s3, s73, 28
    s_add_u32 s76, s76, s3
    s_lshl_b32 s76, s76, 10
    s_add_u32 s76, s76, 16777216
    v_lshlrev_b32 v13, 4, v1
    s_add_u32 s3, s76, 0
    buffer_load_dwordx4 v[144:147], v13, s[48:51], s3 offen offset:0 sc1
    s_add_u32 s3, s76, 0
    buffer_load_dwordx4 v[148:151], v13, s[48:51], s3 offen offset:1024 sc1
    s_add_u32 s3, s76, 0
    buffer_load_dwordx4 v[152:155], v13, s[48:51], s3 offen offset:2048 sc1
    s_add_u32 s3, s76, 0
    buffer_load_dwordx4 v[156:159], v13, s[48:51], s3 offen offset:3072 sc1
    s_add_u32 s3, s76, 4096
    buffer_load_dwordx4 v[160:163], v13, s[48:51], s3 offen offset:0 sc1
    s_add_u32 s3, s76, 4096
    buffer_load_dwordx4 v[164:167], v13, s[48:51], s3 offen offset:1024 sc1
    s_add_u32 s3, s76, 4096
    buffer_load_dwordx4 v[168:171], v13, s[48:51], s3 offen offset:2048 sc1
    s_add_u32 s3, s76, 4096
    buffer_load_dwordx4 v[172:175], v13, s[48:51], s3 offen offset:3072 sc1
    s_add_u32 s3, s76, 8192
    buffer_load_dwordx4 v[176:179], v13, s[48:51], s3 offen offset:0 sc1
    s_add_u32 s3, s76, 8192
    buffer_load_dwordx4 v[180:183], v13, s[48:51], s3 offen offset:1024 sc1
    s_add_u32 s3, s76, 8192
    buffer_load_dwordx4 v[184:187], v13, s[48:51], s3 offen offset:2048 sc1
    s_add_u32 s3, s76, 8192
    buffer_load_dwordx4 v[188:191], v13, s[48:51], s3 offen offset:3072 sc1
    s_add_u32 s3, s76, 12288
    buffer_load_dwordx4 v[192:195], v13, s[48:51], s3 offen offset:0 sc1
    s_add_u32 s3, s76, 12288
    buffer_load_dwordx4 v[196:199], v13, s[48:51], s3 offen offset:1024 sc1
    s_add_u32 s3, s76, 12288
    buffer_load_dwordx4 v[200:203], v13, s[48:51], s3 offen offset:2048 sc1
    s_add_u32 s3, s76, 12288
    buffer_load_dwordx4 v[204:207], v13, s[48:51], s3 offen offset:3072 sc1
    s_add_u32 s3, s76, 16384
    buffer_load_dwordx4 v[208:211], v13, s[48:51], s3 offen offset:0 sc1
    s_add_u32 s3, s76, 16384
    buffer_load_dwordx4 v[212:215], v13, s[48:51], s3 offen offset:1024 sc1
    s_add_u32 s3, s76, 16384
    buffer_load_dwordx4 v[216:219], v13, s[48:51], s3 offen offset:2048 sc1
    s_add_u32 s3, s76, 16384
    buffer_load_dwordx4 v[220:223], v13, s[48:51], s3 offen offset:3072 sc1
    s_add_u32 s3, s76, 20480
    buffer_load_dwordx4 v[224:227], v13, s[48:51], s3 offen offset:0 sc1
    s_add_u32 s3, s76, 20480
    buffer_load_dwordx4 v[228:231], v13, s[48:51], s3 offen offset:1024 sc1
    s_add_u32 s3, s76, 20480
    buffer_load_dwordx4 v[232:235], v13, s[48:51], s3 offen offset:2048 sc1
    s_add_u32 s3, s76, 20480
    buffer_load_dwordx4 v[236:239], v13, s[48:51], s3 offen offset:3072 sc1
    s_add_u32 s3, s76, 24576
    buffer_load_dwordx4 v[240:243], v13, s[48:51], s3 offen offset:0 sc1
    s_add_u32 s3, s76, 24576
    buffer_load_dwordx4 v[244:247], v13, s[48:51], s3 offen offset:1024 sc1
    s_add_u32 s3, s76, 24576
    buffer_load_dwordx4 v[248:251], v13, s[48:51], s3 offen offset:2048 sc1
    s_add_u32 s3, s76, 24576
    buffer_load_dwordx4 v[252:255], v13, s[48:51], s3 offen offset:3072 sc1
    ds_read_b64_tr_b16 v[80:81], v8 offset:0
    ds_read_b64_tr_b16 v[82:83], v8 offset:512
    ds_read_b64_tr_b16 v[84:85], v9 offset:0
    ds_read_b64_tr_b16 v[86:87], v9 offset:512
    ds_read_b64_tr_b16 v[88:89], v8 offset:2048
    ds_read_b64_tr_b16 v[90:91], v8 offset:2560
    ds_read_b64_tr_b16 v[92:93], v9 offset:2048
    ds_read_b64_tr_b16 v[94:95], v9 offset:2560
    ds_read_b64_tr_b16 v[96:97], v8 offset:4096
    ds_read_b64_tr_b16 v[98:99], v8 offset:4608
    ds_read_b64_tr_b16 v[100:101], v9 offset:4096
    ds_read_b64_tr_b16 v[102:103], v9 offset:4608
    ds_read_b64_tr_b16 v[104:105], v8 offset:6144
    ds_read_b64_tr_b16 v[106:107], v8 offset:6656
    ds_read_b64_tr_b16 v[108:109], v9 offset:6144
    ds_read_b64_tr_b16 v[110:111], v9 offset:6656
    s_waitcnt vmcnt(27)
    s_waitcnt lgkmcnt(12)
    v_mfma_f32_32x32x16_bf16 v[16:31], v[80:83], v[144:147], 0
    v_mfma_f32_32x32x16_bf16 v[32:47], v[84:87], v[144:147], 0
    ds_read_b64_tr_b16 v[80:81], v8 offset:8192
    ds_read_b64_tr_b16 v[82:83], v8 offset:8704
    ds_read_b64_tr_b16 v[84:85], v9 offset:8192
    ds_read_b64_tr_b16 v[86:87], v9 offset:8704
    s_waitcnt vmcnt(26)
    s_waitcnt lgkmcnt(12)
    v_mfma_f32_32x32x16_bf16 v[16:31], v[88:91], v[148:151], v[16:31]
    v_mfma_f32_32x32x16_bf16 v[32:47], v[92:95], v[148:151], v[32:47]
    ds_read_b64_tr_b16 v[88:89], v8 offset:10240
    ds_read_b64_tr_b16 v[90:91], v8 offset:10752
    ds_read_b64_tr_b16 v[92:93], v9 offset:10240
    ds_read_b64_tr_b16 v[94:95], v9 offset:10752
    s_waitcnt vmcnt(25)
    s_waitcnt lgkmcnt(12)
    v_mfma_f32_32x32x16_bf16 v[16:31], v[96:99], v[152:155], v[16:31]
    v_mfma_f32_32x32x16_bf16 v[32:47], v[100:103], v[152:155], v[32:47]
    ds_read_b64_tr_b16 v[96:97], v8 offset:12288
    ds_read_b64_tr_b16 v[98:99], v8 offset:12800
    ds_read_b64_tr_b16 v[100:101], v9 offset:12288
    ds_read_b64_tr_b16 v[102:103], v9 offset:12800
    s_waitcnt vmcnt(24)
    s_waitcnt lgkmcnt(12)
    v_mfma_f32_32x32x16_bf16 v[16:31], v[104:107], v[156:159], v[16:31]
    v_mfma_f32_32x32x16_bf16 v[32:47], v[108:111], v[156:159], v[32:47]
    ds_read_b64_tr_b16 v[104:105], v8 offset:14336
    ds_read_b64_tr_b16 v[106:107], v8 offset:14848
    ds_read_b64_tr_b16 v[108:109], v9 offset:14336
    ds_read_b64_tr_b16 v[110:111], v9 offset:14848
    s_waitcnt vmcnt(23)
    s_waitcnt lgkmcnt(12)
    v_mfma_f32_32x32x16_bf16 v[16:31], v[80:83], v[160:163], v[16:31]
    v_mfma_f32_32x32x16_bf16 v[32:47], v[84:87], v[160:163], v[32:47]
    ds_read_b64_tr_b16 v[80:81], v8 offset:16384
    ds_read_b64_tr_b16 v[82:83], v8 offset:16896
    ds_read_b64_tr_b16 v[84:85], v9 offset:16384
    ds_read_b64_tr_b16 v[86:87], v9 offset:16896
    s_waitcnt vmcnt(22)
    s_waitcnt lgkmcnt(12)
    v_mfma_f32_32x32x16_bf16 v[16:31], v[88:91], v[164:167], v[16:31]
    v_mfma_f32_32x32x16_bf16 v[32:47], v[92:95], v[164:167], v[32:47]
    ds_read_b64_tr_b16 v[88:89], v8 offset:18432
    ds_read_b64_tr_b16 v[90:91], v8 offset:18944
    ds_read_b64_tr_b16 v[92:93], v9 offset:18432
    ds_read_b64_tr_b16 v[94:95], v9 offset:18944
    s_waitcnt vmcnt(21)
    s_waitcnt lgkmcnt(12)
    v_mfma_f32_32x32x16_bf16 v[16:31], v[96:99], v[168:171], v[16:31]
    v_mfma_f32_32x32x16_bf16 v[32:47], v[100:103], v[168:171], v[32:47]
    ds_read_b64_tr_b16 v[96:97], v8 offset:20480
    ds_read_b64_tr_b16 v[98:99], v8 offset:20992
    ds_read_b64_tr_b16 v[100:101], v9 offset:20480
    ds_read_b64_tr_b16 v[102:103], v9 offset:20992
    s_waitcnt vmcnt(20)
    s_waitcnt lgkmcnt(12)
    v_mfma_f32_32x32x16_bf16 v[16:31], v[104:107], v[172:175], v[16:31]
    v_mfma_f32_32x32x16_bf16 v[32:47], v[108:111], v[172:175], v[32:47]
    ds_read_b64_tr_b16 v[104:105], v8 offset:22528
    ds_read_b64_tr_b16 v[106:107], v8 offset:23040
    ds_read_b64_tr_b16 v[108:109], v9 offset:22528
    ds_read_b64_tr_b16 v[110:111], v9 offset:23040
    s_waitcnt vmcnt(19)
    s_waitcnt lgkmcnt(12)
    v_mfma_f32_32x32x16_bf16 v[16:31], v[80:83], v[176:179], v[16:31]
    v_mfma_f32_32x32x16_bf16 v[32:47], v[84:87], v[176:179], v[32:47]
    ds_read_b64_tr_b16 v[80:81], v8 offset:24576
    ds_read_b64_tr_b16 v[82:83], v8 offset:25088
    ds_read_b64_tr_b16 v[84:85], v9 offset:24576
    ds_read_b64_tr_b16 v[86:87], v9 offset:25088
    s_waitcnt vmcnt(18)
    s_waitcnt lgkmcnt(12)
    v_mfma_f32_32x32x16_bf16 v[16:31], v[88:91], v[180:183], v[16:31]
    v_mfma_f32_32x32x16_bf16 v[32:47], v[92:95], v[180:183], v[32:47]
    ds_read_b64_tr_b16 v[88:89], v8 offset:26624
    ds_read_b64_tr_b16 v[90:91], v8 offset:27136
    ds_read_b64_tr_b16 v[92:93], v9 offset:26624
    ds_read_b64_tr_b16 v[94:95], v9 offset:27136
    s_waitcnt vmcnt(17)
    s_waitcnt lgkmcnt(12)
    v_mfma_f32_32x32x16_bf16 v[16:31], v[96:99], v[184:187], v[16:31]
    v_mfma_f32_32x32x16_bf16 v[32:47], v[100:103], v[184:187], v[32:47]
    ds_read_b64_tr_b16 v[96:97], v8 offset:28672
    ds_read_b64_tr_b16 v[98:99], v8 offset:29184
    ds_read_b64_tr_b16 v[100:101], v9 offset:28672
    ds_read_b64_tr_b16 v[102:103], v9 offset:29184
    s_waitcnt vmcnt(16)
    s_waitcnt lgkmcnt(12)
    v_mfma_f32_32x32x16_bf16 v[16:31], v[104:107], v[188:191], v[16:31]
    v_mfma_f32_32x32x16_bf16 v[32:47], v[108:111], v[188:191], v[32:47]
    ds_read_b64_tr_b16 v[104:105], v8 offset:30720
    ds_read_b64_tr_b16 v[106:107], v8 offset:31232
    ds_read_b64_tr_b16 v[108:109], v9 offset:30720
    ds_read_b64_tr_b16 v[110:111], v9 offset:31232
    s_waitcnt vmcnt(15)
    s_waitcnt lgkmcnt(12)
    v_mfma_f32_32x32x16_bf16 v[16:31], v[80:83], v[192:195], v[16:31]
    v_mfma_f32_32x32x16_bf16 v[32:47], v[84:87], v[192:195], v[32:47]
    ds_read_b64_tr_b16 v[80:81], v8 offset:32768
    ds_read_b64_tr_b16 v[82:83], v8 offset:33280
    ds_read_b64_tr_b16 v[84:85], v9 offset:32768
    ds_read_b64_tr_b16 v[86:87], v9 offset:33280
    s_waitcnt vmcnt(14)
    s_waitcnt lgkmcnt(12)
    v_mfma_f32_32x32x16_bf16 v[16:31], v[88:91], v[196:199], v[16:31]
    v_mfma_f32_32x32x16_bf16 v[32:47], v[92:95], v[196:199], v[32:47]
    ds_read_b64_tr_b16 v[88:89], v8 offset:34816
    ds_read_b64_tr_b16 v[90:91], v8 offset:35328
    ds_read_b64_tr_b16 v[92:93], v9 offset:34816
    ds_read_b64_tr_b16 v[94:95], v9 offset:35328
    s_waitcnt vmcnt(13)
    s_waitcnt lgkmcnt(12)
    v_mfma_f32_32x32x16_bf16 v[16:31], v[96:99], v[200:203], v[16:31]
    v_mfma_f32_32x32x16_bf16 v[32:47], v[100:103], v[200:203], v[32:47]
    ds_read_b64_tr_b16 v[96:97], v8 offset:36864
    ds_read_b64_tr_b16 v[98:99], v8 offset:37376
    ds_read_b64_tr_b16 v[100:101], v9 offset:36864
    ds_read_b64_tr_b16 v[102:103], v9 offset:37376
    s_waitcnt vmcnt(12)
    s_waitcnt lgkmcnt(12)
    v_mfma_f32_32x32x16_bf16 v[16:31], v[104:107], v[204:207], v[16:31]
    v_mfma_f32_32x32x16_bf16 v[32:47], v[108:111], v[204:207], v[32:47]
    ds_read_b64_tr_b16 v[104:105], v8 offset:38912
    ds_read_b64_tr_b16 v[106:107], v8 offset:39424
    ds_read_b64_tr_b16 v[108:109], v9 offset:38912
    ds_read_b64_tr_b16 v[110:111], v9 offset:39424
    s_waitcnt vmcnt(11)
    s_waitcnt lgkmcnt(12)
    v_mfma_f32_32x32x16_bf16 v[16:31], v[80:83], v[208:211], v[16:31]
    v_mfma_f32_32x32x16_bf16 v[32:47], v[84:87], v[208:211], v[32:47]
    ds_read_b64_tr_b16 v[80:81], v8 offset:40960
    ds_read_b64_tr_b16 v[82:83], v8 offset:41472
    ds_read_b64_tr_b16 v[84:85], v9 offset:40960
    ds_read_b64_tr_b16 v[86:87], v9 offset:41472
    s_waitcnt vmcnt(10)
    s_waitcnt lgkmcnt(12)
    v_mfma_f32_32x32x16_bf16 v[16:31], v[88:91], v[212:215], v[16:31]
    v_mfma_f32_32x32x16_bf16 v[32:47], v[92:95], v[212:215], v[32:47]
    ds_read_b64_tr_b16 v[88:89], v8 offset:43008
    ds_read_b64_tr_b16 v[90:91], v8 offset:43520
    ds_read_b64_tr_b16 v[92:93], v9 offset:43008
    ds_read_b64_tr_b16 v[94:95], v9 offset:43520
    s_waitcnt vmcnt(9)
    s_waitcnt lgkmcnt(12)
    v_mfma_f32_32x32x16_bf16 v[16:31], v[96:99], v[216:219], v[16:31]
    v_mfma_f32_32x32x16_bf16 v[32:47], v[100:103], v[216:219], v[32:47]
    ds_read_b64_tr_b16 v[96:97], v8 offset:45056
    ds_read_b64_tr_b16 v[98:99], v8 offset:45568
    ds_read_b64_tr_b16 v[100:101], v9 offset:45056
    ds_read_b64_tr_b16 v[102:103], v9 offset:45568
    s_waitcnt vmcnt(8)
    s_waitcnt lgkmcnt(12)
    v_mfma_f32_32x32x16_bf16 v[16:31], v[104:107], v[220:223], v[16:31]
    v_mfma_f32_32x32x16_bf16 v[32:47], v[108:111], v[220:223], v[32:47]
    ds_read_b64_tr_b16 v[104:105], v8 offset:47104
    ds_read_b64_tr_b16 v[106:107], v8 offset:47616
    ds_read_b64_tr_b16 v[108:109], v9 offset:47104
    ds_read_b64_tr_b16 v[110:111], v9 offset:47616
    s_waitcnt vmcnt(7)
    s_waitcnt lgkmcnt(12)
    v_mfma_f32_32x32x16_bf16 v[16:31], v[80:83], v[224:227], v[16:31]
    v_mfma_f32_32x32x16_bf16 v[32:47], v[84:87], v[224:227], v[32:47]
    ds_read_b64_tr_b16 v[80:81], v8 offset:49152
    ds_read_b64_tr_b16 v[82:83], v8 offset:49664
    ds_read_b64_tr_b16 v[84:85], v9 offset:49152
    ds_read_b64_tr_b16 v[86:87], v9 offset:49664
    s_waitcnt vmcnt(6)
    s_waitcnt lgkmcnt(12)
    v_mfma_f32_32x32x16_bf16 v[16:31], v[88:91], v[228:231], v[16:31]
    v_mfma_f32_32x32x16_bf16 v[32:47], v[92:95], v[228:231], v[32:47]
    ds_read_b64_tr_b16 v[88:89], v8 offset:51200
    ds_read_b64_tr_b16 v[90:91], v8 offset:51712
    ds_read_b64_tr_b16 v[92:93], v9 offset:51200
    ds_read_b64_tr_b16 v[94:95], v9 offset:51712
    s_waitcnt vmcnt(5)
    s_waitcnt lgkmcnt(12)
    v_mfma_f32_32x32x16_bf16 v[16:31], v[96:99], v[232:235], v[16:31]
    v_mfma_f32_32x32x16_bf16 v[32:47], v[100:103], v[232:235], v[32:47]
    ds_read_b64_tr_b16 v[96:97], v8 offset:53248
    ds_read_b64_tr_b16 v[98:99], v8 offset:53760
    ds_read_b64_tr_b16 v[100:101], v9 offset:53248
    ds_read_b64_tr_b16 v[102:103], v9 offset:53760
    s_waitcnt vmcnt(4)
    s_waitcnt lgkmcnt(12)
    v_mfma_f32_32x32x16_bf16 v[16:31], v[104:107], v[236:239], v[16:31]
    v_mfma_f32_32x32x16_bf16 v[32:47], v[108:111], v[236:239], v[32:47]
    ds_read_b64_tr_b16 v[104:105], v8 offset:55296
    ds_read_b64_tr_b16 v[106:107], v8 offset:55808
    ds_read_b64_tr_b16 v[108:109], v9 offset:55296
    ds_read_b64_tr_b16 v[110:111], v9 offset:55808
    s_waitcnt vmcnt(3)
    s_waitcnt lgkmcnt(12)
    v_mfma_f32_32x32x16_bf16 v[16:31], v[80:83], v[240:243], v[16:31]
    v_mfma_f32_32x32x16_bf16 v[32:47], v[84:87], v[240:243], v[32:47]
    s_waitcnt vmcnt(2)
    s_waitcnt lgkmcnt(8)
    v_mfma_f32_32x32x16_bf16 v[16:31], v[88:91], v[244:247], v[16:31]
    v_mfma_f32_32x32x16_bf16 v[32:47], v[92:95], v[244:247], v[32:47]
    s_waitcnt vmcnt(1)
    s_waitcnt lgkmcnt(4)
    v_mfma_f32_32x32x16_bf16 v[16:31], v[96:99], v[248:251], v[16:31]
    v_mfma_f32_32x32x16_bf16 v[32:47], v[100:103], v[248:251], v[32:47]
    s_waitcnt vmcnt(0)
    s_waitcnt lgkmcnt(0)
    v_mfma_f32_32x32x16_bf16 v[16:31], v[104:107], v[252:255], v[16:31]
    v_mfma_f32_32x32x16_bf16 v[32:47], v[108:111], v[252:255], v[32:47]
    v_lshlrev_b32 v10, 4, v1
    s_lshl_b32 s3, s6, 12
    s_add_u32 s3, s3, 147456
    v_add_u32 v11, s3, v10
    s_xor_b32 s3, s3, 8192
    v_add_u32 v12, s3, v10
    s_nop 7
    s_cmp_ge_u32 s6, 2
    s_cbranch_scc1 XC_47
    ds_write_b128 v11, v[32:35] offset:0
    ds_write_b128 v11, v[36:39] offset:1024
    ds_write_b128 v11, v[40:43] offset:2048
    ds_write_b128 v11, v[44:47] offset:3072
    v_mov_b32 v48, v16
    v_mov_b32 v49, v17
    v_mov_b32 v50, v18
    v_mov_b32 v51, v19
    v_mov_b32 v52, v20
    v_mov_b32 v53, v21
    v_mov_b32 v54, v22
    v_mov_b32 v55, v23
    v_mov_b32 v56, v24
    v_mov_b32 v57, v25
    v_mov_b32 v58, v26
    v_mov_b32 v59, v27
    v_mov_b32 v60, v28
    v_mov_b32 v61, v29
    v_mov_b32 v62, v30
    v_mov_b32 v63, v31
    s_branch XC_48
XC_47:
    ds_write_b128 v11, v[16:19] offset:0
    ds_write_b128 v11, v[20:23] offset:1024
    ds_write_b128 v11, v[24:27] offset:2048
    ds_write_b128 v11, v[28:31] offset:3072
    v_mov_b32 v48, v32
    v_mov_b32 v49, v33
    v_mov_b32 v50, v34
    v_mov_b32 v51, v35
    v_mov_b32 v52, v36
    v_mov_b32 v53, v37
    v_mov_b32 v54, v38
    v_mov_b32 v55, v39
    v_mov_b32 v56, v40
    v_mov_b32 v57, v41
    v_mov_b32 v58, v42
    v_mov_b32 v59, v43
    v_mov_b32 v60, v44
    v_mov_b32 v61, v45
    v_mov_b32 v62, v46
    v_mov_b32 v63, v47
XC_48:
    s_waitcnt lgkmcnt(0)
    s_barrier
    ds_read_b128 v[16:19], v12 offset:0
    ds_read_b128 v[20:23], v12 offset:1024
    ds_read_b128 v[24:27], v12 offset:2048
    ds_read_b128 v[28:31], v12 offset:3072
    s_waitcnt lgkmcnt(0)
    v_add_f32 v48, v48, v16
    v_add_f32 v49, v49, v17
    v_add_f32 v50, v50, v18
    v_add_f32 v51, v51, v19
    v_add_f32 v52, v52, v20
    v_add_f32 v53, v53, v21
    v_add_f32 v54, v54, v22
    v_add_f32 v55, v55, v23
    v_add_f32 v56, v56, v24
    v_add_f32 v57, v57, v25
    v_add_f32 v58, v58, v26
    v_add_f32 v59, v59, v27
    v_add_f32 v60, v60, v28
    v_add_f32 v61, v61, v29
    v_add_f32 v62, v62, v30
    v_add_f32 v63, v63, v31
    v_lshlrev_b32 v10, 4, v0
    v_add_u32 v10, 139264, v10
    ds_read_b128 v[16:19], v10
    ds_read_b128 v[20:23], v10 offset:4096
    s_waitcnt lgkmcnt(0)
    v_lshlrev_b32 v10, 16, v16
    v_and_b32 v11, 0xffff0000, v16
    v_fma_f32 v48, v48, v112, v10
    v_fma_f32 v49, v49, v113, v11
    v_lshlrev_b32 v10, 16, v17
    v_and_b32 v11, 0xffff0000, v17
    v_fma_f32 v50, v50, v114, v10
    v_fma_f32 v51, v51, v115, v11
    v_lshlrev_b32 v10, 16, v18
    v_and_b32 v11, 0xffff0000, v18
    v_fma_f32 v52, v52, v116, v10
    v_fma_f32 v53, v53, v117, v11
    v_lshlrev_b32 v10, 16, v19
    v_and_b32 v11, 0xffff0000, v19
    v_fma_f32 v54, v54, v118, v10
    v_fma_f32 v55, v55, v119, v11
    v_lshlrev_b32 v10, 16, v20
    v_and_b32 v11, 0xffff0000, v20
    v_fma_f32 v56, v56, v120, v10
    v_fma_f32 v57, v57, v121, v11
    v_lshlrev_b32 v10, 16, v21
    v_and_b32 v11, 0xffff0000, v21
    v_fma_f32 v58, v58, v122, v10
    v_fma_f32 v59, v59, v123, v11
    v_lshlrev_b32 v10, 16, v22
    v_and_b32 v11, 0xffff0000, v22
    v_fma_f32 v60, v60, v124, v10
    v_fma_f32 v61, v61, v125, v11
    v_lshlrev_b32 v10, 16, v23
    v_and_b32 v11, 0xffff0000, v23
    v_fma_f32 v62, v62, v126, v10
    v_fma_f32 v63, v63, v127, v11
    s_lshl_b32 s76, s74, 15
    s_lshl_b32 s3, s75, 1
    s_add_u32 s76, s76, s3
    v_lshlrev_b32 v13, 10, v2
    v_lshl_add_u32 v13, v3, 4, v13
    v_cvt_pk_bf16_f32 v28, v48, v49
    v_cvt_pk_bf16_f32 v29, v50, v51
    v_cvt_pk_bf16_f32 v30, v52, v53
    v_cvt_pk_bf16_f32 v31, v54, v55
    s_nop 0
    v_permlane32_swap_b32 v28, v30
    v_permlane32_swap_b32 v29, v31
    buffer_store_dwordx4 v[28:31], v13, s[44:47], s76 offen offset:0
    v_cvt_pk_bf16_f32 v32, v56, v57
    v_cvt_pk_bf16_f32 v33, v58, v59
    v_cvt_pk_bf16_f32 v34, v60, v61
    v_cvt_pk_bf16_f32 v35, v62, v63
    s_nop 0
    v_permlane32_swap_b32 v32, v34
    v_permlane32_swap_b32 v33, v35
    buffer_store_dwordx4 v[32:35], v13, s[44:47], s76 offen offset:32
    s_cmp_lg_u32 s2, 0
    s_cbranch_scc1 FN_49
    s_cmp_lg_u32 s6, 0
    s_cbranch_scc1 FN_49
    v_mov_b32 v4, s7
    v_mov_b32 v5, 0
    s_mov_b64 exec, 1
    buffer_store_dword v4, v5, s[48:51], 0 offen sc0 sc1
    s_mov_b64 exec, -1
FN_49:
    s_waitcnt vmcnt(0)
END:
    s_endpgm
.section .rodata,"a"
.p2align 6
.amdhsa_kernel adaLN_cond__mha_block__mixer_gmlp__prompt_kernel
  .amdhsa_next_free_vgpr 512
  .amdhsa_next_free_sgpr 102
  .amdhsa_accum_offset 256
  .amdhsa_group_segment_fixed_size 0
  .amdhsa_kernarg_size 104
  .amdhsa_user_sgpr_count 2
  .amdhsa_user_sgpr_kernarg_segment_ptr 1
  .amdhsa_system_sgpr_workgroup_id_x 1
.end_amdhsa_kernel
```
